```python
import torch

def _softmax(x, axis=-1):
    return torch.softmax(x, dim=axis)
def _gelu(x):
    return torch.nn.functional.gelu(x, approximate="tanh")
def _silu(x):
    return torch.nn.functional.silu(x)
def _sigmoid(x):
    return torch.sigmoid(x)
def _layernorm(x, axis=-1, eps=1e-5):
    m = x.mean(dim=axis, keepdim=True)
    v = x.var(dim=axis, keepdim=True, unbiased=False)
    return (x - m) / torch.sqrt(v + eps)
def _scatter_add(tgt, idx, src, axis=0):
    return tgt.clone().index_add_(axis, idx, src)
def _segment_sum(src, seg, n):
    out = torch.zeros((n,) + src.shape[1:], dtype=src.dtype)
    return out.index_add_(0, seg, src)
def _pad(x, pw):
    flat = tuple(v for pair in reversed(pw) for v in pair)
    return torch.nn.functional.pad(x, flat)

kernel_name = 'interleave_layers__sliding_block__mixer_token_mlp__prompt'

def setup_inputs():

    _w = (lambda a: (lambda t: t.to(torch.bfloat16) if t.is_floating_point() else t)(torch.as_tensor(a)))
    def _A_setup():
        B, S, D = 1, 2048, 512
        return {
            "x": _w((lambda *s: torch.randn(*s, dtype=torch.bfloat16) * 0.05)(B, S, D)),
            "wqkv": _w((lambda *s: torch.randn(*s, dtype=torch.bfloat16) * 0.05)(D, 3 * D)),
            "wo": _w((lambda *s: torch.randn(*s, dtype=torch.bfloat16) * 0.05)(D, D)),
        }
    _A_in = _A_setup()

    def _B_setup():
        B, S, D, F = 1, 2048, 512, 1376
        return {
            "x": _w((lambda *s: torch.randn(*s, dtype=torch.bfloat16) * 0.05)(B, S, D)),
            "w1": _w((lambda *s: torch.randn(*s, dtype=torch.bfloat16) * 0.8)(S, F) * (S ** -0.5)),
            "b1": _w((lambda *s: torch.randn(*s, dtype=torch.bfloat16) * 0.8)(F) * 0.02),
            "w2": _w((lambda *s: torch.randn(*s, dtype=torch.bfloat16) * 0.8)(F, S) * (F ** -0.5)),
            "b2": _w((lambda *s: torch.randn(*s, dtype=torch.bfloat16) * 0.8)(S) * 0.02),
        }
    _B_in = _B_setup()

    return {
        "A_x": _A_in["x"],
        "A_wqkv": _A_in["wqkv"],
        "A_wo": _A_in["wo"],
        "B_x": _B_in["x"],
        "B_w1": _B_in["w1"],
        "B_b1": _B_in["b1"],
        "B_w2": _B_in["w2"],
        "B_b2": _B_in["b2"],
    }

def reference(A_x, A_wqkv, A_wo, B_x, B_w1, B_b1, B_w2, B_b2):
    def _A_ref(x, wqkv, wo):
        B, S, D = x.shape
        H = 32; Dh = D // H; W = 256
        qkv = (lambda x, *d: x.permute(*d))((x @ wqkv).reshape(B, S, 3, H, Dh), 2, 0, 3, 1, 4)
        q, k, v = qkv[0], qkv[1], qkv[2]
        scores = torch.einsum("bhqd,bhkd->bhqk", q, k) * (Dh ** -0.5)
        idx = torch.arange(S)
        mask = (idx[:, None] - idx[None, :] >= 0) & (idx[:, None] - idx[None, :] < W)
        scores = torch.where(mask[None, None], scores, -1e9)
        p = _softmax(scores, axis=-1)
        o = torch.einsum("bhqk,bhkd->bhqd", p, v)
        return (lambda x, *d: x.permute(*d))(o, 0, 2, 1, 3).reshape(B, S, D) @ wo

    def _B_ref(x, w1, b1, w2, b2):
        B, S, D = x.shape
        h = _layernorm(x, axis=-1)
        u = torch.einsum("bsd,sf->bdf", h, w1) + b1
        u = _gelu(u)
        y = torch.einsum("bdf,fs->bds", u, w2) + b2
        return (lambda x, *d: x.permute(*d))(y, 0, 2, 1)

    x = A_x
    x = x + _A_ref(_layernorm(x, axis=-1), A_wqkv, A_wo)
    x = x + _B_ref(_layernorm(x, axis=-1), B_w1, B_b1, B_w2, B_b2)
    x = x + _A_ref(_layernorm(x, axis=-1), A_wqkv, A_wo)
    x = x + _B_ref(_layernorm(x, axis=-1), B_w1, B_b1, B_w2, B_b2)
    return x
```

```asm
; @launch grid=(256,1,1) block=(256,1,1) lds=163840
.amdgcn_target "amdgcn-amd-amdhsa--gfx950"
.text
.globl interleave_layers__sliding_block__mixer_token_mlp__prompt_kernel
.p2align 8
.type interleave_layers__sliding_block__mixer_token_mlp__prompt_kernel,@function
interleave_layers__sliding_block__mixer_token_mlp__prompt_kernel:
  s_cmp_ge_u32 s2, 256
  s_cbranch_scc1 L_end
  s_getpc_b64 s[32:33]
L_pc:
  s_sub_u32 s32, s32, L_pc-interleave_layers__sliding_block__mixer_token_mlp__prompt_kernel
  s_subb_u32 s33, s33, 0
  s_mov_b32 s34, L_code_end-interleave_layers__sliding_block__mixer_token_mlp__prompt_kernel
  s_mov_b32 s35, 0x20000
  v_and_b32 v3, 63, v0
  v_lshrrev_b32 v4, 6, v0
  v_mul_u32_u24 v4, 640, v4
  v_lshl_add_u32 v3, v3, 7, v4
  s_lshr_b32 s72, s2, 3
  s_mul_i32 s72, s72, 2560
  s_mov_b64 exec, 0x1f
  buffer_load_dword v249, v3, s[32:35], s72 offen
  s_mov_b64 exec, -1
  s_load_dwordx16 s[36:51], s[0:1], 0
  s_load_dwordx4 s[52:55], s[0:1], 64
  s_load_dwordx2 s[56:57], s[0:1], 80
  v_and_b32 v1, 63, v0
  v_lshlrev_b32 v2, 4, v1
  v_lshrrev_b32 v3, 6, v0
  s_nop 0
  v_readfirstlane_b32 s60, v3
  s_and_b32 s70, s2, 7
  s_lshr_b32 s71, s2, 3
  s_lshr_b32 s72, s71, 3
  s_lshl_b32 s58, s70, 2
  s_add_u32 s58, s58, s72
  s_and_b32 s59, s71, 7
  s_and_b32 s72, s70, 1
  s_lshl_b32 s72, s72, 2
  s_and_b32 s73, s71, 3
  s_add_u32 s64, s72, s73
  s_lshr_b32 s72, s70, 1
  s_lshr_b32 s73, s71, 2
  s_mul_i32 s74, s72, 7
  s_min_u32 s75, s72, 1
  s_add_u32 s74, s74, s75
  s_add_u32 s65, s74, s73
  s_cmp_eq_u32 s72, 0
  s_cselect_b32 s75, 8, 7
  s_cmp_lt_u32 s73, s75
  s_cselect_b32 s66, 1, 0
  s_and_b32 s67, s60, 1
  s_lshr_b32 s68, s60, 1
  s_xor_b32 s69, s67, s68
  s_mov_b32 s61, 0
  s_waitcnt lgkmcnt(0)
  s_mov_b32 s4, s36
  s_mov_b32 s5, s37
  s_mov_b32 s6, 2097152
  s_mov_b32 s7, 0x20000
  s_mov_b32 s8, s38
  s_mov_b32 s9, s39
  s_mov_b32 s10, 1572864
  s_mov_b32 s11, 0x20000
  v_lshlrev_b32 v3, 7, v1
  s_lshl_b32 s70, s59, 2
  s_add_u32 s70, s70, s60
  s_lshl_b32 s70, s70, 11
  s_lshl_b32 s71, s58, 16
  s_add_u32 s70, s70, s71
  s_mov_b64 exec, 0xffff
  buffer_load_dword v231, v3, s[4:7], s70 offen
  s_mov_b64 exec, -1
  s_lshl_b32 s70, s2, 2
  s_add_u32 s70, s70, s60
  s_mul_i32 s70, s70, 1536
  s_mov_b64 exec, 0xfff
  buffer_load_dword v248, v3, s[8:11], s70 offen
  s_mov_b64 exec, -1
  s_mov_b32 s12, s40
  s_mov_b32 s13, s41
  s_mov_b32 s14, 524288
  s_mov_b32 s15, 0x20000
  s_mov_b32 s16, s56
  s_mov_b32 s17, s57
  s_mov_b32 s18, 67108864
  s_mov_b32 s19, 0x20000
  s_mov_b32 s28, s48
  s_mov_b32 s29, s49
  s_mov_b32 s30, 5636096
  s_mov_b32 s31, 0x20000
  s_mov_b32 s96, s44
  s_mov_b32 s97, s45
  s_mov_b32 s98, 5636096
  s_mov_b32 s99, 0x20000
  s_add_u32 s20, s56, 22020096
  s_addc_u32 s21, s57, 0
  s_mov_b32 s22, 2097152
  s_mov_b32 s23, 0x20000
  v_mov_b32 v3, 0
  buffer_load_dword v250, v3, s[16:19], 0 offen sc1
  v_lshrrev_b32 v3, 3, v0
  v_and_b32 v4, 7, v0
  s_lshl_b32 s70, s58, 16
  s_lshl_b32 s71, s59, 7
  s_add_u32 s70, s70, s71
  v_lshlrev_b32 v5, 10, v3
  v_lshl_add_u32 v5, v4, 4, v5
  buffer_load_dwordx4 v[240:243], v5, s[4:7], s70 offen
  s_add_u32 s70, s70, 32768
  buffer_load_dwordx4 v[244:247], v5, s[4:7], s70 offen
  v_lshrrev_b32 v3, 3, v1
  v_mul_u32_u24 v12, 3072, v3
  v_bfe_u32 v4, v1, 4, 1
  v_lshlrev_b32 v4, 2, v4
  v_and_b32 v5, 7, v1
  v_xor_b32 v5, v5, v4
  v_lshl_add_u32 v12, v5, 4, v12
  v_lshrrev_b32 v3, 3, v1
  s_lshl_b32 s72, s60, 4
  s_add_u32 s72, s72, 0
  v_add_u32 v6, s72, v3
  v_bfe_u32 v7, v6, 1, 3
  v_and_b32 v5, 7, v1
  v_xor_b32 v5, v5, v7
  v_lshlrev_b32 v6, 10, v6
  v_lshl_add_u32 v10, v5, 4, v6
  s_lshl_b32 s72, s60, 4
  s_add_u32 s72, s72, 8
  v_add_u32 v6, s72, v3
  v_bfe_u32 v7, v6, 1, 3
  v_and_b32 v5, 7, v1
  v_xor_b32 v5, v5, v7
  v_lshlrev_b32 v6, 10, v6
  v_lshl_add_u32 v11, v5, 4, v6
  s_mul_i32 s70, s60, 24576
  s_lshl_b32 s72, s59, 7
  s_add_u32 s70, s70, s72
  s_lshl_b32 s71, s60, 10
  s_lshl_b32 s76, s58, 16
  s_lshl_b32 s77, s60, 11
  s_add_u32 m0, s71, 65536
  s_add_u32 s78, s70, 1024
  buffer_load_dwordx4 v12, s[8:11], s78 offen lds
  v_and_b32 v3, 31, v1
  s_lshl_b32 s72, s68, 5
  s_add_u32 m0, s71, 69632
  s_add_u32 s78, s70, 99328
  buffer_load_dwordx4 v12, s[8:11], s78 offen lds
  v_add_u32 v3, s72, v3
  v_bfe_u32 v4, v3, 1, 3
  s_add_u32 m0, s71, 73728
  s_add_u32 s78, s70, 2048
  buffer_load_dwordx4 v12, s[8:11], s78 offen lds
  v_lshrrev_b32 v5, 5, v1
  s_xor_b32 s72, s69, 0
  s_add_u32 m0, s71, 77824
  s_add_u32 s78, s70, 100352
  buffer_load_dwordx4 v12, s[8:11], s78 offen lds
  s_lshl_b32 s72, s72, 1
  v_add_u32 v6, s72, v5
  s_add_u32 m0, s77, 0
  s_add_u32 s78, s76, 0
  buffer_load_dwordx4 v10, s[4:7], s78 offen sc1 lds
  v_xor_b32 v6, v6, v4
  v_lshlrev_b32 v6, 4, v6
  s_add_u32 m0, s77, 1024
  s_add_u32 s78, s76, 0
  buffer_load_dwordx4 v11, s[4:7], s78 offen sc1 lds
  v_lshl_add_u32 v13, v3, 7, v6
  s_xor_b32 s72, s69, 1
  s_add_u32 m0, s71, 81920
  s_add_u32 s78, s70, 197632
  buffer_load_dwordx4 v12, s[8:11], s78 offen lds
  s_lshl_b32 s72, s72, 1
  v_add_u32 v6, s72, v5
  s_add_u32 m0, s71, 86016
  s_add_u32 s78, s70, 295936
  buffer_load_dwordx4 v12, s[8:11], s78 offen lds
  v_xor_b32 v6, v6, v4
  v_lshlrev_b32 v6, 4, v6
  s_add_u32 m0, s71, 90112
  s_add_u32 s78, s70, 198656
  buffer_load_dwordx4 v12, s[8:11], s78 offen lds
  v_lshl_add_u32 v14, v3, 7, v6
  s_xor_b32 s72, s69, 2
  s_add_u32 m0, s71, 94208
  s_add_u32 s78, s70, 296960
  buffer_load_dwordx4 v12, s[8:11], s78 offen lds
  s_lshl_b32 s72, s72, 1
  v_add_u32 v6, s72, v5
  s_add_u32 m0, s77, 8192
  s_add_u32 s78, s76, 128
  buffer_load_dwordx4 v10, s[4:7], s78 offen sc1 lds
  v_xor_b32 v6, v6, v4
  v_lshlrev_b32 v6, 4, v6
  s_add_u32 m0, s77, 9216
  s_add_u32 s78, s76, 128
  buffer_load_dwordx4 v11, s[4:7], s78 offen sc1 lds
  v_lshl_add_u32 v15, v3, 7, v6
  s_xor_b32 s72, s69, 3
  s_add_u32 m0, s71, 98304
  s_add_u32 s78, s70, 394240
  buffer_load_dwordx4 v12, s[8:11], s78 offen lds
  s_lshl_b32 s72, s72, 1
  v_add_u32 v6, s72, v5
  s_add_u32 m0, s71, 102400
  s_add_u32 s78, s70, 492544
  buffer_load_dwordx4 v12, s[8:11], s78 offen lds
  v_xor_b32 v6, v6, v4
  v_lshlrev_b32 v6, 4, v6
  s_add_u32 m0, s71, 106496
  s_add_u32 s78, s70, 395264
  buffer_load_dwordx4 v12, s[8:11], s78 offen lds
  v_lshl_add_u32 v16, v3, 7, v6
  v_and_b32 v3, 15, v1
  s_add_u32 m0, s71, 110592
  s_add_u32 s78, s70, 493568
  buffer_load_dwordx4 v12, s[8:11], s78 offen lds
  v_lshrrev_b32 v4, 2, v3
  v_lshrrev_b32 v5, 5, v1
  s_add_u32 m0, s77, 16384
  s_add_u32 s78, s76, 256
  buffer_load_dwordx4 v10, s[4:7], s78 offen sc1 lds
  v_lshl_add_u32 v4, v5, 3, v4
  v_bfe_u32 v5, v1, 4, 1
  s_add_u32 m0, s77, 17408
  s_add_u32 s78, s76, 256
  buffer_load_dwordx4 v11, s[4:7], s78 offen sc1 lds
  v_lshlrev_b32 v5, 1, v5
  v_bfe_u32 v6, v1, 1, 1
  s_add_u32 m0, s71, 114688
  s_add_u32 s78, s70, 590848
  buffer_load_dwordx4 v12, s[8:11], s78 offen lds
  v_add_u32 v5, v5, v6
  s_lshl_b32 s72, s67, 2
  s_add_u32 m0, s71, 118784
  s_add_u32 s78, s70, 689152
  buffer_load_dwordx4 v12, s[8:11], s78 offen lds
  v_add_u32 v5, s72, v5
  v_bfe_u32 v6, v1, 3, 1
  s_add_u32 m0, s71, 122880
  s_add_u32 s78, s70, 591872
  buffer_load_dwordx4 v12, s[8:11], s78 offen lds
  v_lshlrev_b32 v6, 2, v6
  v_xor_b32 v5, v5, v6
  s_add_u32 m0, s71, 126976
  s_add_u32 s78, s70, 690176
  buffer_load_dwordx4 v12, s[8:11], s78 offen lds
  v_lshlrev_b32 v5, 4, v5
  v_lshl_add_u32 v5, v4, 7, v5
  s_add_u32 m0, s77, 24576
  s_add_u32 s78, s76, 384
  buffer_load_dwordx4 v10, s[4:7], s78 offen sc1 lds
  v_and_b32 v6, 1, v1
  v_lshl_add_u32 v5, v6, 3, v5
  s_add_u32 m0, s77, 25600
  s_add_u32 s78, s76, 384
  buffer_load_dwordx4 v11, s[4:7], s78 offen sc1 lds
  s_xor_b32 s72, s69, 0
  s_lshl_b32 s72, s72, 11
  s_add_u32 m0, s71, 131072
  s_add_u32 s78, s70, 787456
  buffer_load_dwordx4 v12, s[8:11], s78 offen lds
  s_add_u32 s72, s72, 65536
  v_add_u32 v17, s72, v5
  s_add_u32 m0, s71, 135168
  s_add_u32 s78, s70, 885760
  buffer_load_dwordx4 v12, s[8:11], s78 offen lds
  v_add_u32 v19, 49152, v17
  s_xor_b32 s72, s69, 1
  s_add_u32 m0, s71, 139264
  s_add_u32 s78, s70, 788480
  buffer_load_dwordx4 v12, s[8:11], s78 offen lds
  s_lshl_b32 s72, s72, 11
  s_add_u32 s72, s72, 65536
  s_add_u32 m0, s71, 143360
  s_add_u32 s78, s70, 886784
  buffer_load_dwordx4 v12, s[8:11], s78 offen lds
  v_add_u32 v18, s72, v5
  v_add_u32 v20, 49152, v18
  s_add_u32 m0, s77, 32768
  s_add_u32 s78, s76, 512
  buffer_load_dwordx4 v10, s[4:7], s78 offen sc1 lds
  v_mov_b32 v21, 0
  v_mov_b32 v24, 0
  s_add_u32 m0, s77, 33792
  s_add_u32 s78, s76, 512
  buffer_load_dwordx4 v11, s[4:7], s78 offen sc1 lds
  v_mov_b32 v25, 0
  s_mov_b32 s74, 0x3f803f80
  s_add_u32 m0, s77, 40960
  s_add_u32 s78, s76, 640
  buffer_load_dwordx4 v10, s[4:7], s78 offen sc1 lds
  s_lshl_b32 s72, s61, 5
  s_add_u32 s72, s72, s58
  s_add_u32 m0, s77, 41984
  s_add_u32 s78, s76, 640
  buffer_load_dwordx4 v11, s[4:7], s78 offen sc1 lds
  s_lshl_b32 s75, s72, 13
  s_add_u32 s75, s75, 36700160
  s_add_u32 m0, s77, 49152
  s_add_u32 s78, s76, 768
  buffer_load_dwordx4 v10, s[4:7], s78 offen sc1 lds
  v_and_b32 v3, 31, v1
  s_lshl_b32 s72, s68, 5
  s_add_u32 m0, s77, 50176
  s_add_u32 s78, s76, 768
  buffer_load_dwordx4 v11, s[4:7], s78 offen sc1 lds
  v_add_u32 v3, s72, v3
  v_lshlrev_b32 v3, 4, v3
  s_add_u32 m0, s77, 57344
  s_add_u32 s78, s76, 896
  buffer_load_dwordx4 v10, s[4:7], s78 offen sc1 lds
  v_lshrrev_b32 v4, 5, v1
  v_lshl_add_u32 v61, v4, 12, v3
  s_add_u32 m0, s77, 58368
  s_add_u32 s78, s76, 896
  buffer_load_dwordx4 v11, s[4:7], s78 offen sc1 lds
  v_lshlrev_b32 v3, 21, v1
  s_mov_b64 exec, 0x3ffff
  buffer_load_dword v251, v3, s[16:19], 0 offen
  s_mov_b64 exec, -1
  s_lshl_b32 s72, s2, 2
  s_add_u32 s72, s72, s60
  s_lshl_b32 s72, s72, 9
  v_lshlrev_b32 v3, 7, v1
  s_mov_b64 exec, 0xf
  buffer_load_dword v252, v3, s[12:15], s72 offen
  s_mov_b64 exec, -1
  v_lshrrev_b32 v3, 3, v0
  v_and_b32 v4, 7, v0
  v_mul_u32_u24 v6, 144, v3
  v_lshl_add_u32 v6, v4, 4, v6
  v_add_u32 v6, 147456, v6
  s_waitcnt vmcnt(40)
  v_readfirstlane_b32 s62, v250
  s_add_u32 s62, s62, 1
  s_not_b32 s63, s62
  s_waitcnt vmcnt(39)
  ds_write_b128 v6, v[240:243]
  s_waitcnt vmcnt(38)
  ds_write_b128 v6, v[244:247] offset:4608
  v_mov_b32 v232, 0
  v_mov_b32 v233, 0
  v_lshlrev_b32 v8, 16, v240
  v_and_b32 v9, 0xffff0000, v240
  v_add_f32 v232, v232, v8
  v_fmac_f32 v233, v8, v8
  v_add_f32 v232, v232, v9
  v_fmac_f32 v233, v9, v9
  v_lshlrev_b32 v8, 16, v241
  v_and_b32 v9, 0xffff0000, v241
  v_add_f32 v232, v232, v8
  v_fmac_f32 v233, v8, v8
  v_add_f32 v232, v232, v9
  v_fmac_f32 v233, v9, v9
  v_lshlrev_b32 v8, 16, v242
  v_and_b32 v9, 0xffff0000, v242
  v_add_f32 v232, v232, v8
  v_fmac_f32 v233, v8, v8
  v_add_f32 v232, v232, v9
  v_fmac_f32 v233, v9, v9
  v_lshlrev_b32 v8, 16, v243
  v_and_b32 v9, 0xffff0000, v243
  v_add_f32 v232, v232, v8
  v_fmac_f32 v233, v8, v8
  v_add_f32 v232, v232, v9
  v_fmac_f32 v233, v9, v9
  v_mov_b32 v236, 0
  v_mov_b32 v237, 0
  v_lshlrev_b32 v8, 16, v244
  v_and_b32 v9, 0xffff0000, v244
  v_add_f32 v236, v236, v8
  v_fmac_f32 v237, v8, v8
  v_add_f32 v236, v236, v9
  v_fmac_f32 v237, v9, v9
  v_lshlrev_b32 v8, 16, v245
  v_and_b32 v9, 0xffff0000, v245
  v_add_f32 v236, v236, v8
  v_fmac_f32 v237, v8, v8
  v_add_f32 v236, v236, v9
  v_fmac_f32 v237, v9, v9
  v_lshlrev_b32 v8, 16, v246
  v_and_b32 v9, 0xffff0000, v246
  v_add_f32 v236, v236, v8
  v_fmac_f32 v237, v8, v8
  v_add_f32 v236, v236, v9
  v_fmac_f32 v237, v9, v9
  v_lshlrev_b32 v8, 16, v247
  v_and_b32 v9, 0xffff0000, v247
  v_add_f32 v236, v236, v8
  v_fmac_f32 v237, v8, v8
  v_add_f32 v236, v236, v9
  v_fmac_f32 v237, v9, v9
  v_add_f32_dpp v232, v232, v232 quad_perm:[1,0,3,2] row_mask:0xf bank_mask:0xf
  v_add_f32_dpp v233, v233, v233 quad_perm:[1,0,3,2] row_mask:0xf bank_mask:0xf
  v_add_f32_dpp v236, v236, v236 quad_perm:[1,0,3,2] row_mask:0xf bank_mask:0xf
  v_add_f32_dpp v237, v237, v237 quad_perm:[1,0,3,2] row_mask:0xf bank_mask:0xf
  v_add_f32_dpp v232, v232, v232 quad_perm:[2,3,0,1] row_mask:0xf bank_mask:0xf
  v_add_f32_dpp v233, v233, v233 quad_perm:[2,3,0,1] row_mask:0xf bank_mask:0xf
  v_add_f32_dpp v236, v236, v236 quad_perm:[2,3,0,1] row_mask:0xf bank_mask:0xf
  v_add_f32_dpp v237, v237, v237 quad_perm:[2,3,0,1] row_mask:0xf bank_mask:0xf
  v_add_f32_dpp v232, v232, v232 row_half_mirror row_mask:0xf bank_mask:0xf
  v_add_f32_dpp v233, v233, v233 row_half_mirror row_mask:0xf bank_mask:0xf
  v_add_f32_dpp v236, v236, v236 row_half_mirror row_mask:0xf bank_mask:0xf
  v_add_f32_dpp v237, v237, v237 row_half_mirror row_mask:0xf bank_mask:0xf
  v_mov_b32 v234, s62
  v_mov_b32 v235, s63
  v_mov_b32 v238, s62
  v_mov_b32 v239, s63
  s_add_u32 s72, s58, 0
  s_lshl_b32 s72, s72, 3
  s_add_u32 s72, s72, s59
  s_lshl_b32 s72, s72, 10
  s_add_u32 s72, s72, 36700160
  v_lshrrev_b32 v3, 3, v0
  v_lshlrev_b32 v3, 4, v3
  v_and_b32 v4, 7, v0
  v_cmp_eq_u32 vcc, 0, v4
  s_mov_b64 exec, vcc
  buffer_store_dwordx4 v[232:235], v3, s[16:19], s72 offen offset:0 sc1
  buffer_store_dwordx4 v[236:239], v3, s[16:19], s72 offen offset:512 sc1
  s_mov_b64 exec, -1
  s_getreg_b32 s72, hwreg(HW_REG_XCC_ID)
  s_and_b32 s1, s72, 15
  s_mov_b32 s0, 0
  s_lshl_b32 s72, s58, 3
  s_add_u32 s72, s72, s59
  s_lshl_b32 s72, s72, 4
  s_add_u32 s72, s72, 37224448
  v_mov_b32 v232, s1
  v_mov_b32 v233, 0
  v_mov_b32 v234, s62
  v_mov_b32 v235, s63
  v_mov_b32 v3, s72
  s_cmp_eq_u32 s60, 0
  s_cbranch_scc0 L_xc_1
  s_mov_b64 exec, 1
  buffer_store_dwordx4 v[232:235], v3, s[16:19], 0 offen sc1
  s_mov_b64 exec, -1
L_xc_1:
  s_mul_i32 s70, s60, 24576
  s_lshl_b32 s72, s59, 7
  s_add_u32 s70, s70, s72
  s_lshl_b32 s71, s60, 10
  s_waitcnt vmcnt(34)
  s_barrier
  ds_read_b128 v[64:67], v13 offset:0
  ds_read_b64_tr_b16 v[32:33], v17 offset:0
  ds_read_b64_tr_b16 v[34:35], v17 offset:512
  ds_read_b64_tr_b16 v[36:37], v17 offset:8192
  ds_read_b64_tr_b16 v[38:39], v17 offset:8704
  ds_read_b128 v[68:71], v14 offset:0
  ds_read_b64_tr_b16 v[40:41], v18 offset:0
  ds_read_b64_tr_b16 v[42:43], v18 offset:512
  ds_read_b64_tr_b16 v[44:45], v18 offset:8192
  ds_read_b64_tr_b16 v[46:47], v18 offset:8704
  s_waitcnt lgkmcnt(7)
  v_mfma_f32_32x32x16_bf16 v[192:207], v[32:35], v[64:67], 0
  ds_read_b128 v[72:75], v15 offset:0
  ds_read_b64_tr_b16 v[48:49], v17 offset:4096
  ds_read_b64_tr_b16 v[50:51], v17 offset:4608
  s_waitcnt lgkmcnt(8)
  v_mfma_f32_32x32x16_bf16 v[208:223], v[64:67], v[36:39], 0
  ds_read_b64_tr_b16 v[52:53], v17 offset:12288
  ds_read_b64_tr_b16 v[54:55], v17 offset:12800
  v_dot2c_f32_bf16 v24, s74, v32
  v_dot2c_f32_bf16 v25, s74, v36
  v_dot2c_f32_bf16 v24, s74, v33
  v_dot2c_f32_bf16 v25, s74, v37
  v_dot2c_f32_bf16 v24, s74, v34
  v_dot2c_f32_bf16 v25, s74, v38
  v_dot2c_f32_bf16 v24, s74, v35
  v_dot2c_f32_bf16 v25, s74, v39
  s_waitcnt lgkmcnt(7)
  v_mfma_f32_32x32x16_bf16 v[192:207], v[40:43], v[68:71], v[192:207]
  ds_read_b128 v[76:79], v16 offset:0
  ds_read_b64_tr_b16 v[32:33], v18 offset:4096
  ds_read_b64_tr_b16 v[34:35], v18 offset:4608
  s_waitcnt lgkmcnt(8)
  v_mfma_f32_32x32x16_bf16 v[208:223], v[68:71], v[44:47], v[208:223]
  ds_read_b64_tr_b16 v[36:37], v18 offset:12288
  ds_read_b64_tr_b16 v[38:39], v18 offset:12800
  s_waitcnt lgkmcnt(7)
  v_mfma_f32_32x32x16_bf16 v[192:207], v[48:51], v[72:75], v[192:207]
  s_waitcnt vmcnt(28)
  s_barrier
  ds_read_b128 v[80:83], v13 offset:8192
  ds_read_b64_tr_b16 v[40:41], v17 offset:16384
  ds_read_b64_tr_b16 v[42:43], v17 offset:16896
  s_waitcnt lgkmcnt(8)
  v_mfma_f32_32x32x16_bf16 v[208:223], v[72:75], v[52:55], v[208:223]
  ds_read_b64_tr_b16 v[44:45], v17 offset:24576
  ds_read_b64_tr_b16 v[46:47], v17 offset:25088
  v_dot2c_f32_bf16 v24, s74, v48
  v_dot2c_f32_bf16 v25, s74, v52
  v_dot2c_f32_bf16 v24, s74, v49
  v_dot2c_f32_bf16 v25, s74, v53
  v_dot2c_f32_bf16 v24, s74, v50
  v_dot2c_f32_bf16 v25, s74, v54
  v_dot2c_f32_bf16 v24, s74, v51
  v_dot2c_f32_bf16 v25, s74, v55
  s_waitcnt lgkmcnt(7)
  v_mfma_f32_32x32x16_bf16 v[192:207], v[32:35], v[76:79], v[192:207]
  ds_read_b128 v[84:87], v14 offset:8192
  ds_read_b64_tr_b16 v[48:49], v18 offset:16384
  ds_read_b64_tr_b16 v[50:51], v18 offset:16896
  s_waitcnt lgkmcnt(8)
  v_mfma_f32_32x32x16_bf16 v[208:223], v[76:79], v[36:39], v[208:223]
  ds_read_b64_tr_b16 v[52:53], v18 offset:24576
  ds_read_b64_tr_b16 v[54:55], v18 offset:25088
  s_waitcnt lgkmcnt(7)
  v_mfma_f32_32x32x16_bf16 v[192:207], v[40:43], v[80:83], v[192:207]
  ds_read_b128 v[88:91], v15 offset:8192
  ds_read_b64_tr_b16 v[32:33], v17 offset:20480
  ds_read_b64_tr_b16 v[34:35], v17 offset:20992
  s_waitcnt lgkmcnt(8)
  v_mfma_f32_32x32x16_bf16 v[208:223], v[80:83], v[44:47], v[208:223]
  ds_read_b64_tr_b16 v[36:37], v17 offset:28672
  ds_read_b64_tr_b16 v[38:39], v17 offset:29184
  v_dot2c_f32_bf16 v24, s74, v40
  v_dot2c_f32_bf16 v25, s74, v44
  v_dot2c_f32_bf16 v24, s74, v41
  v_dot2c_f32_bf16 v25, s74, v45
  v_dot2c_f32_bf16 v24, s74, v42
  v_dot2c_f32_bf16 v25, s74, v46
  v_dot2c_f32_bf16 v24, s74, v43
  v_dot2c_f32_bf16 v25, s74, v47
  s_waitcnt lgkmcnt(7)
  v_mfma_f32_32x32x16_bf16 v[192:207], v[48:51], v[84:87], v[192:207]
  ds_read_b128 v[92:95], v16 offset:8192
  ds_read_b64_tr_b16 v[40:41], v18 offset:20480
  ds_read_b64_tr_b16 v[42:43], v18 offset:20992
  s_waitcnt lgkmcnt(8)
  v_mfma_f32_32x32x16_bf16 v[208:223], v[84:87], v[52:55], v[208:223]
  ds_read_b64_tr_b16 v[44:45], v18 offset:28672
  ds_read_b64_tr_b16 v[46:47], v18 offset:29184
  s_waitcnt lgkmcnt(7)
  v_mfma_f32_32x32x16_bf16 v[192:207], v[32:35], v[88:91], v[192:207]
  s_waitcnt vmcnt(22)
  s_barrier
  ds_read_b128 v[96:99], v13 offset:16384
  ds_read_b64_tr_b16 v[48:49], v17 offset:32768
  ds_read_b64_tr_b16 v[50:51], v17 offset:33280
  s_waitcnt lgkmcnt(8)
  v_mfma_f32_32x32x16_bf16 v[208:223], v[88:91], v[36:39], v[208:223]
  ds_read_b64_tr_b16 v[52:53], v17 offset:40960
  ds_read_b64_tr_b16 v[54:55], v17 offset:41472
  s_add_u32 m0, s71, 65536
  s_add_u32 s72, s70, 984064
  buffer_load_dwordx4 v12, s[8:11], s72 offen lds
  v_dot2c_f32_bf16 v24, s74, v32
  v_dot2c_f32_bf16 v25, s74, v36
  v_dot2c_f32_bf16 v24, s74, v33
  v_dot2c_f32_bf16 v25, s74, v37
  v_dot2c_f32_bf16 v24, s74, v34
  v_dot2c_f32_bf16 v25, s74, v38
  v_dot2c_f32_bf16 v24, s74, v35
  v_dot2c_f32_bf16 v25, s74, v39
  s_waitcnt lgkmcnt(7)
  v_mfma_f32_32x32x16_bf16 v[192:207], v[40:43], v[92:95], v[192:207]
  ds_read_b128 v[100:103], v14 offset:16384
  ds_read_b64_tr_b16 v[32:33], v18 offset:32768
  ds_read_b64_tr_b16 v[34:35], v18 offset:33280
  s_waitcnt lgkmcnt(8)
  v_mfma_f32_32x32x16_bf16 v[208:223], v[92:95], v[44:47], v[208:223]
  ds_read_b64_tr_b16 v[36:37], v18 offset:40960
  ds_read_b64_tr_b16 v[38:39], v18 offset:41472
  s_add_u32 m0, s71, 69632
  s_add_u32 s72, s70, 1082368
  buffer_load_dwordx4 v12, s[8:11], s72 offen lds
  s_waitcnt lgkmcnt(7)
  v_mfma_f32_32x32x16_bf16 v[192:207], v[48:51], v[96:99], v[192:207]
  ds_read_b128 v[104:107], v15 offset:16384
  ds_read_b64_tr_b16 v[40:41], v17 offset:36864
  ds_read_b64_tr_b16 v[42:43], v17 offset:37376
  s_waitcnt lgkmcnt(8)
  v_mfma_f32_32x32x16_bf16 v[208:223], v[96:99], v[52:55], v[208:223]
  ds_read_b64_tr_b16 v[44:45], v17 offset:45056
  ds_read_b64_tr_b16 v[46:47], v17 offset:45568
  s_add_u32 m0, s71, 73728
  s_add_u32 s72, s70, 985088
  buffer_load_dwordx4 v12, s[8:11], s72 offen lds
  v_dot2c_f32_bf16 v24, s74, v48
  v_dot2c_f32_bf16 v25, s74, v52
  v_dot2c_f32_bf16 v24, s74, v49
  v_dot2c_f32_bf16 v25, s74, v53
  v_dot2c_f32_bf16 v24, s74, v50
  v_dot2c_f32_bf16 v25, s74, v54
  v_dot2c_f32_bf16 v24, s74, v51
  v_dot2c_f32_bf16 v25, s74, v55
  s_waitcnt lgkmcnt(7)
  v_mfma_f32_32x32x16_bf16 v[192:207], v[32:35], v[100:103], v[192:207]
  ds_read_b128 v[108:111], v16 offset:16384
  ds_read_b64_tr_b16 v[48:49], v18 offset:36864
  ds_read_b64_tr_b16 v[50:51], v18 offset:37376
  s_waitcnt lgkmcnt(8)
  v_mfma_f32_32x32x16_bf16 v[208:223], v[100:103], v[36:39], v[208:223]
  ds_read_b64_tr_b16 v[52:53], v18 offset:45056
  ds_read_b64_tr_b16 v[54:55], v18 offset:45568
  s_add_u32 m0, s71, 77824
  s_add_u32 s72, s70, 1083392
  buffer_load_dwordx4 v12, s[8:11], s72 offen lds
  s_waitcnt lgkmcnt(7)
  v_mfma_f32_32x32x16_bf16 v[192:207], v[40:43], v[104:107], v[192:207]
  s_waitcnt vmcnt(20)
  s_barrier
  ds_read_b128 v[112:115], v13 offset:24576
  ds_read_b64_tr_b16 v[32:33], v19 offset:0
  ds_read_b64_tr_b16 v[34:35], v19 offset:512
  s_waitcnt lgkmcnt(8)
  v_mfma_f32_32x32x16_bf16 v[208:223], v[104:107], v[44:47], v[208:223]
  ds_read_b64_tr_b16 v[36:37], v19 offset:8192
  ds_read_b64_tr_b16 v[38:39], v19 offset:8704
  s_add_u32 m0, s71, 81920
  s_add_u32 s72, s70, 1180672
  buffer_load_dwordx4 v12, s[8:11], s72 offen lds
  v_dot2c_f32_bf16 v24, s74, v40
  v_dot2c_f32_bf16 v25, s74, v44
  v_dot2c_f32_bf16 v24, s74, v41
  v_dot2c_f32_bf16 v25, s74, v45
  v_dot2c_f32_bf16 v24, s74, v42
  v_dot2c_f32_bf16 v25, s74, v46
  v_dot2c_f32_bf16 v24, s74, v43
  v_dot2c_f32_bf16 v25, s74, v47
  s_waitcnt lgkmcnt(7)
  v_mfma_f32_32x32x16_bf16 v[192:207], v[48:51], v[108:111], v[192:207]
  ds_read_b128 v[116:119], v14 offset:24576
  ds_read_b64_tr_b16 v[40:41], v20 offset:0
  ds_read_b64_tr_b16 v[42:43], v20 offset:512
  s_waitcnt lgkmcnt(8)
  v_mfma_f32_32x32x16_bf16 v[208:223], v[108:111], v[52:55], v[208:223]
  ds_read_b64_tr_b16 v[44:45], v20 offset:8192
  ds_read_b64_tr_b16 v[46:47], v20 offset:8704
  s_add_u32 m0, s71, 86016
  s_add_u32 s72, s70, 1278976
  buffer_load_dwordx4 v12, s[8:11], s72 offen lds
  s_waitcnt lgkmcnt(7)
  v_mfma_f32_32x32x16_bf16 v[192:207], v[32:35], v[112:115], v[192:207]
  ds_read_b128 v[120:123], v15 offset:24576
  ds_read_b64_tr_b16 v[48:49], v19 offset:4096
  ds_read_b64_tr_b16 v[50:51], v19 offset:4608
  s_waitcnt lgkmcnt(8)
  v_mfma_f32_32x32x16_bf16 v[208:223], v[112:115], v[36:39], v[208:223]
  ds_read_b64_tr_b16 v[52:53], v19 offset:12288
  ds_read_b64_tr_b16 v[54:55], v19 offset:12800
  s_add_u32 m0, s71, 90112
  s_add_u32 s72, s70, 1181696
  buffer_load_dwordx4 v12, s[8:11], s72 offen lds
  v_dot2c_f32_bf16 v24, s74, v32
  v_dot2c_f32_bf16 v25, s74, v36
  v_dot2c_f32_bf16 v24, s74, v33
  v_dot2c_f32_bf16 v25, s74, v37
  v_dot2c_f32_bf16 v24, s74, v34
  v_dot2c_f32_bf16 v25, s74, v38
  v_dot2c_f32_bf16 v24, s74, v35
  v_dot2c_f32_bf16 v25, s74, v39
  s_waitcnt lgkmcnt(7)
  v_mfma_f32_32x32x16_bf16 v[192:207], v[40:43], v[116:119], v[192:207]
  ds_read_b128 v[124:127], v16 offset:24576
  ds_read_b64_tr_b16 v[32:33], v20 offset:4096
  ds_read_b64_tr_b16 v[34:35], v20 offset:4608
  s_waitcnt lgkmcnt(8)
  v_mfma_f32_32x32x16_bf16 v[208:223], v[116:119], v[44:47], v[208:223]
  ds_read_b64_tr_b16 v[36:37], v20 offset:12288
  ds_read_b64_tr_b16 v[38:39], v20 offset:12800
  s_add_u32 m0, s71, 94208
  s_add_u32 s72, s70, 1280000
  buffer_load_dwordx4 v12, s[8:11], s72 offen lds
  s_waitcnt lgkmcnt(7)
  v_mfma_f32_32x32x16_bf16 v[192:207], v[48:51], v[120:123], v[192:207]
  s_waitcnt vmcnt(18)
  s_barrier
  ds_read_b128 v[128:131], v13 offset:32768
  ds_read_b64_tr_b16 v[40:41], v19 offset:16384
  ds_read_b64_tr_b16 v[42:43], v19 offset:16896
  s_waitcnt lgkmcnt(8)
  v_mfma_f32_32x32x16_bf16 v[208:223], v[120:123], v[52:55], v[208:223]
  ds_read_b64_tr_b16 v[44:45], v19 offset:24576
  ds_read_b64_tr_b16 v[46:47], v19 offset:25088
  s_add_u32 m0, s71, 98304
  s_add_u32 s72, s70, 1377280
  buffer_load_dwordx4 v12, s[8:11], s72 offen lds
  v_dot2c_f32_bf16 v24, s74, v48
  v_dot2c_f32_bf16 v25, s74, v52
  v_dot2c_f32_bf16 v24, s74, v49
  v_dot2c_f32_bf16 v25, s74, v53
  v_dot2c_f32_bf16 v24, s74, v50
  v_dot2c_f32_bf16 v25, s74, v54
  v_dot2c_f32_bf16 v24, s74, v51
  v_dot2c_f32_bf16 v25, s74, v55
  s_waitcnt lgkmcnt(7)
  v_mfma_f32_32x32x16_bf16 v[192:207], v[32:35], v[124:127], v[192:207]
  ds_read_b128 v[132:135], v14 offset:32768
  ds_read_b64_tr_b16 v[48:49], v20 offset:16384
  ds_read_b64_tr_b16 v[50:51], v20 offset:16896
  s_waitcnt lgkmcnt(8)
  v_mfma_f32_32x32x16_bf16 v[208:223], v[124:127], v[36:39], v[208:223]
  ds_read_b64_tr_b16 v[52:53], v20 offset:24576
  ds_read_b64_tr_b16 v[54:55], v20 offset:25088
  s_add_u32 m0, s71, 102400
  s_add_u32 s72, s70, 1475584
  buffer_load_dwordx4 v12, s[8:11], s72 offen lds
  s_waitcnt lgkmcnt(7)
  v_mfma_f32_32x32x16_bf16 v[192:207], v[40:43], v[128:131], v[192:207]
  ds_read_b128 v[136:139], v15 offset:32768
  ds_read_b64_tr_b16 v[32:33], v19 offset:20480
  ds_read_b64_tr_b16 v[34:35], v19 offset:20992
  s_waitcnt lgkmcnt(8)
  v_mfma_f32_32x32x16_bf16 v[208:223], v[128:131], v[44:47], v[208:223]
  ds_read_b64_tr_b16 v[36:37], v19 offset:28672
  ds_read_b64_tr_b16 v[38:39], v19 offset:29184
  s_add_u32 m0, s71, 106496
  s_add_u32 s72, s70, 1378304
  buffer_load_dwordx4 v12, s[8:11], s72 offen lds
  v_dot2c_f32_bf16 v24, s74, v40
  v_dot2c_f32_bf16 v25, s74, v44
  v_dot2c_f32_bf16 v24, s74, v41
  v_dot2c_f32_bf16 v25, s74, v45
  v_dot2c_f32_bf16 v24, s74, v42
  v_dot2c_f32_bf16 v25, s74, v46
  v_dot2c_f32_bf16 v24, s74, v43
  v_dot2c_f32_bf16 v25, s74, v47
  s_waitcnt lgkmcnt(7)
  v_mfma_f32_32x32x16_bf16 v[192:207], v[48:51], v[132:135], v[192:207]
  ds_read_b128 v[140:143], v16 offset:32768
  ds_read_b64_tr_b16 v[40:41], v20 offset:20480
  ds_read_b64_tr_b16 v[42:43], v20 offset:20992
  s_waitcnt lgkmcnt(8)
  v_mfma_f32_32x32x16_bf16 v[208:223], v[132:135], v[52:55], v[208:223]
  ds_read_b64_tr_b16 v[44:45], v20 offset:28672
  ds_read_b64_tr_b16 v[46:47], v20 offset:29184
  s_add_u32 m0, s71, 110592
  s_add_u32 s72, s70, 1476608
  buffer_load_dwordx4 v12, s[8:11], s72 offen lds
  s_waitcnt lgkmcnt(7)
  v_mfma_f32_32x32x16_bf16 v[192:207], v[32:35], v[136:139], v[192:207]
  s_waitcnt vmcnt(8)
  s_barrier
  ds_read_b128 v[144:147], v13 offset:40960
  ds_read_b64_tr_b16 v[48:49], v17 offset:0
  ds_read_b64_tr_b16 v[50:51], v17 offset:512
  s_waitcnt lgkmcnt(8)
  v_mfma_f32_32x32x16_bf16 v[208:223], v[136:139], v[36:39], v[208:223]
  ds_read_b64_tr_b16 v[52:53], v17 offset:8192
  ds_read_b64_tr_b16 v[54:55], v17 offset:8704
  s_add_u32 m0, s71, 114688
  s_add_u32 s72, s70, 0
  buffer_load_dwordx4 v12, s[8:11], s72 offen lds
  v_dot2c_f32_bf16 v24, s74, v32
  v_dot2c_f32_bf16 v25, s74, v36
  v_dot2c_f32_bf16 v24, s74, v33
  v_dot2c_f32_bf16 v25, s74, v37
  v_dot2c_f32_bf16 v24, s74, v34
  v_dot2c_f32_bf16 v25, s74, v38
  v_dot2c_f32_bf16 v24, s74, v35
  v_dot2c_f32_bf16 v25, s74, v39
  s_waitcnt lgkmcnt(7)
  v_mfma_f32_32x32x16_bf16 v[192:207], v[40:43], v[140:143], v[192:207]
  ds_read_b128 v[148:151], v14 offset:40960
  ds_read_b64_tr_b16 v[32:33], v18 offset:0
  ds_read_b64_tr_b16 v[34:35], v18 offset:512
  s_waitcnt lgkmcnt(8)
  v_mfma_f32_32x32x16_bf16 v[208:223], v[140:143], v[44:47], v[208:223]
  ds_read_b64_tr_b16 v[36:37], v18 offset:8192
  ds_read_b64_tr_b16 v[38:39], v18 offset:8704
  s_add_u32 m0, s71, 118784
  s_add_u32 s72, s70, 98304
  buffer_load_dwordx4 v12, s[8:11], s72 offen lds
  s_waitcnt lgkmcnt(7)
  v_mfma_f32_32x32x16_bf16 v[192:207], v[48:51], v[144:147], v[192:207]
  ds_read_b128 v[152:155], v15 offset:40960
  ds_read_b64_tr_b16 v[40:41], v17 offset:4096
  ds_read_b64_tr_b16 v[42:43], v17 offset:4608
  s_waitcnt lgkmcnt(8)
  v_mfma_f32_32x32x16_bf16 v[208:223], v[144:147], v[52:55], v[208:223]
  ds_read_b64_tr_b16 v[44:45], v17 offset:12288
  ds_read_b64_tr_b16 v[46:47], v17 offset:12800
  s_add_u32 m0, s71, 122880
  s_add_u32 s72, s70, 196608
  buffer_load_dwordx4 v12, s[8:11], s72 offen lds
  v_dot2c_f32_bf16 v24, s74, v48
  v_dot2c_f32_bf16 v25, s74, v52
  v_dot2c_f32_bf16 v24, s74, v49
  v_dot2c_f32_bf16 v25, s74, v53
  v_dot2c_f32_bf16 v24, s74, v50
  v_dot2c_f32_bf16 v25, s74, v54
  v_dot2c_f32_bf16 v24, s74, v51
  v_dot2c_f32_bf16 v25, s74, v55
  s_waitcnt lgkmcnt(7)
  v_mfma_f32_32x32x16_bf16 v[192:207], v[32:35], v[148:151], v[192:207]
  ds_read_b128 v[156:159], v16 offset:40960
  ds_read_b64_tr_b16 v[48:49], v18 offset:4096
  ds_read_b64_tr_b16 v[50:51], v18 offset:4608
  s_waitcnt lgkmcnt(8)
  v_mfma_f32_32x32x16_bf16 v[208:223], v[148:151], v[36:39], v[208:223]
  ds_read_b64_tr_b16 v[52:53], v18 offset:12288
  ds_read_b64_tr_b16 v[54:55], v18 offset:12800
  s_add_u32 m0, s71, 126976
  s_add_u32 s72, s70, 294912
  buffer_load_dwordx4 v12, s[8:11], s72 offen lds
  s_waitcnt lgkmcnt(7)
  v_mfma_f32_32x32x16_bf16 v[192:207], v[40:43], v[152:155], v[192:207]
  s_waitcnt vmcnt(8)
  s_barrier
  ds_read_b128 v[160:163], v13 offset:49152
  ds_read_b64_tr_b16 v[32:33], v17 offset:16384
  ds_read_b64_tr_b16 v[34:35], v17 offset:16896
  s_waitcnt lgkmcnt(8)
  v_mfma_f32_32x32x16_bf16 v[208:223], v[152:155], v[44:47], v[208:223]
  ds_read_b64_tr_b16 v[36:37], v17 offset:24576
  ds_read_b64_tr_b16 v[38:39], v17 offset:25088
  s_add_u32 m0, s71, 131072
  s_add_u32 s72, s70, 393216
  buffer_load_dwordx4 v12, s[8:11], s72 offen lds
  v_dot2c_f32_bf16 v24, s74, v40
  v_dot2c_f32_bf16 v25, s74, v44
  v_dot2c_f32_bf16 v24, s74, v41
  v_dot2c_f32_bf16 v25, s74, v45
  v_dot2c_f32_bf16 v24, s74, v42
  v_dot2c_f32_bf16 v25, s74, v46
  v_dot2c_f32_bf16 v24, s74, v43
  v_dot2c_f32_bf16 v25, s74, v47
  s_waitcnt lgkmcnt(7)
  v_mfma_f32_32x32x16_bf16 v[192:207], v[48:51], v[156:159], v[192:207]
  ds_read_b128 v[164:167], v14 offset:49152
  ds_read_b64_tr_b16 v[40:41], v18 offset:16384
  ds_read_b64_tr_b16 v[42:43], v18 offset:16896
  s_waitcnt lgkmcnt(8)
  v_mfma_f32_32x32x16_bf16 v[208:223], v[156:159], v[52:55], v[208:223]
  ds_read_b64_tr_b16 v[44:45], v18 offset:24576
  ds_read_b64_tr_b16 v[46:47], v18 offset:25088
  s_add_u32 m0, s71, 135168
  s_add_u32 s72, s70, 491520
  buffer_load_dwordx4 v12, s[8:11], s72 offen lds
  s_waitcnt lgkmcnt(7)
  v_mfma_f32_32x32x16_bf16 v[192:207], v[32:35], v[160:163], v[192:207]
  ds_read_b128 v[168:171], v15 offset:49152
  ds_read_b64_tr_b16 v[48:49], v17 offset:20480
  ds_read_b64_tr_b16 v[50:51], v17 offset:20992
  s_waitcnt lgkmcnt(8)
  v_mfma_f32_32x32x16_bf16 v[208:223], v[160:163], v[36:39], v[208:223]
  ds_read_b64_tr_b16 v[52:53], v17 offset:28672
  ds_read_b64_tr_b16 v[54:55], v17 offset:29184
  s_add_u32 m0, s71, 139264
  s_add_u32 s72, s70, 589824
  buffer_load_dwordx4 v12, s[8:11], s72 offen lds
  buffer_load_dwordx4 v[240:243], v61, s[16:19], s75 offen offset:0 sc1
  buffer_load_dwordx4 v[244:247], v61, s[16:19], s75 offen offset:1024 sc1
  buffer_load_dwordx4 v[248:251], v61, s[16:19], s75 offen offset:2048 sc1
  buffer_load_dwordx4 v[252:255], v61, s[16:19], s75 offen offset:3072 sc1
  v_dot2c_f32_bf16 v24, s74, v32
  v_dot2c_f32_bf16 v25, s74, v36
  v_dot2c_f32_bf16 v24, s74, v33
  v_dot2c_f32_bf16 v25, s74, v37
  v_dot2c_f32_bf16 v24, s74, v34
  v_dot2c_f32_bf16 v25, s74, v38
  v_dot2c_f32_bf16 v24, s74, v35
  v_dot2c_f32_bf16 v25, s74, v39
  s_waitcnt lgkmcnt(7)
  v_mfma_f32_32x32x16_bf16 v[192:207], v[40:43], v[164:167], v[192:207]
  ds_read_b128 v[172:175], v16 offset:49152
  ds_read_b64_tr_b16 v[32:33], v18 offset:20480
  ds_read_b64_tr_b16 v[34:35], v18 offset:20992
  s_waitcnt lgkmcnt(8)
  v_mfma_f32_32x32x16_bf16 v[208:223], v[164:167], v[44:47], v[208:223]
  ds_read_b64_tr_b16 v[36:37], v18 offset:28672
  ds_read_b64_tr_b16 v[38:39], v18 offset:29184
  s_add_u32 m0, s71, 143360
  s_add_u32 s72, s70, 688128
  buffer_load_dwordx4 v12, s[8:11], s72 offen lds
  s_waitcnt lgkmcnt(7)
  v_mfma_f32_32x32x16_bf16 v[192:207], v[48:51], v[168:171], v[192:207]
  s_waitcnt vmcnt(12)
  s_barrier
  ds_read_b128 v[176:179], v13 offset:57344
  ds_read_b64_tr_b16 v[40:41], v17 offset:32768
  ds_read_b64_tr_b16 v[42:43], v17 offset:33280
  s_waitcnt lgkmcnt(8)
  v_mfma_f32_32x32x16_bf16 v[208:223], v[168:171], v[52:55], v[208:223]
  ds_read_b64_tr_b16 v[44:45], v17 offset:40960
  ds_read_b64_tr_b16 v[46:47], v17 offset:41472
  s_add_u32 m0, s71, 65536
  s_add_u32 s72, s70, 786432
  buffer_load_dwordx4 v12, s[8:11], s72 offen lds
  v_dot2c_f32_bf16 v24, s74, v48
  v_dot2c_f32_bf16 v25, s74, v52
  v_dot2c_f32_bf16 v24, s74, v49
  v_dot2c_f32_bf16 v25, s74, v53
  v_dot2c_f32_bf16 v24, s74, v50
  v_dot2c_f32_bf16 v25, s74, v54
  v_dot2c_f32_bf16 v24, s74, v51
  v_dot2c_f32_bf16 v25, s74, v55
  s_waitcnt lgkmcnt(7)
  v_mfma_f32_32x32x16_bf16 v[192:207], v[32:35], v[172:175], v[192:207]
  ds_read_b128 v[180:183], v14 offset:57344
  ds_read_b64_tr_b16 v[48:49], v18 offset:32768
  ds_read_b64_tr_b16 v[50:51], v18 offset:33280
  s_waitcnt lgkmcnt(8)
  v_mfma_f32_32x32x16_bf16 v[208:223], v[172:175], v[36:39], v[208:223]
  ds_read_b64_tr_b16 v[52:53], v18 offset:40960
  ds_read_b64_tr_b16 v[54:55], v18 offset:41472
  s_add_u32 m0, s71, 69632
  s_add_u32 s72, s70, 884736
  buffer_load_dwordx4 v12, s[8:11], s72 offen lds
  s_waitcnt lgkmcnt(7)
  v_mfma_f32_32x32x16_bf16 v[192:207], v[40:43], v[176:179], v[192:207]
  ds_read_b128 v[184:187], v15 offset:57344
  ds_read_b64_tr_b16 v[32:33], v17 offset:36864
  ds_read_b64_tr_b16 v[34:35], v17 offset:37376
  s_waitcnt lgkmcnt(8)
  v_mfma_f32_32x32x16_bf16 v[208:223], v[176:179], v[44:47], v[208:223]
  ds_read_b64_tr_b16 v[36:37], v17 offset:45056
  ds_read_b64_tr_b16 v[38:39], v17 offset:45568
  s_add_u32 m0, s71, 73728
  s_add_u32 s72, s70, 983040
  buffer_load_dwordx4 v12, s[8:11], s72 offen lds
  v_dot2c_f32_bf16 v24, s74, v40
  v_dot2c_f32_bf16 v25, s74, v44
  v_dot2c_f32_bf16 v24, s74, v41
  v_dot2c_f32_bf16 v25, s74, v45
  v_dot2c_f32_bf16 v24, s74, v42
  v_dot2c_f32_bf16 v25, s74, v46
  v_dot2c_f32_bf16 v24, s74, v43
  v_dot2c_f32_bf16 v25, s74, v47
  s_waitcnt lgkmcnt(7)
  v_mfma_f32_32x32x16_bf16 v[192:207], v[48:51], v[180:183], v[192:207]
  ds_read_b128 v[188:191], v16 offset:57344
  ds_read_b64_tr_b16 v[40:41], v18 offset:36864
  ds_read_b64_tr_b16 v[42:43], v18 offset:37376
  s_waitcnt lgkmcnt(8)
  v_mfma_f32_32x32x16_bf16 v[208:223], v[180:183], v[52:55], v[208:223]
  ds_read_b64_tr_b16 v[44:45], v18 offset:45056
  ds_read_b64_tr_b16 v[46:47], v18 offset:45568
  s_add_u32 m0, s71, 77824
  s_add_u32 s72, s70, 1081344
  buffer_load_dwordx4 v12, s[8:11], s72 offen lds
  s_waitcnt lgkmcnt(7)
  v_mfma_f32_32x32x16_bf16 v[192:207], v[32:35], v[184:187], v[192:207]
  s_waitcnt lgkmcnt(5)
  v_mfma_f32_32x32x16_bf16 v[208:223], v[184:187], v[36:39], v[208:223]
  v_dot2c_f32_bf16 v24, s74, v32
  v_dot2c_f32_bf16 v25, s74, v36
  v_dot2c_f32_bf16 v24, s74, v33
  v_dot2c_f32_bf16 v25, s74, v37
  v_dot2c_f32_bf16 v24, s74, v34
  v_dot2c_f32_bf16 v25, s74, v38
  v_dot2c_f32_bf16 v24, s74, v35
  v_dot2c_f32_bf16 v25, s74, v39
  s_waitcnt lgkmcnt(2)
  v_mfma_f32_32x32x16_bf16 v[192:207], v[40:43], v[188:191], v[192:207]
  s_waitcnt lgkmcnt(0)
  v_mfma_f32_32x32x16_bf16 v[208:223], v[188:191], v[44:47], v[208:223]
  v_and_b32 v3, 31, v1
  s_lshl_b32 s72, s67, 1
  s_add_u32 s72, s72, s68
  s_mul_i32 s72, s72, 384
  s_add_u32 s72, s72, 157696
  v_lshl_add_u32 v9, v3, 2, s72
  v_mov_b32 v26, v24
  v_mov_b32 v27, v25
  s_nop 0
  v_permlane32_swap_b32 v24, v26
  v_permlane32_swap_b32 v25, v27
  v_add_f32 v24, v24, v26
  v_add_f32 v25, v25, v27
  ds_write_b32 v9, v24
  ds_write_b32 v9, v25 offset:128
  s_waitcnt lgkmcnt(0)
  s_barrier
  s_mov_b32 s100, 0
L_s2p_2:
  s_waitcnt vmcnt(8)
  v_cmp_ne_u64 vcc, s[62:63], v[242:243]
  s_waitcnt vmcnt(7)
  v_cmp_ne_u64 s[72:73], s[62:63], v[246:247]
  s_or_b64 vcc, vcc, s[72:73]
  s_waitcnt vmcnt(6)
  v_cmp_ne_u64 s[72:73], s[62:63], v[250:251]
  s_or_b64 vcc, vcc, s[72:73]
  s_waitcnt vmcnt(5)
  v_cmp_ne_u64 s[72:73], s[62:63], v[254:255]
  s_or_b64 vcc, vcc, s[72:73]
  s_cbranch_vccz L_s2o_3
  buffer_load_dwordx4 v[240:243], v61, s[16:19], s75 offen offset:0 sc1
  buffer_load_dwordx4 v[244:247], v61, s[16:19], s75 offen offset:1024 sc1
  buffer_load_dwordx4 v[248:251], v61, s[16:19], s75 offen offset:2048 sc1
  buffer_load_dwordx4 v[252:255], v61, s[16:19], s75 offen offset:3072 sc1
  s_waitcnt vmcnt(0)
  s_add_u32 s100, s100, 1
  s_cmp_lt_u32 s100, 400000
  s_cbranch_scc1 L_s2p_2
  s_branch L_fail
L_s2o_3:
  v_add_f32 v26, v240, v244
  v_add_f32 v27, v241, v245
  v_add_f32 v28, v248, v252
  v_add_f32 v29, v249, v253
  v_add_f32 v26, v26, v28
  v_add_f32 v27, v27, v29
  v_mov_b32 v28, v26
  v_mov_b32 v29, v27
  s_nop 0
  v_permlane32_swap_b32 v26, v28
  v_permlane32_swap_b32 v27, v29
  v_add_f32 v26, v26, v28
  v_add_f32 v27, v27, v29
  v_mul_f32 v26, 0x3b000000, v26
  v_mul_f32 v27, 0x3b000000, v27
  v_fma_f32 v27, -v26, v26, v27
  v_max_f32 v27, 0, v27
  v_add_f32 v27, 0x3727c5ac, v27
  v_rsq_f32 v27, v27
  s_mul_i32 s72, s67, 768
  s_add_u32 s72, s72, 157696
  v_lshrrev_b32 v5, 5, v1
  v_lshl_add_u32 v56, v5, 4, s72
  ds_read_b128 v[240:243], v56 offset:0
  ds_read_b128 v[244:247], v56 offset:32
  ds_read_b128 v[248:251], v56 offset:64
  ds_read_b128 v[252:255], v56 offset:96
  ds_read_b128 v[32:35], v56 offset:384
  ds_read_b128 v[36:39], v56 offset:416
  ds_read_b128 v[40:43], v56 offset:448
  ds_read_b128 v[44:47], v56 offset:480
  v_lshl_add_u32 v57, v3, 2, s72
  ds_read_b32 v58, v57 offset:128
  ds_read_b32 v59, v57 offset:512
  s_lshl_b32 s72, s60, 8
  s_add_u32 s72, s72, 159232
  v_lshl_add_u32 v4, v3, 2, s72
  ds_write_b32 v4, v26
  ds_write_b32 v4, v27 offset:128
  s_waitcnt lgkmcnt(7)
  v_add_f32 v240, v240, v32
  v_add_f32 v241, v241, v33
  v_add_f32 v242, v242, v34
  v_add_f32 v243, v243, v35
  s_waitcnt lgkmcnt(6)
  v_add_f32 v244, v244, v36
  v_add_f32 v245, v245, v37
  v_add_f32 v246, v246, v38
  v_add_f32 v247, v247, v39
  s_waitcnt lgkmcnt(5)
  v_add_f32 v248, v248, v40
  v_add_f32 v249, v249, v41
  v_add_f32 v250, v250, v42
  v_add_f32 v251, v251, v43
  s_waitcnt lgkmcnt(4)
  v_add_f32 v252, v252, v44
  v_add_f32 v253, v253, v45
  v_add_f32 v254, v254, v46
  v_add_f32 v255, v255, v47
  s_waitcnt lgkmcnt(2)
  v_add_f32 v58, v58, v59
  v_lshl_add_u32 v4, v5, 4, s72
  s_waitcnt lgkmcnt(0)
  ds_read_b128 v[32:35], v4 offset:0
  ds_read_b128 v[36:39], v4 offset:32
  ds_read_b128 v[40:43], v4 offset:64
  ds_read_b128 v[44:47], v4 offset:96
  ds_read_b128 v[48:51], v4 offset:128
  ds_read_b128 v[52:55], v4 offset:160
  v_fma_f32 v192, -v26, v240, v192
  v_fma_f32 v193, -v26, v241, v193
  v_fma_f32 v194, -v26, v242, v194
  v_fma_f32 v195, -v26, v243, v195
  v_fma_f32 v196, -v26, v244, v196
  v_fma_f32 v197, -v26, v245, v197
  v_fma_f32 v198, -v26, v246, v198
  v_fma_f32 v199, -v26, v247, v199
  v_fma_f32 v200, -v26, v248, v200
  v_fma_f32 v201, -v26, v249, v201
  v_fma_f32 v202, -v26, v250, v202
  v_fma_f32 v203, -v26, v251, v203
  v_fma_f32 v204, -v26, v252, v204
  v_fma_f32 v205, -v26, v253, v205
  v_fma_f32 v206, -v26, v254, v206
  v_fma_f32 v207, -v26, v255, v207
  v_mul_f32 v192, v27, v192
  v_mul_f32 v193, v27, v193
  v_mul_f32 v194, v27, v194
  v_mul_f32 v195, v27, v195
  v_mul_f32 v196, v27, v196
  v_mul_f32 v197, v27, v197
  v_mul_f32 v198, v27, v198
  v_mul_f32 v199, v27, v199
  v_mul_f32 v200, v27, v200
  v_mul_f32 v201, v27, v201
  v_mul_f32 v202, v27, v202
  v_mul_f32 v203, v27, v203
  v_mul_f32 v204, v27, v204
  v_mul_f32 v205, v27, v205
  v_mul_f32 v206, v27, v206
  v_mul_f32 v207, v27, v207
  v_cvt_pk_bf16_f32 v192, v192, v193
  v_cvt_pk_bf16_f32 v193, v194, v195
  v_cvt_pk_bf16_f32 v194, v196, v197
  v_cvt_pk_bf16_f32 v195, v198, v199
  v_cvt_pk_bf16_f32 v196, v200, v201
  v_cvt_pk_bf16_f32 v197, v202, v203
  v_cvt_pk_bf16_f32 v198, v204, v205
  v_cvt_pk_bf16_f32 v199, v206, v207
  s_lshl_b32 s75, s59, 1
  s_add_u32 s75, s75, s67
  s_lshl_b32 s75, s75, 6
  s_lshl_b32 s76, s58, 1
  s_add_u32 s75, s75, s76
  s_add_u32 s75, s75, s68
  s_lshl_b32 s75, s75, 12
  s_lshl_b32 s76, s61, 22
  s_add_u32 s75, s75, s76
  s_add_u32 s75, s75, 1048576
  buffer_store_dwordx4 v[192:195], v2, s[16:19], s75 offen sc1
  buffer_store_dwordx4 v[196:199], v2, s[16:19], s75 offen offset:2048 sc1
  ds_read_b128 v[248:251], v4 offset:192
  ds_read_b128 v[252:255], v4 offset:224
  s_waitcnt lgkmcnt(7)
  v_fma_f32 v208, -v32, v58, v208
  v_fma_f32 v209, -v33, v58, v209
  v_fma_f32 v210, -v34, v58, v210
  v_fma_f32 v211, -v35, v58, v211
  s_waitcnt lgkmcnt(6)
  v_fma_f32 v212, -v36, v58, v212
  v_fma_f32 v213, -v37, v58, v213
  v_fma_f32 v214, -v38, v58, v214
  v_fma_f32 v215, -v39, v58, v215
  s_waitcnt lgkmcnt(5)
  v_fma_f32 v216, -v40, v58, v216
  v_fma_f32 v217, -v41, v58, v217
  v_fma_f32 v218, -v42, v58, v218
  v_fma_f32 v219, -v43, v58, v219
  s_waitcnt lgkmcnt(4)
  v_fma_f32 v220, -v44, v58, v220
  v_fma_f32 v221, -v45, v58, v221
  v_fma_f32 v222, -v46, v58, v222
  v_fma_f32 v223, -v47, v58, v223
  s_waitcnt lgkmcnt(3)
  v_mul_f32 v208, v48, v208
  v_mul_f32 v209, v49, v209
  v_mul_f32 v210, v50, v210
  v_mul_f32 v211, v51, v211
  s_waitcnt lgkmcnt(2)
  v_mul_f32 v212, v52, v212
  v_mul_f32 v213, v53, v213
  v_mul_f32 v214, v54, v214
  v_mul_f32 v215, v55, v215
  s_waitcnt lgkmcnt(1)
  v_mul_f32 v216, v248, v216
  v_mul_f32 v217, v249, v217
  v_mul_f32 v218, v250, v218
  v_mul_f32 v219, v251, v219
  s_waitcnt lgkmcnt(0)
  v_mul_f32 v220, v252, v220
  v_mul_f32 v221, v253, v221
  v_mul_f32 v222, v254, v222
  v_mul_f32 v223, v255, v223
  v_cvt_pk_bf16_f32 v208, v208, v209
  v_cvt_pk_bf16_f32 v209, v210, v211
  v_cvt_pk_bf16_f32 v210, v212, v213
  v_cvt_pk_bf16_f32 v211, v214, v215
  v_cvt_pk_bf16_f32 v212, v216, v217
  v_cvt_pk_bf16_f32 v213, v218, v219
  v_cvt_pk_bf16_f32 v214, v220, v221
  v_cvt_pk_bf16_f32 v215, v222, v223
  v_bfe_u32 v3, v1, 4, 1
  v_lshlrev_b32 v3, 11, v3
  v_lshrrev_b32 v5, 5, v1
  v_lshl_add_u32 v3, v5, 8, v3
  v_and_b32 v5, 15, v1
  v_lshl_add_u32 v3, v5, 4, v3
  buffer_store_dwordx4 v[208:211], v3, s[16:19], s75 offen offset:1024 sc1
  buffer_store_dwordx4 v[212:215], v3, s[16:19], s75 offen offset:1536 sc1
  s_mul_i32 s70, s60, 24576
  s_lshl_b32 s72, s59, 7
  s_add_u32 s70, s70, s72
  s_lshl_b32 s71, s60, 10
  s_barrier
  ds_read_b64_tr_b16 v[32:33], v19 offset:0
  ds_read_b64_tr_b16 v[34:35], v19 offset:512
  ds_read_b64_tr_b16 v[40:41], v20 offset:0
  ds_read_b64_tr_b16 v[42:43], v20 offset:512
  s_waitcnt lgkmcnt(2)
  v_mfma_f32_32x32x16_bf16 v[224:239], v[32:35], v[64:67], 0
  ds_read_b64_tr_b16 v[48:49], v19 offset:4096
  ds_read_b64_tr_b16 v[50:51], v19 offset:4608
  s_add_u32 m0, s71, 81920
  s_add_u32 s72, s70, 1179648
  buffer_load_dwordx4 v12, s[8:11], s72 offen lds
  v_dot2c_f32_bf16 v21, s74, v32
  v_dot2c_f32_bf16 v21, s74, v33
  v_dot2c_f32_bf16 v21, s74, v34
  v_dot2c_f32_bf16 v21, s74, v35
  s_waitcnt lgkmcnt(2)
  v_mfma_f32_32x32x16_bf16 v[224:239], v[40:43], v[68:71], v[224:239]
  ds_read_b64_tr_b16 v[32:33], v20 offset:4096
  ds_read_b64_tr_b16 v[34:35], v20 offset:4608
  s_add_u32 m0, s71, 86016
  s_add_u32 s72, s70, 1277952
  buffer_load_dwordx4 v12, s[8:11], s72 offen lds
  s_waitcnt lgkmcnt(2)
  v_mfma_f32_32x32x16_bf16 v[224:239], v[48:51], v[72:75], v[224:239]
  ds_read_b64_tr_b16 v[40:41], v19 offset:8192
  ds_read_b64_tr_b16 v[42:43], v19 offset:8704
  s_add_u32 m0, s71, 90112
  s_add_u32 s72, s70, 1376256
  buffer_load_dwordx4 v12, s[8:11], s72 offen lds
  v_dot2c_f32_bf16 v21, s74, v48
  v_dot2c_f32_bf16 v21, s74, v49
  v_dot2c_f32_bf16 v21, s74, v50
  v_dot2c_f32_bf16 v21, s74, v51
  s_waitcnt lgkmcnt(2)
  v_mfma_f32_32x32x16_bf16 v[224:239], v[32:35], v[76:79], v[224:239]
  ds_read_b64_tr_b16 v[48:49], v20 offset:8192
  ds_read_b64_tr_b16 v[50:51], v20 offset:8704
  s_add_u32 m0, s71, 94208
  s_add_u32 s72, s70, 1474560
  buffer_load_dwordx4 v12, s[8:11], s72 offen lds
  s_waitcnt lgkmcnt(2)
  v_mfma_f32_32x32x16_bf16 v[224:239], v[40:43], v[80:83], v[224:239]
  ds_read_b64_tr_b16 v[32:33], v19 offset:12288
  ds_read_b64_tr_b16 v[34:35], v19 offset:12800
  v_dot2c_f32_bf16 v21, s74, v40
  v_dot2c_f32_bf16 v21, s74, v41
  v_dot2c_f32_bf16 v21, s74, v42
  v_dot2c_f32_bf16 v21, s74, v43
  s_waitcnt lgkmcnt(2)
  v_mfma_f32_32x32x16_bf16 v[224:239], v[48:51], v[84:87], v[224:239]
  ds_read_b64_tr_b16 v[40:41], v20 offset:12288
  ds_read_b64_tr_b16 v[42:43], v20 offset:12800
  s_waitcnt lgkmcnt(2)
  v_mfma_f32_32x32x16_bf16 v[224:239], v[32:35], v[88:91], v[224:239]
  s_waitcnt vmcnt(12)
  s_barrier
  ds_read_b64_tr_b16 v[48:49], v19 offset:16384
  ds_read_b64_tr_b16 v[50:51], v19 offset:16896
  v_dot2c_f32_bf16 v21, s74, v32
  v_dot2c_f32_bf16 v21, s74, v33
  v_dot2c_f32_bf16 v21, s74, v34
  v_dot2c_f32_bf16 v21, s74, v35
  s_waitcnt lgkmcnt(2)
  v_mfma_f32_32x32x16_bf16 v[224:239], v[40:43], v[92:95], v[224:239]
  ds_read_b64_tr_b16 v[32:33], v20 offset:16384
  ds_read_b64_tr_b16 v[34:35], v20 offset:16896
  s_waitcnt lgkmcnt(2)
  v_mfma_f32_32x32x16_bf16 v[224:239], v[48:51], v[96:99], v[224:239]
  ds_read_b64_tr_b16 v[40:41], v19 offset:20480
  ds_read_b64_tr_b16 v[42:43], v19 offset:20992
  v_dot2c_f32_bf16 v21, s74, v48
  v_dot2c_f32_bf16 v21, s74, v49
  v_dot2c_f32_bf16 v21, s74, v50
  v_dot2c_f32_bf16 v21, s74, v51
  s_waitcnt lgkmcnt(2)
  v_mfma_f32_32x32x16_bf16 v[224:239], v[32:35], v[100:103], v[224:239]
  ds_read_b64_tr_b16 v[48:49], v20 offset:20480
  ds_read_b64_tr_b16 v[50:51], v20 offset:20992
  s_waitcnt lgkmcnt(2)
  v_mfma_f32_32x32x16_bf16 v[224:239], v[40:43], v[104:107], v[224:239]
  ds_read_b64_tr_b16 v[32:33], v19 offset:24576
  ds_read_b64_tr_b16 v[34:35], v19 offset:25088
  v_dot2c_f32_bf16 v21, s74, v40
  v_dot2c_f32_bf16 v21, s74, v41
  v_dot2c_f32_bf16 v21, s74, v42
  v_dot2c_f32_bf16 v21, s74, v43
  s_waitcnt lgkmcnt(2)
  v_mfma_f32_32x32x16_bf16 v[224:239], v[48:51], v[108:111], v[224:239]
  ds_read_b64_tr_b16 v[40:41], v20 offset:24576
  ds_read_b64_tr_b16 v[42:43], v20 offset:25088
  s_waitcnt lgkmcnt(2)
  v_mfma_f32_32x32x16_bf16 v[224:239], v[32:35], v[112:115], v[224:239]
  ds_read_b64_tr_b16 v[48:49], v19 offset:28672
  ds_read_b64_tr_b16 v[50:51], v19 offset:29184
  v_dot2c_f32_bf16 v21, s74, v32
  v_dot2c_f32_bf16 v21, s74, v33
  v_dot2c_f32_bf16 v21, s74, v34
  v_dot2c_f32_bf16 v21, s74, v35
  s_waitcnt lgkmcnt(2)
  v_mfma_f32_32x32x16_bf16 v[224:239], v[40:43], v[116:119], v[224:239]
  ds_read_b64_tr_b16 v[32:33], v20 offset:28672
  ds_read_b64_tr_b16 v[34:35], v20 offset:29184
  s_waitcnt lgkmcnt(2)
  v_mfma_f32_32x32x16_bf16 v[224:239], v[48:51], v[120:123], v[224:239]
  s_waitcnt vmcnt(8)
  s_barrier
  ds_read_b64_tr_b16 v[40:41], v17 offset:0
  ds_read_b64_tr_b16 v[42:43], v17 offset:512
  v_dot2c_f32_bf16 v21, s74, v48
  v_dot2c_f32_bf16 v21, s74, v49
  v_dot2c_f32_bf16 v21, s74, v50
  v_dot2c_f32_bf16 v21, s74, v51
  s_waitcnt lgkmcnt(2)
  v_mfma_f32_32x32x16_bf16 v[224:239], v[32:35], v[124:127], v[224:239]
  ds_read_b64_tr_b16 v[48:49], v18 offset:0
  ds_read_b64_tr_b16 v[50:51], v18 offset:512
  s_waitcnt lgkmcnt(2)
  v_mfma_f32_32x32x16_bf16 v[224:239], v[40:43], v[128:131], v[224:239]
  ds_read_b64_tr_b16 v[32:33], v17 offset:4096
  ds_read_b64_tr_b16 v[34:35], v17 offset:4608
  v_dot2c_f32_bf16 v21, s74, v40
  v_dot2c_f32_bf16 v21, s74, v41
  v_dot2c_f32_bf16 v21, s74, v42
  v_dot2c_f32_bf16 v21, s74, v43
  s_waitcnt lgkmcnt(2)
  v_mfma_f32_32x32x16_bf16 v[224:239], v[48:51], v[132:135], v[224:239]
  ds_read_b64_tr_b16 v[40:41], v18 offset:4096
  ds_read_b64_tr_b16 v[42:43], v18 offset:4608
  s_waitcnt lgkmcnt(2)
  v_mfma_f32_32x32x16_bf16 v[224:239], v[32:35], v[136:139], v[224:239]
  ds_read_b64_tr_b16 v[48:49], v17 offset:8192
  ds_read_b64_tr_b16 v[50:51], v17 offset:8704
  v_dot2c_f32_bf16 v21, s74, v32
  v_dot2c_f32_bf16 v21, s74, v33
  v_dot2c_f32_bf16 v21, s74, v34
  v_dot2c_f32_bf16 v21, s74, v35
  s_waitcnt lgkmcnt(2)
  v_mfma_f32_32x32x16_bf16 v[224:239], v[40:43], v[140:143], v[224:239]
  ds_read_b64_tr_b16 v[32:33], v18 offset:8192
  ds_read_b64_tr_b16 v[34:35], v18 offset:8704
  s_waitcnt lgkmcnt(2)
  v_mfma_f32_32x32x16_bf16 v[224:239], v[48:51], v[144:147], v[224:239]
  ds_read_b64_tr_b16 v[40:41], v17 offset:12288
  ds_read_b64_tr_b16 v[42:43], v17 offset:12800
  v_dot2c_f32_bf16 v21, s74, v48
  v_dot2c_f32_bf16 v21, s74, v49
  v_dot2c_f32_bf16 v21, s74, v50
  v_dot2c_f32_bf16 v21, s74, v51
  s_waitcnt lgkmcnt(2)
  v_mfma_f32_32x32x16_bf16 v[224:239], v[32:35], v[148:151], v[224:239]
  ds_read_b64_tr_b16 v[48:49], v18 offset:12288
  ds_read_b64_tr_b16 v[50:51], v18 offset:12800
  s_waitcnt lgkmcnt(2)
  v_mfma_f32_32x32x16_bf16 v[224:239], v[40:43], v[152:155], v[224:239]
  s_waitcnt vmcnt(4)
  s_waitcnt vmcnt(0)
  s_barrier
  s_cmp_eq_u32 s60, 0
  s_cbranch_scc0 L_fs_4
  s_lshl_b32 s78, s61, 8
  s_add_u32 s78, s78, s2
  s_lshl_b32 s78, s78, 7
  s_add_u32 s78, s78, 4096
  v_mov_b32 v4, s62
  v_mov_b32 v5, s63
  v_mov_b32 v6, s78
  s_mov_b64 exec, 1
  buffer_store_dwordx2 v[4:5], v6, s[16:19], 0 offen sc1
  s_mov_b64 exec, -1
L_fs_4:
  ds_read_b64_tr_b16 v[32:33], v17 offset:16384
  ds_read_b64_tr_b16 v[34:35], v17 offset:16896
  v_dot2c_f32_bf16 v21, s74, v40
  v_dot2c_f32_bf16 v21, s74, v41
  v_dot2c_f32_bf16 v21, s74, v42
  v_dot2c_f32_bf16 v21, s74, v43
  s_waitcnt lgkmcnt(2)
  v_mfma_f32_32x32x16_bf16 v[224:239], v[48:51], v[156:159], v[224:239]
  ds_read_b64_tr_b16 v[40:41], v18 offset:16384
  ds_read_b64_tr_b16 v[42:43], v18 offset:16896
  s_waitcnt lgkmcnt(2)
  v_mfma_f32_32x32x16_bf16 v[224:239], v[32:35], v[160:163], v[224:239]
  ds_read_b64_tr_b16 v[48:49], v17 offset:20480
  ds_read_b64_tr_b16 v[50:51], v17 offset:20992
  v_dot2c_f32_bf16 v21, s74, v32
  v_dot2c_f32_bf16 v21, s74, v33
  v_dot2c_f32_bf16 v21, s74, v34
  v_dot2c_f32_bf16 v21, s74, v35
  s_waitcnt lgkmcnt(2)
  v_mfma_f32_32x32x16_bf16 v[224:239], v[40:43], v[164:167], v[224:239]
  ds_read_b64_tr_b16 v[32:33], v18 offset:20480
  ds_read_b64_tr_b16 v[34:35], v18 offset:20992
  s_waitcnt lgkmcnt(2)
  v_mfma_f32_32x32x16_bf16 v[224:239], v[48:51], v[168:171], v[224:239]
  ds_read_b64_tr_b16 v[40:41], v17 offset:24576
  ds_read_b64_tr_b16 v[42:43], v17 offset:25088
  v_dot2c_f32_bf16 v21, s74, v48
  v_dot2c_f32_bf16 v21, s74, v49
  v_dot2c_f32_bf16 v21, s74, v50
  v_dot2c_f32_bf16 v21, s74, v51
  s_waitcnt lgkmcnt(2)
  v_mfma_f32_32x32x16_bf16 v[224:239], v[32:35], v[172:175], v[224:239]
  ds_read_b64_tr_b16 v[48:49], v18 offset:24576
  ds_read_b64_tr_b16 v[50:51], v18 offset:25088
  s_waitcnt lgkmcnt(2)
  v_mfma_f32_32x32x16_bf16 v[224:239], v[40:43], v[176:179], v[224:239]
  ds_read_b64_tr_b16 v[32:33], v17 offset:28672
  ds_read_b64_tr_b16 v[34:35], v17 offset:29184
  v_dot2c_f32_bf16 v21, s74, v40
  v_dot2c_f32_bf16 v21, s74, v41
  v_dot2c_f32_bf16 v21, s74, v42
  v_dot2c_f32_bf16 v21, s74, v43
  s_waitcnt lgkmcnt(2)
  v_mfma_f32_32x32x16_bf16 v[224:239], v[48:51], v[180:183], v[224:239]
  ds_read_b64_tr_b16 v[40:41], v18 offset:28672
  ds_read_b64_tr_b16 v[42:43], v18 offset:29184
  s_waitcnt lgkmcnt(2)
  v_mfma_f32_32x32x16_bf16 v[224:239], v[32:35], v[184:187], v[224:239]
  v_dot2c_f32_bf16 v21, s74, v32
  v_dot2c_f32_bf16 v21, s74, v33
  v_dot2c_f32_bf16 v21, s74, v34
  v_dot2c_f32_bf16 v21, s74, v35
  s_waitcnt lgkmcnt(0)
  v_mfma_f32_32x32x16_bf16 v[224:239], v[40:43], v[188:191], v[224:239]
  v_mov_b32 v28, v21
  s_nop 1
  v_permlane32_swap_b32 v21, v28
  v_add_f32 v21, v21, v28
  ds_write_b32 v9, v21 offset:256
  s_waitcnt lgkmcnt(0)
  s_barrier
  s_lshl_b32 s92, s59, 1
  s_add_u32 s92, s92, s67
  s_lshl_b32 s92, s92, 6
  s_lshl_b32 s93, s58, 1
  s_add_u32 s92, s92, s93
  s_add_u32 s92, s92, s68
  s_lshl_b32 s92, s92, 12
  s_add_u32 s92, s92, 1048576
  s_mul_i32 s93, s67, 40960
  s_lshl_b32 s94, s68, 12
  s_add_u32 s93, s93, s94
  s_add_u32 s93, s93, 98304
  s_add_u32 m0, s93, 0
  s_add_u32 s94, s92, 0
  buffer_load_dwordx4 v2, s[16:19], s94 offen sc1 lds
  s_add_u32 m0, s93, 1024
  s_add_u32 s94, s92, 1024
  buffer_load_dwordx4 v2, s[16:19], s94 offen sc1 lds
  s_add_u32 m0, s93, 2048
  s_add_u32 s94, s92, 2048
  buffer_load_dwordx4 v2, s[16:19], s94 offen sc1 lds
  s_add_u32 m0, s93, 3072
  s_add_u32 s94, s92, 3072
  buffer_load_dwordx4 v2, s[16:19], s94 offen sc1 lds
  ds_read_b128 v[240:243], v56 offset:256
  ds_read_b128 v[244:247], v56 offset:288
  ds_read_b128 v[248:251], v56 offset:320
  ds_read_b128 v[252:255], v56 offset:352
  ds_read_b128 v[32:35], v56 offset:640
  ds_read_b128 v[36:39], v56 offset:672
  ds_read_b128 v[40:43], v56 offset:704
  ds_read_b128 v[44:47], v56 offset:736
  s_waitcnt lgkmcnt(3)
  v_add_f32 v240, v240, v32
  v_add_f32 v241, v241, v33
  v_add_f32 v242, v242, v34
  v_add_f32 v243, v243, v35
  s_waitcnt lgkmcnt(2)
  v_add_f32 v244, v244, v36
  v_add_f32 v245, v245, v37
  v_add_f32 v246, v246, v38
  v_add_f32 v247, v247, v39
  s_waitcnt lgkmcnt(1)
  v_add_f32 v248, v248, v40
  v_add_f32 v249, v249, v41
  v_add_f32 v250, v250, v42
  v_add_f32 v251, v251, v43
  s_waitcnt lgkmcnt(0)
  v_add_f32 v252, v252, v44
  v_add_f32 v253, v253, v45
  v_add_f32 v254, v254, v46
  v_add_f32 v255, v255, v47
  v_fma_f32 v224, -v26, v240, v224
  v_fma_f32 v225, -v26, v241, v225
  v_fma_f32 v226, -v26, v242, v226
  v_fma_f32 v227, -v26, v243, v227
  v_fma_f32 v228, -v26, v244, v228
  v_fma_f32 v229, -v26, v245, v229
  v_fma_f32 v230, -v26, v246, v230
  v_fma_f32 v231, -v26, v247, v231
  v_fma_f32 v232, -v26, v248, v232
  v_fma_f32 v233, -v26, v249, v233
  v_fma_f32 v234, -v26, v250, v234
  v_fma_f32 v235, -v26, v251, v235
  v_fma_f32 v236, -v26, v252, v236
  v_fma_f32 v237, -v26, v253, v237
  v_fma_f32 v238, -v26, v254, v238
  v_fma_f32 v239, -v26, v255, v239
  v_mul_f32 v27, 0x3eb8aa3b, v27
  v_mul_f32 v224, v27, v224
  v_mul_f32 v225, v27, v225
  v_mul_f32 v226, v27, v226
  v_mul_f32 v227, v27, v227
  v_mul_f32 v228, v27, v228
  v_mul_f32 v229, v27, v229
  v_mul_f32 v230, v27, v230
  v_mul_f32 v231, v27, v231
  v_mul_f32 v232, v27, v232
  v_mul_f32 v233, v27, v233
  v_mul_f32 v234, v27, v234
  v_mul_f32 v235, v27, v235
  v_mul_f32 v236, v27, v236
  v_mul_f32 v237, v27, v237
  v_mul_f32 v238, v27, v238
  v_mul_f32 v239, v27, v239
  v_cvt_pk_bf16_f32 v224, v224, v225
  v_cvt_pk_bf16_f32 v225, v226, v227
  v_cvt_pk_bf16_f32 v226, v228, v229
  v_cvt_pk_bf16_f32 v227, v230, v231
  v_cvt_pk_bf16_f32 v228, v232, v233
  v_cvt_pk_bf16_f32 v229, v234, v235
  v_cvt_pk_bf16_f32 v230, v236, v237
  v_cvt_pk_bf16_f32 v231, v238, v239
  v_and_b32 v3, 31, v1
  v_lshrrev_b32 v4, 5, v1
  v_lshlrev_b32 v4, 2, v4
  v_sub_u32 v3, v3, v4
  v_mov_b32 v48, 0
  v_mov_b32 v49, 0xf149f2ca
  v_mov_b32 v50, 0xffff
  v_mov_b32 v51, 0xffff0000
  v_cmp_le_i32 s[72:73], 0, v3
  v_mov_b32 v160, 0
  v_mov_b32 v176, 0
  v_cndmask_b32 v208, v49, v48, s[72:73]
  v_cndmask_b32 v232, v48, v49, s[72:73]
  v_cndmask_b32 v52, v48, v50, s[72:73]
  v_cmp_le_i32 s[74:75], 1, v3
  v_mov_b32 v161, 0
  v_mov_b32 v177, 0
  v_cndmask_b32 v209, v49, v48, s[74:75]
  v_cndmask_b32 v233, v48, v49, s[74:75]
  v_cndmask_b32 v53, v48, v51, s[74:75]
  v_or_b32 v32, v52, v53
  v_not_b32 v40, v32
  v_cmp_le_i32 s[76:77], 2, v3
  v_mov_b32 v162, 0
  v_mov_b32 v178, 0
  v_cndmask_b32 v210, v49, v48, s[76:77]
  v_cndmask_b32 v234, v48, v49, s[76:77]
  v_cndmask_b32 v52, v48, v50, s[76:77]
  v_cmp_le_i32 s[78:79], 3, v3
  v_mov_b32 v163, 0
  v_mov_b32 v179, 0
  v_cndmask_b32 v211, v49, v48, s[78:79]
  v_cndmask_b32 v235, v48, v49, s[78:79]
  v_cndmask_b32 v53, v48, v51, s[78:79]
  v_or_b32 v33, v52, v53
  v_not_b32 v41, v33
  v_cmp_le_i32 s[72:73], 8, v3
  v_mov_b32 v164, 0
  v_mov_b32 v180, 0
  v_cndmask_b32 v212, v49, v48, s[72:73]
  v_cndmask_b32 v236, v48, v49, s[72:73]
  v_cndmask_b32 v52, v48, v50, s[72:73]
  v_cmp_le_i32 s[74:75], 9, v3
  v_mov_b32 v165, 0
  v_mov_b32 v181, 0
  v_cndmask_b32 v213, v49, v48, s[74:75]
  v_cndmask_b32 v237, v48, v49, s[74:75]
  v_cndmask_b32 v53, v48, v51, s[74:75]
  v_or_b32 v34, v52, v53
  v_not_b32 v42, v34
  v_cmp_le_i32 s[76:77], 10, v3
  v_mov_b32 v166, 0
  v_mov_b32 v182, 0
  v_cndmask_b32 v214, v49, v48, s[76:77]
  v_cndmask_b32 v238, v48, v49, s[76:77]
  v_cndmask_b32 v52, v48, v50, s[76:77]
  v_cmp_le_i32 s[78:79], 11, v3
  v_mov_b32 v167, 0
  v_mov_b32 v183, 0
  v_cndmask_b32 v215, v49, v48, s[78:79]
  v_cndmask_b32 v239, v48, v49, s[78:79]
  v_cndmask_b32 v53, v48, v51, s[78:79]
  v_or_b32 v35, v52, v53
  v_not_b32 v43, v35
  v_cmp_le_i32 s[72:73], 16, v3
  v_mov_b32 v168, 0
  v_mov_b32 v184, 0
  v_cndmask_b32 v216, v49, v48, s[72:73]
  v_cndmask_b32 v240, v48, v49, s[72:73]
  v_cndmask_b32 v52, v48, v50, s[72:73]
  v_cmp_le_i32 s[74:75], 17, v3
  v_mov_b32 v169, 0
  v_mov_b32 v185, 0
  v_cndmask_b32 v217, v49, v48, s[74:75]
  v_cndmask_b32 v241, v48, v49, s[74:75]
  v_cndmask_b32 v53, v48, v51, s[74:75]
  v_or_b32 v36, v52, v53
  v_not_b32 v44, v36
  v_cmp_le_i32 s[76:77], 18, v3
  v_mov_b32 v170, 0
  v_mov_b32 v186, 0
  v_cndmask_b32 v218, v49, v48, s[76:77]
  v_cndmask_b32 v242, v48, v49, s[76:77]
  v_cndmask_b32 v52, v48, v50, s[76:77]
  v_cmp_le_i32 s[78:79], 19, v3
  v_mov_b32 v171, 0
  v_mov_b32 v187, 0
  v_cndmask_b32 v219, v49, v48, s[78:79]
  v_cndmask_b32 v243, v48, v49, s[78:79]
  v_cndmask_b32 v53, v48, v51, s[78:79]
  v_or_b32 v37, v52, v53
  v_not_b32 v45, v37
  v_cmp_le_i32 s[72:73], 24, v3
  v_mov_b32 v172, 0
  v_mov_b32 v188, 0
  v_cndmask_b32 v220, v49, v48, s[72:73]
  v_cndmask_b32 v244, v48, v49, s[72:73]
  v_cndmask_b32 v52, v48, v50, s[72:73]
  v_cmp_le_i32 s[74:75], 25, v3
  v_mov_b32 v173, 0
  v_mov_b32 v189, 0
  v_cndmask_b32 v221, v49, v48, s[74:75]
  v_cndmask_b32 v245, v48, v49, s[74:75]
  v_cndmask_b32 v53, v48, v51, s[74:75]
  v_or_b32 v38, v52, v53
  v_not_b32 v46, v38
  v_cmp_le_i32 s[76:77], 26, v3
  v_mov_b32 v174, 0
  v_mov_b32 v190, 0
  v_cndmask_b32 v222, v49, v48, s[76:77]
  v_cndmask_b32 v246, v48, v49, s[76:77]
  v_cndmask_b32 v52, v48, v50, s[76:77]
  v_cmp_le_i32 s[78:79], 27, v3
  v_mov_b32 v175, 0
  v_mov_b32 v191, 0
  v_cndmask_b32 v223, v49, v48, s[78:79]
  v_cndmask_b32 v247, v48, v49, s[78:79]
  v_cndmask_b32 v53, v48, v51, s[78:79]
  v_or_b32 v39, v52, v53
  v_not_b32 v47, v39
  v_mov_b32 v192, 0
  v_mov_b32 v200, 0
  v_mov_b32 v193, 0
  v_mov_b32 v201, 0
  v_mov_b32 v194, 0
  v_mov_b32 v202, 0
  v_mov_b32 v195, 0
  v_mov_b32 v203, 0
  v_mov_b32 v196, 0
  v_mov_b32 v204, 0
  v_mov_b32 v197, 0
  v_mov_b32 v205, 0
  v_mov_b32 v198, 0
  v_mov_b32 v206, 0
  v_mov_b32 v199, 0
  v_mov_b32 v207, 0
  v_accvgpr_write_b32 a72, v48
  v_accvgpr_write_b32 a73, v48
  v_accvgpr_write_b32 a74, v48
  v_accvgpr_write_b32 a75, v48
  v_accvgpr_write_b32 a76, v48
  v_accvgpr_write_b32 a77, v48
  v_accvgpr_write_b32 a78, v48
  v_accvgpr_write_b32 a79, v48
  v_accvgpr_write_b32 a80, v48
  v_accvgpr_write_b32 a81, v48
  v_accvgpr_write_b32 a82, v48
  v_accvgpr_write_b32 a83, v48
  v_accvgpr_write_b32 a84, v48
  v_accvgpr_write_b32 a85, v48
  v_accvgpr_write_b32 a86, v48
  v_accvgpr_write_b32 a87, v48
  v_mov_b32 v54, 0x3f803f80
  s_mov_b32 exec_lo, 0x00110000
  s_mov_b32 exec_hi, 0x00110000
  v_accvgpr_write_b32 a72, v54
  v_accvgpr_write_b32 a73, v54
  v_accvgpr_write_b32 a74, v54
  v_accvgpr_write_b32 a75, v54
  v_accvgpr_write_b32 a76, v54
  v_accvgpr_write_b32 a77, v54
  v_accvgpr_write_b32 a78, v54
  v_accvgpr_write_b32 a79, v54
  v_accvgpr_write_b32 a80, v54
  v_accvgpr_write_b32 a81, v54
  v_accvgpr_write_b32 a82, v54
  v_accvgpr_write_b32 a83, v54
  v_accvgpr_write_b32 a84, v54
  v_accvgpr_write_b32 a85, v54
  v_accvgpr_write_b32 a86, v54
  v_accvgpr_write_b32 a87, v54
  s_mov_b64 exec, -1
  s_sub_u32 s72, s58, 4
  v_add_u32 v8, s72, v1
  v_cmp_le_i32 s[74:75], 0, v8
  v_and_b32 v9, 3, v8
  v_lshlrev_b32 v9, 3, v9
  v_add_u32 v9, s59, v9
  v_lshlrev_b32 v9, 3, v9
  v_lshrrev_b32 v7, 2, v8
  v_add_u32 v9, v9, v7
  s_lshl_b32 s70, s61, 15
  s_add_u32 s70, s70, 4096
  v_lshlrev_b32 v9, 7, v9
  v_add_u32 v9, s70, v9
  s_and_b64 s[74:75], s[74:75], 0xf
  s_lshl_b32 s76, s58, 1
  s_add_u32 s76, s76, s68
  s_sub_u32 s77, 8, s76
  s_max_i32 s77, s77, 0
  s_lshl_b32 s78, s59, 1
  s_add_u32 s78, s78, s67
  s_lshl_b32 s78, s78, 18
  s_lshl_b32 s79, s61, 22
  s_add_u32 s78, s78, s79
  s_add_u32 s78, s78, 1048576
  s_lshl_b32 s79, s68, 2
  s_lshl_b32 s80, s58, 1
  s_add_u32 s80, s80, s79
  s_sub_u32 s80, s80, 8
  s_add_i32 s81, s80, 0
  s_max_i32 s81, s81, 0
  s_lshl_b32 s81, s81, 12
  s_add_u32 s81, s81, s78
  s_add_i32 s82, s80, 1
  s_max_i32 s82, s82, 0
  s_lshl_b32 s82, s82, 12
  s_add_u32 s82, s82, s78
  s_add_i32 s83, s80, 2
  s_max_i32 s83, s83, 0
  s_lshl_b32 s83, s83, 12
  s_add_u32 s83, s83, s78
  s_add_i32 s84, s80, 3
  s_max_i32 s84, s84, 0
  s_lshl_b32 s84, s84, 12
  s_add_u32 s84, s84, s78
  s_mul_i32 s86, s67, 40960
  s_lshl_b32 s87, s68, 14
  s_add_u32 s87, s87, s86
  s_add_u32 s87, s87, 65536
  s_lshl_b32 s88, s68, 12
  s_add_u32 s88, s88, s86
  s_add_u32 s88, s88, 65536
  v_add_u32 v10, s88, v2
  v_and_b32 v8, 15, v1
  v_lshlrev_b32 v8, 4, v8
  v_lshrrev_b32 v7, 5, v1
  v_lshl_add_u32 v8, v7, 8, v8
  v_add_u32 v11, s88, v8
  s_mov_b32 s90, 0xffff
  s_mov_b32 s91, 0xffff
  v_bfe_u32 v20, v1, 4, 1
  v_lshlrev_b32 v20, 14, v20
  v_and_b32 v7, 15, v1
  v_lshl_add_u32 v20, v7, 4, v20
  v_lshrrev_b32 v7, 5, v1
  v_lshl_add_u32 v20, v7, 8, v20
  s_lshl_b32 s72, s58, 2
  s_lshl_b32 s73, s68, 1
  s_add_u32 s72, s72, s73
  s_lshl_b32 s72, s72, 4
  s_lshl_b32 s73, s59, 1
  s_add_u32 s72, s72, s73
  s_add_u32 s72, s72, s67
  s_lshl_b32 s72, s72, 10
  s_lshl_b32 s73, s61, 21
  s_add_u32 s72, s72, s73
  s_add_u32 s89, s72, 9437184
  s_mov_b64 s[76:77], s[74:75]
  s_lshl_b32 s72, s58, 7
  s_add_u32 s72, s72, 37224448
  v_lshlrev_b32 v3, 4, v1
  s_mov_b32 s100, 0
  s_mov_b64 exec, 0xff
L_tc_5:
  buffer_load_dwordx4 v[24:27], v3, s[16:19], s72 offen sc1
  s_waitcnt vmcnt(0)
  v_cmp_ne_u64 vcc, s[62:63], v[26:27]
  s_nop 0
  s_cbranch_vccz L_tco_6
  s_add_u32 s100, s100, 1
  s_cmp_lt_u32 s100, 400000
  s_cbranch_scc1 L_tc_5
  s_branch L_fail
L_tco_6:
  v_cmp_ne_u32 vcc, s1, v24
  s_cmp_eq_u64 vcc, 0
  s_cselect_b32 s0, 1, 0
  s_mov_b64 exec, -1
  s_lshr_b32 s72, s2, 2
  s_and_b32 s73, s2, 3
  s_mul_i32 s74, s73, 7
  s_min_u32 s75, s73, 1
  s_add_u32 s74, s74, s75
  s_cmp_eq_u32 s73, 0
  s_cselect_b32 s75, 8, 7
  s_mul_i32 s101, s72, 88064
  s_mul_i32 s73, s74, 96
  s_add_u32 s101, s101, s73
  s_mul_i32 s75, s75, 6
  s_mov_b32 s72, 1311
  s_mov_b32 s73, 2752
  s_lshl_b32 s74, s60, 6
  s_add_u32 s74, s74, 0
  v_add_u32 v3, s74, v1
  v_mul_lo_u32 v4, v3, s72
  v_lshrrev_b32 v4, 16, v4
  v_mul_u32_u24 v5, 50, v4
  v_sub_u32 v5, v3, v5
  v_mul_lo_u32 v6, v4, s73
  v_lshl_add_u32 v6, v5, 4, v6
  v_cmp_gt_u32 vcc, s75, v5
  v_cmp_gt_u32 s[78:79], 32, v4
  s_and_b64 vcc, vcc, s[78:79]
  v_mov_b32 v5, 0x7ff00000
  v_cndmask_b32 v12, v5, v6, vcc
  s_lshl_b32 s74, s60, 6
  s_add_u32 s74, s74, 256
  v_add_u32 v3, s74, v1
  v_mul_lo_u32 v4, v3, s72
  v_lshrrev_b32 v4, 16, v4
  v_mul_u32_u24 v5, 50, v4
  v_sub_u32 v5, v3, v5
  v_mul_lo_u32 v6, v4, s73
  v_lshl_add_u32 v6, v5, 4, v6
  v_cmp_gt_u32 vcc, s75, v5
  v_cmp_gt_u32 s[78:79], 32, v4
  s_and_b64 vcc, vcc, s[78:79]
  v_mov_b32 v5, 0x7ff00000
  v_cndmask_b32 v13, v5, v6, vcc
  s_lshl_b32 s74, s60, 6
  s_add_u32 s74, s74, 512
  v_add_u32 v3, s74, v1
  v_mul_lo_u32 v4, v3, s72
  v_lshrrev_b32 v4, 16, v4
  v_mul_u32_u24 v5, 50, v4
  v_sub_u32 v5, v3, v5
  v_mul_lo_u32 v6, v4, s73
  v_lshl_add_u32 v6, v5, 4, v6
  v_cmp_gt_u32 vcc, s75, v5
  v_cmp_gt_u32 s[78:79], 32, v4
  s_and_b64 vcc, vcc, s[78:79]
  v_mov_b32 v5, 0x7ff00000
  v_cndmask_b32 v14, v5, v6, vcc
  s_lshl_b32 s74, s60, 6
  s_add_u32 s74, s74, 768
  v_add_u32 v3, s74, v1
  v_mul_lo_u32 v4, v3, s72
  v_lshrrev_b32 v4, 16, v4
  v_mul_u32_u24 v5, 50, v4
  v_sub_u32 v5, v3, v5
  v_mul_lo_u32 v6, v4, s73
  v_lshl_add_u32 v6, v5, 4, v6
  v_cmp_gt_u32 vcc, s75, v5
  v_cmp_gt_u32 s[78:79], 32, v4
  s_and_b64 vcc, vcc, s[78:79]
  v_mov_b32 v5, 0x7ff00000
  v_cndmask_b32 v15, v5, v6, vcc
  s_lshl_b32 s74, s60, 6
  s_add_u32 s74, s74, 1024
  v_add_u32 v3, s74, v1
  v_mul_lo_u32 v4, v3, s72
  v_lshrrev_b32 v4, 16, v4
  v_mul_u32_u24 v5, 50, v4
  v_sub_u32 v5, v3, v5
  v_mul_lo_u32 v6, v4, s73
  v_lshl_add_u32 v6, v5, 4, v6
  v_cmp_gt_u32 vcc, s75, v5
  v_cmp_gt_u32 s[78:79], 32, v4
  s_and_b64 vcc, vcc, s[78:79]
  v_mov_b32 v5, 0x7ff00000
  v_cndmask_b32 v16, v5, v6, vcc
  s_lshl_b32 s74, s60, 6
  s_add_u32 s74, s74, 1280
  v_add_u32 v3, s74, v1
  v_mul_lo_u32 v4, v3, s72
  v_lshrrev_b32 v4, 16, v4
  v_mul_u32_u24 v5, 50, v4
  v_sub_u32 v5, v3, v5
  v_mul_lo_u32 v6, v4, s73
  v_lshl_add_u32 v6, v5, 4, v6
  v_cmp_gt_u32 vcc, s75, v5
  v_cmp_gt_u32 s[78:79], 32, v4
  s_and_b64 vcc, vcc, s[78:79]
  v_mov_b32 v5, 0x7ff00000
  v_cndmask_b32 v17, v5, v6, vcc
  s_lshl_b32 s74, s60, 6
  s_add_u32 s74, s74, 1536
  v_add_u32 v3, s74, v1
  v_mul_lo_u32 v4, v3, s72
  v_lshrrev_b32 v4, 16, v4
  v_mul_u32_u24 v5, 50, v4
  v_sub_u32 v5, v3, v5
  v_mul_lo_u32 v6, v4, s73
  v_lshl_add_u32 v6, v5, 4, v6
  v_cmp_gt_u32 vcc, s75, v5
  v_cmp_gt_u32 s[78:79], 32, v4
  s_and_b64 vcc, vcc, s[78:79]
  v_mov_b32 v5, 0x7ff00000
  v_cndmask_b32 v18, v5, v6, vcc
  v_lshrrev_b32 v3, 3, v1
  v_lshlrev_b32 v3, 10, v3
  v_bfe_u32 v4, v1, 1, 2
  v_bfe_u32 v5, v1, 4, 2
  v_xor_b32 v4, v4, v5
  v_lshlrev_b32 v4, 1, v4
  v_and_b32 v5, 1, v1
  v_add_u32 v4, v4, v5
  v_lshl_add_u32 v19, v4, 4, v3
  s_lshl_b32 s78, s60, 17
  s_lshl_b32 s73, s59, 7
  s_add_u32 s78, s78, s73
  s_lshl_b32 s79, s60, 14
  s_mov_b64 exec, s[76:77]
  s_mov_b32 s100, 0
  s_cbranch_execz L_pok_8
L_poll_7:
  buffer_load_dwordx2 v[4:5], v9, s[16:19], 0 offen sc1
  s_waitcnt vmcnt(0)
  v_cmp_ne_u64 vcc, s[62:63], v[4:5]
  s_nop 0
  s_cbranch_vccz L_pok_8
  s_add_u32 s100, s100, 1
  s_cmp_lt_u32 s100, 400000
  s_cbranch_scc1 L_poll_7
  s_branch L_fail
L_pok_8:
  s_mov_b64 exec, -1
  s_lshl_b32 s76, s58, 1
  s_add_u32 s76, s76, s68
  s_sub_u32 s77, 8, s76
  s_max_i32 s77, s77, 0
  s_add_u32 m0, s87, 0
  s_add_u32 s72, s81, 0
  buffer_load_dwordx4 v2, s[16:19], s72 offen sc1 lds
  s_add_u32 m0, s87, 2048
  s_add_u32 s72, s81, 2048
  buffer_load_dwordx4 v2, s[16:19], s72 offen sc1 lds
  s_add_u32 m0, s87, 4096
  s_add_u32 s72, s82, 0
  buffer_load_dwordx4 v2, s[16:19], s72 offen sc1 lds
  s_add_u32 m0, s87, 6144
  s_add_u32 s72, s82, 2048
  buffer_load_dwordx4 v2, s[16:19], s72 offen sc1 lds
  s_add_u32 m0, s87, 8192
  s_add_u32 s72, s83, 0
  buffer_load_dwordx4 v2, s[16:19], s72 offen sc1 lds
  s_add_u32 m0, s87, 10240
  s_add_u32 s72, s83, 2048
  buffer_load_dwordx4 v2, s[16:19], s72 offen sc1 lds
  s_add_u32 m0, s87, 12288
  s_add_u32 s72, s84, 0
  buffer_load_dwordx4 v2, s[16:19], s72 offen sc1 lds
  s_add_u32 m0, s87, 14336
  s_add_u32 s72, s84, 2048
  buffer_load_dwordx4 v2, s[16:19], s72 offen sc1 lds
  s_add_u32 m0, s87, 1024
  s_add_u32 s72, s81, 1024
  buffer_load_dwordx4 v2, s[16:19], s72 offen sc1 lds
  s_add_u32 m0, s87, 3072
  s_add_u32 s72, s81, 3072
  buffer_load_dwordx4 v2, s[16:19], s72 offen sc1 lds
  s_add_u32 m0, s87, 5120
  s_add_u32 s72, s82, 1024
  buffer_load_dwordx4 v2, s[16:19], s72 offen sc1 lds
  s_add_u32 m0, s87, 7168
  s_add_u32 s72, s82, 3072
  buffer_load_dwordx4 v2, s[16:19], s72 offen sc1 lds
  s_add_u32 m0, s87, 9216
  s_add_u32 s72, s83, 1024
  buffer_load_dwordx4 v2, s[16:19], s72 offen sc1 lds
  s_add_u32 m0, s87, 11264
  s_add_u32 s72, s83, 3072
  buffer_load_dwordx4 v2, s[16:19], s72 offen sc1 lds
  s_add_u32 m0, s87, 13312
  s_add_u32 s72, s84, 1024
  buffer_load_dwordx4 v2, s[16:19], s72 offen sc1 lds
  s_add_u32 m0, s87, 15360
  s_add_u32 s72, s84, 3072
  buffer_load_dwordx4 v2, s[16:19], s72 offen sc1 lds
  v_mov_b32 v48, 0xf149f2ca
  v_mov_b32 v49, 0xf149f2ca
  v_mov_b32 v50, 0xf149f2ca
  v_mov_b32 v51, 0xf149f2ca
  s_waitcnt vmcnt(8)
  s_barrier
  ds_read_b128 a[0:3], v10 offset:0
  ds_read_b128 a[4:7], v10 offset:2048
  ds_read_b128 a[8:11], v10 offset:4096
  ds_read_b128 a[12:15], v10 offset:6144
  s_waitcnt lgkmcnt(3)
  v_mfma_f32_32x32x16_bf16 v[64:79], a[0:3], v[224:227], v[232:247]
  ds_read_b128 a[16:19], v10 offset:8192
  s_waitcnt lgkmcnt(3)
  v_mfma_f32_32x32x16_bf16 v[80:95], a[4:7], v[228:231], v[232:247]
  s_cmp_gt_u32 s77, 0
  s_cbranch_scc1 L_p1s_9
  ds_read_b128 a[20:23], v10 offset:10240
  s_waitcnt lgkmcnt(3)
  v_mfma_f32_32x32x16_bf16 v[96:111], a[8:11], v[224:227], 0
  s_nop 3
  v_max3_f32 v48, v48, v64, v65
  v_max3_f32 v49, v49, v66, v67
  v_max3_f32 v48, v48, v68, v69
  v_max3_f32 v49, v49, v70, v71
  v_max3_f32 v48, v48, v72, v73
  v_max3_f32 v49, v49, v74, v75
  v_max3_f32 v48, v48, v76, v77
  v_max3_f32 v49, v49, v78, v79
  ds_read_b128 a[24:27], v10 offset:12288
  s_waitcnt lgkmcnt(3)
  v_mfma_f32_32x32x16_bf16 v[112:127], a[12:15], v[228:231], 0
  v_max3_f32 v50, v50, v80, v81
  v_max3_f32 v51, v51, v82, v83
  v_max3_f32 v50, v50, v84, v85
  v_max3_f32 v51, v51, v86, v87
  v_max3_f32 v50, v50, v88, v89
  v_max3_f32 v51, v51, v90, v91
  v_max3_f32 v50, v50, v92, v93
  v_max3_f32 v51, v51, v94, v95
L_p1b_10:
  s_cmp_gt_u32 s77, 1
  s_cbranch_scc1 L_p1s_11
  ds_read_b128 a[28:31], v10 offset:14336
  s_waitcnt lgkmcnt(3)
  v_mfma_f32_32x32x16_bf16 v[64:79], a[16:19], v[224:227], 0
  v_max3_f32 v48, v48, v96, v97
  v_max3_f32 v49, v49, v98, v99
  v_max3_f32 v48, v48, v100, v101
  v_max3_f32 v49, v49, v102, v103
  v_max3_f32 v48, v48, v104, v105
  v_max3_f32 v49, v49, v106, v107
  v_max3_f32 v48, v48, v108, v109
  v_max3_f32 v49, v49, v110, v111
  ds_read_b128 a[32:35], v10 offset:16384
  s_waitcnt lgkmcnt(3)
  v_mfma_f32_32x32x16_bf16 v[80:95], a[20:23], v[228:231], 0
  v_max3_f32 v50, v50, v112, v113
  v_max3_f32 v51, v51, v114, v115
  v_max3_f32 v50, v50, v116, v117
  v_max3_f32 v51, v51, v118, v119
  v_max3_f32 v50, v50, v120, v121
  v_max3_f32 v51, v51, v122, v123
  v_max3_f32 v50, v50, v124, v125
  v_max3_f32 v51, v51, v126, v127
L_p1b_12:
  buffer_load_dwordx4 a[96:99], v12, s[96:99], s101 offen
  buffer_load_dwordx4 a[100:103], v13, s[96:99], s101 offen
  buffer_load_dwordx4 a[104:107], v14, s[96:99], s101 offen
  buffer_load_dwordx4 a[108:111], v15, s[96:99], s101 offen
  buffer_load_dwordx4 a[112:115], v16, s[96:99], s101 offen
  buffer_load_dwordx4 a[116:119], v17, s[96:99], s101 offen
  buffer_load_dwordx4 a[120:123], v18, s[96:99], s101 offen
  s_cmp_gt_u32 s77, 2
  s_cbranch_scc1 L_p1s_13
  ds_read_b128 a[36:39], v10 offset:18432
  s_waitcnt lgkmcnt(3)
  v_mfma_f32_32x32x16_bf16 v[96:111], a[24:27], v[224:227], 0
  v_max3_f32 v48, v48, v64, v65
  v_max3_f32 v49, v49, v66, v67
  v_max3_f32 v48, v48, v68, v69
  v_max3_f32 v49, v49, v70, v71
  v_max3_f32 v48, v48, v72, v73
  v_max3_f32 v49, v49, v74, v75
  v_max3_f32 v48, v48, v76, v77
  v_max3_f32 v49, v49, v78, v79
  ds_read_b128 a[40:43], v10 offset:20480
  s_waitcnt lgkmcnt(3)
  v_mfma_f32_32x32x16_bf16 v[112:127], a[28:31], v[228:231], 0
  v_max3_f32 v50, v50, v80, v81
  v_max3_f32 v51, v51, v82, v83
  v_max3_f32 v50, v50, v84, v85
  v_max3_f32 v51, v51, v86, v87
  v_max3_f32 v50, v50, v88, v89
  v_max3_f32 v51, v51, v90, v91
  v_max3_f32 v50, v50, v92, v93
  v_max3_f32 v51, v51, v94, v95
L_p1b_14:
  s_cmp_gt_u32 s77, 3
  s_cbranch_scc1 L_p1s_15
  ds_read_b128 a[44:47], v10 offset:22528
  s_waitcnt lgkmcnt(3)
  v_mfma_f32_32x32x16_bf16 v[64:79], a[32:35], v[224:227], 0
  v_max3_f32 v48, v48, v96, v97
  v_max3_f32 v49, v49, v98, v99
  v_max3_f32 v48, v48, v100, v101
  v_max3_f32 v49, v49, v102, v103
  v_max3_f32 v48, v48, v104, v105
  v_max3_f32 v49, v49, v106, v107
  v_max3_f32 v48, v48, v108, v109
  v_max3_f32 v49, v49, v110, v111
  ds_read_b128 a[48:51], v10 offset:24576
  s_waitcnt lgkmcnt(3)
  v_mfma_f32_32x32x16_bf16 v[80:95], a[36:39], v[228:231], 0
  v_max3_f32 v50, v50, v112, v113
  v_max3_f32 v51, v51, v114, v115
  v_max3_f32 v50, v50, v116, v117
  v_max3_f32 v51, v51, v118, v119
  v_max3_f32 v50, v50, v120, v121
  v_max3_f32 v51, v51, v122, v123
  v_max3_f32 v50, v50, v124, v125
  v_max3_f32 v51, v51, v126, v127
L_p1b_16:
  s_cmp_gt_u32 s77, 4
  s_cbranch_scc1 L_p1s_17
  ds_read_b128 a[52:55], v10 offset:26624
  s_waitcnt lgkmcnt(3)
  v_mfma_f32_32x32x16_bf16 v[96:111], a[40:43], v[224:227], 0
  v_max3_f32 v48, v48, v64, v65
  v_max3_f32 v49, v49, v66, v67
  v_max3_f32 v48, v48, v68, v69
  v_max3_f32 v49, v49, v70, v71
  v_max3_f32 v48, v48, v72, v73
  v_max3_f32 v49, v49, v74, v75
  v_max3_f32 v48, v48, v76, v77
  v_max3_f32 v49, v49, v78, v79
  ds_read_b128 a[56:59], v10 offset:28672
  s_waitcnt lgkmcnt(3)
  v_mfma_f32_32x32x16_bf16 v[112:127], a[44:47], v[228:231], 0
  v_max3_f32 v50, v50, v80, v81
  v_max3_f32 v51, v51, v82, v83
  v_max3_f32 v50, v50, v84, v85
  v_max3_f32 v51, v51, v86, v87
  v_max3_f32 v50, v50, v88, v89
  v_max3_f32 v51, v51, v90, v91
  v_max3_f32 v50, v50, v92, v93
  v_max3_f32 v51, v51, v94, v95
L_p1b_18:
  s_cmp_gt_u32 s77, 5
  s_cbranch_scc1 L_p1s_19
  ds_read_b128 a[60:63], v10 offset:30720
  s_waitcnt lgkmcnt(3)
  v_mfma_f32_32x32x16_bf16 v[64:79], a[48:51], v[224:227], 0
  v_max3_f32 v48, v48, v96, v97
  v_max3_f32 v49, v49, v98, v99
  v_max3_f32 v48, v48, v100, v101
  v_max3_f32 v49, v49, v102, v103
  v_max3_f32 v48, v48, v104, v105
  v_max3_f32 v49, v49, v106, v107
  v_max3_f32 v48, v48, v108, v109
  v_max3_f32 v49, v49, v110, v111
  ds_read_b128 a[64:67], v10 offset:32768
  s_waitcnt lgkmcnt(3)
  v_mfma_f32_32x32x16_bf16 v[80:95], a[52:55], v[228:231], 0
  v_max3_f32 v50, v50, v112, v113
  v_max3_f32 v51, v51, v114, v115
  v_max3_f32 v50, v50, v116, v117
  v_max3_f32 v51, v51, v118, v119
  v_max3_f32 v50, v50, v120, v121
  v_max3_f32 v51, v51, v122, v123
  v_max3_f32 v50, v50, v124, v125
  v_max3_f32 v51, v51, v126, v127
L_p1b_20:
  s_cmp_gt_u32 s77, 6
  s_cbranch_scc1 L_p1s_21
  ds_read_b128 a[68:71], v10 offset:34816
  s_waitcnt lgkmcnt(3)
  v_mfma_f32_32x32x16_bf16 v[96:111], a[56:59], v[224:227], 0
  v_max3_f32 v48, v48, v64, v65
  v_max3_f32 v49, v49, v66, v67
  v_max3_f32 v48, v48, v68, v69
  v_max3_f32 v49, v49, v70, v71
  v_max3_f32 v48, v48, v72, v73
  v_max3_f32 v49, v49, v74, v75
  v_max3_f32 v48, v48, v76, v77
  v_max3_f32 v49, v49, v78, v79
  s_waitcnt lgkmcnt(2)
  v_mfma_f32_32x32x16_bf16 v[112:127], a[60:63], v[228:231], 0
  v_max3_f32 v50, v50, v80, v81
  v_max3_f32 v51, v51, v82, v83
  v_max3_f32 v50, v50, v84, v85
  v_max3_f32 v51, v51, v86, v87
  v_max3_f32 v50, v50, v88, v89
  v_max3_f32 v51, v51, v90, v91
  v_max3_f32 v50, v50, v92, v93
  v_max3_f32 v51, v51, v94, v95
L_p1b_22:
  s_cmp_gt_u32 s77, 7
  s_cbranch_scc1 L_p1s_23
  s_waitcnt lgkmcnt(1)
  v_mfma_f32_32x32x16_bf16 v[64:79], a[64:67], v[224:227], v[208:223]
  v_max3_f32 v48, v48, v96, v97
  v_max3_f32 v49, v49, v98, v99
  v_max3_f32 v48, v48, v100, v101
  v_max3_f32 v49, v49, v102, v103
  v_max3_f32 v48, v48, v104, v105
  v_max3_f32 v49, v49, v106, v107
  v_max3_f32 v48, v48, v108, v109
  v_max3_f32 v49, v49, v110, v111
  s_waitcnt lgkmcnt(0)
  v_mfma_f32_32x32x16_bf16 v[80:95], a[68:71], v[228:231], v[208:223]
  v_max3_f32 v50, v50, v112, v113
  v_max3_f32 v51, v51, v114, v115
  v_max3_f32 v50, v50, v116, v117
  v_max3_f32 v51, v51, v118, v119
  v_max3_f32 v50, v50, v120, v121
  v_max3_f32 v51, v51, v122, v123
  v_max3_f32 v50, v50, v124, v125
  v_max3_f32 v51, v51, v126, v127
L_p1b_24:
  v_max3_f32 v48, v48, v64, v65
  v_max3_f32 v49, v49, v66, v67
  v_max3_f32 v48, v48, v68, v69
  v_max3_f32 v49, v49, v70, v71
  v_max3_f32 v48, v48, v72, v73
  v_max3_f32 v49, v49, v74, v75
  v_max3_f32 v48, v48, v76, v77
  v_max3_f32 v49, v49, v78, v79
  v_max3_f32 v50, v50, v80, v81
  v_max3_f32 v51, v51, v82, v83
  v_max3_f32 v50, v50, v84, v85
  v_max3_f32 v51, v51, v86, v87
  v_max3_f32 v50, v50, v88, v89
  v_max3_f32 v51, v51, v90, v91
  v_max3_f32 v50, v50, v92, v93
  v_max3_f32 v51, v51, v94, v95
  v_max_f32 v48, v48, v49
  v_mov_b32 v49, v48
  v_max_f32 v50, v50, v51
  v_mov_b32 v51, v50
  v_permlane32_swap_b32 v48, v49
  s_nop 0
  v_permlane32_swap_b32 v50, v51
  v_max_f32 v48, v48, v49
  v_xor_b32 v48, 0x80000000, v48
  v_max_f32 v50, v50, v51
  v_xor_b32 v50, 0x80000000, v50
  v_mov_b32 v128, v48
  v_mov_b32 v129, v48
  v_mov_b32 v130, v48
  v_mov_b32 v131, v48
  v_mov_b32 v132, v48
  v_mov_b32 v133, v48
  v_mov_b32 v134, v48
  v_mov_b32 v135, v48
  v_mov_b32 v136, v48
  v_mov_b32 v137, v48
  v_mov_b32 v138, v48
  v_mov_b32 v139, v48
  v_mov_b32 v140, v48
  v_mov_b32 v141, v48
  v_mov_b32 v142, v48
  v_mov_b32 v143, v48
  s_nop 1
  v_mfma_f32_32x32x16_bf16 v[64:79], a[0:3], v[224:227], v[128:143]
  v_mov_b32 v144, v50
  v_mov_b32 v145, v50
  v_mov_b32 v146, v50
  v_mov_b32 v147, v50
  v_mov_b32 v148, v50
  v_mov_b32 v149, v50
  v_mov_b32 v150, v50
  v_mov_b32 v151, v50
  v_mov_b32 v152, v50
  v_mov_b32 v153, v50
  v_mov_b32 v154, v50
  v_mov_b32 v155, v50
  v_mov_b32 v156, v50
  v_mov_b32 v157, v50
  v_mov_b32 v158, v50
  v_mov_b32 v159, v50
  s_waitcnt vmcnt(7)
  s_barrier
  buffer_load_dword v21, v20, s[16:19], s89 offen sc1
  buffer_load_dword v23, v20, s[16:19], s89 offen offset:512 sc1
  s_lshl_b32 s72, s61, 5
  s_add_u32 s72, s72, s58
  s_lshl_b32 s72, s72, 3
  s_add_u32 s72, s72, s59
  s_lshl_b32 s72, s72, 10
  s_lshl_b32 s73, s60, 8
  s_add_u32 s72, s72, s73
  s_add_u32 s72, s72, 524288
  s_mov_b64 exec, 0xffff
  buffer_load_dword v22, v2, s[16:19], s72 offen sc1
  s_mov_b64 exec, -1
  s_cmp_gt_u32 s77, 0
  s_cbranch_scc1 L_sk_25
  v_exp_f32 v64, v64
  v_exp_f32 v65, v65
  v_mfma_f32_32x32x16_bf16 v[80:95], a[4:7], v[228:231], v[144:159]
  v_exp_f32 v66, v66
  v_cvt_pk_bf16_f32 v192, v64, v65
  v_exp_f32 v67, v67
  v_exp_f32 v68, v68
  v_cvt_pk_bf16_f32 v193, v66, v67
  v_exp_f32 v69, v69
  v_exp_f32 v70, v70
  v_cvt_pk_bf16_f32 v194, v68, v69
  v_exp_f32 v71, v71
  v_exp_f32 v72, v72
  v_cvt_pk_bf16_f32 v195, v70, v71
  v_exp_f32 v73, v73
  v_exp_f32 v74, v74
  v_cvt_pk_bf16_f32 v196, v72, v73
  v_exp_f32 v75, v75
  s_mov_b64 exec, s[90:91]
  ds_read_b128 a[72:75], v11 offset:1024
  ds_read_b128 a[76:79], v11 offset:1536
  s_mov_b64 exec, -1
  v_exp_f32 v76, v76
  v_cvt_pk_bf16_f32 v197, v74, v75
  v_exp_f32 v77, v77
  v_exp_f32 v78, v78
  v_cvt_pk_bf16_f32 v198, v76, v77
  v_exp_f32 v79, v79
  s_nop 0
  v_cvt_pk_bf16_f32 v199, v78, v79
  v_and_b32 v192, v40, v192
  v_and_b32 v193, v41, v193
  v_and_b32 v194, v42, v194
  v_and_b32 v195, v43, v195
  v_and_b32 v196, v44, v196
  v_and_b32 v197, v45, v197
  v_and_b32 v198, v46, v198
  v_and_b32 v199, v47, v199
  v_exp_f32 v80, v80
  v_exp_f32 v81, v81
  v_mfma_f32_32x32x16_bf16 v[64:79], a[8:11], v[224:227], v[128:143]
  v_exp_f32 v82, v82
  v_cvt_pk_bf16_f32 v200, v80, v81
  v_exp_f32 v83, v83
  v_exp_f32 v84, v84
  v_cvt_pk_bf16_f32 v201, v82, v83
  s_waitcnt lgkmcnt(1)
  v_mfma_f32_32x32x16_bf16 v[160:175], a[72:75], v[192:195], v[160:175]
  v_exp_f32 v85, v85
  v_exp_f32 v86, v86
  v_cvt_pk_bf16_f32 v202, v84, v85
  v_exp_f32 v87, v87
  v_exp_f32 v88, v88
  v_cvt_pk_bf16_f32 v203, v86, v87
  v_exp_f32 v89, v89
  s_waitcnt lgkmcnt(0)
  v_mfma_f32_32x32x16_bf16 v[160:175], a[76:79], v[196:199], v[160:175]
  v_exp_f32 v90, v90
  v_cvt_pk_bf16_f32 v204, v88, v89
  v_exp_f32 v91, v91
  s_mov_b64 exec, s[90:91]
  ds_read_b128 a[80:83], v11 offset:3072
  ds_read_b128 a[84:87], v11 offset:3584
  s_mov_b64 exec, -1
  v_exp_f32 v92, v92
  v_cvt_pk_bf16_f32 v205, v90, v91
  v_exp_f32 v93, v93
  v_exp_f32 v94, v94
  v_cvt_pk_bf16_f32 v206, v92, v93
  v_exp_f32 v95, v95
  s_nop 0
  v_cvt_pk_bf16_f32 v207, v94, v95
  v_and_b32 v200, v40, v200
  v_and_b32 v201, v41, v201
  v_and_b32 v202, v42, v202
  v_and_b32 v203, v43, v203
  v_and_b32 v204, v44, v204
  v_and_b32 v205, v45, v205
  v_and_b32 v206, v46, v206
  v_and_b32 v207, v47, v207
L_bk_26:
  s_cmp_gt_u32 s77, 1
  s_cbranch_scc1 L_sk_27
  v_exp_f32 v64, v64
  v_exp_f32 v65, v65
  v_mfma_f32_32x32x16_bf16 v[80:95], a[12:15], v[228:231], v[144:159]
  v_exp_f32 v66, v66
  v_cvt_pk_bf16_f32 v192, v64, v65
  v_exp_f32 v67, v67
  v_exp_f32 v68, v68
  v_cvt_pk_bf16_f32 v193, v66, v67
  s_waitcnt lgkmcnt(1)
  v_mfma_f32_32x32x16_bf16 v[176:191], a[80:83], v[200:203], v[176:191]
  v_exp_f32 v69, v69
  v_exp_f32 v70, v70
  v_cvt_pk_bf16_f32 v194, v68, v69
  v_exp_f32 v71, v71
  v_exp_f32 v72, v72
  v_cvt_pk_bf16_f32 v195, v70, v71
  v_exp_f32 v73, v73
  s_waitcnt lgkmcnt(0)
  v_mfma_f32_32x32x16_bf16 v[176:191], a[84:87], v[204:207], v[176:191]
  v_exp_f32 v74, v74
  v_cvt_pk_bf16_f32 v196, v72, v73
  v_exp_f32 v75, v75
  s_mov_b64 exec, s[90:91]
  ds_read_b128 a[72:75], v11 offset:5120
  ds_read_b128 a[76:79], v11 offset:5632
  s_mov_b64 exec, -1
  v_exp_f32 v76, v76
  v_cvt_pk_bf16_f32 v197, v74, v75
  v_exp_f32 v77, v77
  v_exp_f32 v78, v78
  v_cvt_pk_bf16_f32 v198, v76, v77
  v_exp_f32 v79, v79
  s_nop 0
  v_cvt_pk_bf16_f32 v199, v78, v79
  v_exp_f32 v80, v80
  v_exp_f32 v81, v81
  v_mfma_f32_32x32x16_bf16 v[64:79], a[16:19], v[224:227], v[128:143]
  v_exp_f32 v82, v82
  v_cvt_pk_bf16_f32 v200, v80, v81
  v_exp_f32 v83, v83
  v_exp_f32 v84, v84
  v_cvt_pk_bf16_f32 v201, v82, v83
  s_waitcnt lgkmcnt(1)
  v_mfma_f32_32x32x16_bf16 v[160:175], a[72:75], v[192:195], v[160:175]
  v_exp_f32 v85, v85
  v_exp_f32 v86, v86
  v_cvt_pk_bf16_f32 v202, v84, v85
  v_exp_f32 v87, v87
  v_exp_f32 v88, v88
  v_cvt_pk_bf16_f32 v203, v86, v87
  v_exp_f32 v89, v89
  s_waitcnt lgkmcnt(0)
  v_mfma_f32_32x32x16_bf16 v[160:175], a[76:79], v[196:199], v[160:175]
  v_exp_f32 v90, v90
  v_cvt_pk_bf16_f32 v204, v88, v89
  v_exp_f32 v91, v91
  s_mov_b64 exec, s[90:91]
  ds_read_b128 a[80:83], v11 offset:7168
  ds_read_b128 a[84:87], v11 offset:7680
  s_mov_b64 exec, -1
  v_exp_f32 v92, v92
  v_cvt_pk_bf16_f32 v205, v90, v91
  v_exp_f32 v93, v93
  v_exp_f32 v94, v94
  v_cvt_pk_bf16_f32 v206, v92, v93
  v_exp_f32 v95, v95
  s_nop 0
  v_cvt_pk_bf16_f32 v207, v94, v95
L_bk_28:
  s_cmp_gt_u32 s77, 2
  s_cbranch_scc1 L_sk_29
  v_exp_f32 v64, v64
  v_exp_f32 v65, v65
  v_mfma_f32_32x32x16_bf16 v[80:95], a[20:23], v[228:231], v[144:159]
  v_exp_f32 v66, v66
  v_cvt_pk_bf16_f32 v192, v64, v65
  v_exp_f32 v67, v67
  v_exp_f32 v68, v68
  v_cvt_pk_bf16_f32 v193, v66, v67
  s_waitcnt lgkmcnt(1)
  v_mfma_f32_32x32x16_bf16 v[176:191], a[80:83], v[200:203], v[176:191]
  v_exp_f32 v69, v69
  v_exp_f32 v70, v70
  v_cvt_pk_bf16_f32 v194, v68, v69
  v_exp_f32 v71, v71
  v_exp_f32 v72, v72
  v_cvt_pk_bf16_f32 v195, v70, v71
  v_exp_f32 v73, v73
  s_waitcnt lgkmcnt(0)
  v_mfma_f32_32x32x16_bf16 v[176:191], a[84:87], v[204:207], v[176:191]
  v_exp_f32 v74, v74
  v_cvt_pk_bf16_f32 v196, v72, v73
  v_exp_f32 v75, v75
  s_mov_b64 exec, s[90:91]
  ds_read_b128 a[72:75], v11 offset:9216
  ds_read_b128 a[76:79], v11 offset:9728
  s_mov_b64 exec, -1
  v_exp_f32 v76, v76
  v_cvt_pk_bf16_f32 v197, v74, v75
  v_exp_f32 v77, v77
  v_exp_f32 v78, v78
  v_cvt_pk_bf16_f32 v198, v76, v77
  v_exp_f32 v79, v79
  s_nop 0
  v_cvt_pk_bf16_f32 v199, v78, v79
  v_exp_f32 v80, v80
  v_exp_f32 v81, v81
  v_mfma_f32_32x32x16_bf16 v[64:79], a[24:27], v[224:227], v[128:143]
  v_exp_f32 v82, v82
  v_cvt_pk_bf16_f32 v200, v80, v81
  v_exp_f32 v83, v83
  v_exp_f32 v84, v84
  v_cvt_pk_bf16_f32 v201, v82, v83
  s_waitcnt lgkmcnt(1)
  v_mfma_f32_32x32x16_bf16 v[160:175], a[72:75], v[192:195], v[160:175]
  v_exp_f32 v85, v85
  v_exp_f32 v86, v86
  v_cvt_pk_bf16_f32 v202, v84, v85
  v_exp_f32 v87, v87
  v_exp_f32 v88, v88
  v_cvt_pk_bf16_f32 v203, v86, v87
  v_exp_f32 v89, v89
  s_waitcnt lgkmcnt(0)
  v_mfma_f32_32x32x16_bf16 v[160:175], a[76:79], v[196:199], v[160:175]
  v_exp_f32 v90, v90
  v_cvt_pk_bf16_f32 v204, v88, v89
  v_exp_f32 v91, v91
  s_mov_b64 exec, s[90:91]
  ds_read_b128 a[80:83], v11 offset:11264
  ds_read_b128 a[84:87], v11 offset:11776
  s_mov_b64 exec, -1
  v_exp_f32 v92, v92
  v_cvt_pk_bf16_f32 v205, v90, v91
  v_exp_f32 v93, v93
  v_exp_f32 v94, v94
  v_cvt_pk_bf16_f32 v206, v92, v93
  v_exp_f32 v95, v95
  s_nop 0
  v_cvt_pk_bf16_f32 v207, v94, v95
L_bk_30:
  s_cmp_gt_u32 s77, 3
  s_cbranch_scc1 L_sk_31
  v_exp_f32 v64, v64
  v_exp_f32 v65, v65
  v_mfma_f32_32x32x16_bf16 v[80:95], a[28:31], v[228:231], v[144:159]
  v_exp_f32 v66, v66
  v_cvt_pk_bf16_f32 v192, v64, v65
  v_exp_f32 v67, v67
  v_exp_f32 v68, v68
  v_cvt_pk_bf16_f32 v193, v66, v67
  s_waitcnt lgkmcnt(1)
  v_mfma_f32_32x32x16_bf16 v[176:191], a[80:83], v[200:203], v[176:191]
  v_exp_f32 v69, v69
  v_exp_f32 v70, v70
  v_cvt_pk_bf16_f32 v194, v68, v69
  v_exp_f32 v71, v71
  v_exp_f32 v72, v72
  v_cvt_pk_bf16_f32 v195, v70, v71
  v_exp_f32 v73, v73
  s_waitcnt lgkmcnt(0)
  v_mfma_f32_32x32x16_bf16 v[176:191], a[84:87], v[204:207], v[176:191]
  v_exp_f32 v74, v74
  v_cvt_pk_bf16_f32 v196, v72, v73
  v_exp_f32 v75, v75
  s_mov_b64 exec, s[90:91]
  ds_read_b128 a[72:75], v11 offset:13312
  ds_read_b128 a[76:79], v11 offset:13824
  s_mov_b64 exec, -1
  v_exp_f32 v76, v76
  v_cvt_pk_bf16_f32 v197, v74, v75
  v_exp_f32 v77, v77
  v_exp_f32 v78, v78
  v_cvt_pk_bf16_f32 v198, v76, v77
  v_exp_f32 v79, v79
  s_nop 0
  v_cvt_pk_bf16_f32 v199, v78, v79
  v_exp_f32 v80, v80
  v_exp_f32 v81, v81
  v_mfma_f32_32x32x16_bf16 v[64:79], a[32:35], v[224:227], v[128:143]
  v_exp_f32 v82, v82
  v_cvt_pk_bf16_f32 v200, v80, v81
  v_exp_f32 v83, v83
  v_exp_f32 v84, v84
  v_cvt_pk_bf16_f32 v201, v82, v83
  s_waitcnt lgkmcnt(1)
  v_mfma_f32_32x32x16_bf16 v[160:175], a[72:75], v[192:195], v[160:175]
  v_exp_f32 v85, v85
  v_exp_f32 v86, v86
  v_cvt_pk_bf16_f32 v202, v84, v85
  v_exp_f32 v87, v87
  v_exp_f32 v88, v88
  v_cvt_pk_bf16_f32 v203, v86, v87
  v_exp_f32 v89, v89
  s_waitcnt lgkmcnt(0)
  v_mfma_f32_32x32x16_bf16 v[160:175], a[76:79], v[196:199], v[160:175]
  v_exp_f32 v90, v90
  v_cvt_pk_bf16_f32 v204, v88, v89
  v_exp_f32 v91, v91
  s_mov_b64 exec, s[90:91]
  ds_read_b128 a[80:83], v11 offset:15360
  ds_read_b128 a[84:87], v11 offset:15872
  s_mov_b64 exec, -1
  v_exp_f32 v92, v92
  v_cvt_pk_bf16_f32 v205, v90, v91
  v_exp_f32 v93, v93
  v_exp_f32 v94, v94
  v_cvt_pk_bf16_f32 v206, v92, v93
  v_exp_f32 v95, v95
  s_nop 0
  v_cvt_pk_bf16_f32 v207, v94, v95
L_bk_32:
  s_cmp_gt_u32 s77, 4
  s_cbranch_scc1 L_sk_33
  v_exp_f32 v64, v64
  v_exp_f32 v65, v65
  v_mfma_f32_32x32x16_bf16 v[80:95], a[36:39], v[228:231], v[144:159]
  v_exp_f32 v66, v66
  v_cvt_pk_bf16_f32 v192, v64, v65
  v_exp_f32 v67, v67
  v_exp_f32 v68, v68
  v_cvt_pk_bf16_f32 v193, v66, v67
  s_waitcnt lgkmcnt(1)
  v_mfma_f32_32x32x16_bf16 v[176:191], a[80:83], v[200:203], v[176:191]
  v_exp_f32 v69, v69
  v_exp_f32 v70, v70
  v_cvt_pk_bf16_f32 v194, v68, v69
  v_exp_f32 v71, v71
  v_exp_f32 v72, v72
  v_cvt_pk_bf16_f32 v195, v70, v71
  v_exp_f32 v73, v73
  s_waitcnt lgkmcnt(0)
  v_mfma_f32_32x32x16_bf16 v[176:191], a[84:87], v[204:207], v[176:191]
  v_exp_f32 v74, v74
  v_cvt_pk_bf16_f32 v196, v72, v73
  v_exp_f32 v75, v75
  s_mov_b64 exec, s[90:91]
  ds_read_b128 a[72:75], v11 offset:17408
  ds_read_b128 a[76:79], v11 offset:17920
  s_mov_b64 exec, -1
  v_exp_f32 v76, v76
  v_cvt_pk_bf16_f32 v197, v74, v75
  v_exp_f32 v77, v77
  v_exp_f32 v78, v78
  v_cvt_pk_bf16_f32 v198, v76, v77
  v_exp_f32 v79, v79
  s_nop 0
  v_cvt_pk_bf16_f32 v199, v78, v79
  v_exp_f32 v80, v80
  v_exp_f32 v81, v81
  v_mfma_f32_32x32x16_bf16 v[64:79], a[40:43], v[224:227], v[128:143]
  v_exp_f32 v82, v82
  v_cvt_pk_bf16_f32 v200, v80, v81
  v_exp_f32 v83, v83
  v_exp_f32 v84, v84
  v_cvt_pk_bf16_f32 v201, v82, v83
  s_waitcnt lgkmcnt(1)
  v_mfma_f32_32x32x16_bf16 v[160:175], a[72:75], v[192:195], v[160:175]
  v_exp_f32 v85, v85
  v_exp_f32 v86, v86
  v_cvt_pk_bf16_f32 v202, v84, v85
  v_exp_f32 v87, v87
  v_exp_f32 v88, v88
  v_cvt_pk_bf16_f32 v203, v86, v87
  v_exp_f32 v89, v89
  s_waitcnt lgkmcnt(0)
  v_mfma_f32_32x32x16_bf16 v[160:175], a[76:79], v[196:199], v[160:175]
  v_exp_f32 v90, v90
  v_cvt_pk_bf16_f32 v204, v88, v89
  v_exp_f32 v91, v91
  s_mov_b64 exec, s[90:91]
  ds_read_b128 a[80:83], v11 offset:19456
  ds_read_b128 a[84:87], v11 offset:19968
  s_mov_b64 exec, -1
  v_exp_f32 v92, v92
  v_cvt_pk_bf16_f32 v205, v90, v91
  v_exp_f32 v93, v93
  v_exp_f32 v94, v94
  v_cvt_pk_bf16_f32 v206, v92, v93
  v_exp_f32 v95, v95
  s_nop 0
  v_cvt_pk_bf16_f32 v207, v94, v95
L_bk_34:
  s_lshr_b32 s72, s2, 2
  s_and_b32 s73, s2, 3
  s_mul_i32 s74, s73, 7
  s_min_u32 s75, s73, 1
  s_add_u32 s74, s74, s75
  s_cmp_eq_u32 s73, 0
  s_cselect_b32 s75, 8, 7
  s_lshl_b32 s80, s60, 10
  s_add_u32 s80, s80, 0
  v_add_u32 v120, s80, v2
  s_waitcnt vmcnt(9)
  ds_write_b128 v120, a[96:99] offset:0
  s_waitcnt vmcnt(8)
  ds_write_b128 v120, a[100:103] offset:4096
  s_waitcnt vmcnt(7)
  ds_write_b128 v120, a[104:107] offset:8192
  s_waitcnt vmcnt(6)
  ds_write_b128 v120, a[108:111] offset:12288
  s_waitcnt vmcnt(5)
  ds_write_b128 v120, a[112:115] offset:16384
  s_waitcnt vmcnt(4)
  ds_write_b128 v120, a[116:119] offset:20480
  s_waitcnt vmcnt(3)
  ds_write_b128 v120, a[120:123] offset:24576
  v_lshrrev_b32 v121, 4, v1
  v_lshlrev_b32 v121, 3, v121
  v_bfe_u32 v122, v1, 2, 2
  v_add_u32 v121, v121, v122
  v_and_b32 v122, 3, v1
  v_mul_u32_u24 v123, 800, v121
  v_lshl_add_u32 v123, v122, 3, v123
  s_lshl_b32 s80, s60, 5
  s_add_u32 s80, s80, 0
  v_add_u32 v123, s80, v123
  s_waitcnt lgkmcnt(0)
  s_barrier
  ds_read_b64_tr_b16 v[96:97], v123 offset:0
  ds_read_b64_tr_b16 v[98:99], v123 offset:3200
  ds_read_b64_tr_b16 v[100:101], v123 offset:128
  ds_read_b64_tr_b16 v[102:103], v123 offset:3328
  ds_read_b64_tr_b16 v[104:105], v123 offset:256
  ds_read_b64_tr_b16 v[106:107], v123 offset:3456
  ds_read_b64_tr_b16 v[108:109], v123 offset:384
  ds_read_b64_tr_b16 v[110:111], v123 offset:3584
  ds_read_b64_tr_b16 v[112:113], v123 offset:512
  ds_read_b64_tr_b16 v[114:115], v123 offset:3712
  ds_read_b64_tr_b16 v[116:117], v123 offset:640
  ds_read_b64_tr_b16 v[118:119], v123 offset:3840
  s_add_u32 s80, s60, 0
  s_mul_i32 s81, s80, 43
  s_lshr_b32 s81, s81, 7
  s_mul_i32 s82, s81, 3
  s_sub_u32 s82, s80, s82
  s_cmp_lt_u32 s81, s75
  s_cselect_b32 s85, 0, 0x70000000
  s_add_u32 s81, s81, s74
  s_lshl_b32 s81, s81, 6
  s_add_u32 s81, s81, s72
  s_mul_i32 s81, s81, 3
  s_add_u32 s81, s81, s82
  s_lshl_b32 s81, s81, 10
  s_add_u32 s81, s81, 24117248
  s_or_b32 s81, s81, s85
  s_waitcnt lgkmcnt(10)
  buffer_store_dwordx4 v[96:99], v2, s[16:19], s81 offen sc1
  s_add_u32 s80, s60, 4
  s_mul_i32 s81, s80, 43
  s_lshr_b32 s81, s81, 7
  s_mul_i32 s82, s81, 3
  s_sub_u32 s82, s80, s82
  s_cmp_lt_u32 s81, s75
  s_cselect_b32 s85, 0, 0x70000000
  s_add_u32 s81, s81, s74
  s_lshl_b32 s81, s81, 6
  s_add_u32 s81, s81, s72
  s_mul_i32 s81, s81, 3
  s_add_u32 s81, s81, s82
  s_lshl_b32 s81, s81, 10
  s_add_u32 s81, s81, 24117248
  s_or_b32 s81, s81, s85
  s_waitcnt lgkmcnt(8)
  buffer_store_dwordx4 v[100:103], v2, s[16:19], s81 offen sc1
  s_add_u32 s80, s60, 8
  s_mul_i32 s81, s80, 43
  s_lshr_b32 s81, s81, 7
  s_mul_i32 s82, s81, 3
  s_sub_u32 s82, s80, s82
  s_cmp_lt_u32 s81, s75
  s_cselect_b32 s85, 0, 0x70000000
  s_add_u32 s81, s81, s74
  s_lshl_b32 s81, s81, 6
  s_add_u32 s81, s81, s72
  s_mul_i32 s81, s81, 3
  s_add_u32 s81, s81, s82
  s_lshl_b32 s81, s81, 10
  s_add_u32 s81, s81, 24117248
  s_or_b32 s81, s81, s85
  s_waitcnt lgkmcnt(6)
  buffer_store_dwordx4 v[104:107], v2, s[16:19], s81 offen sc1
  s_add_u32 s80, s60, 12
  s_mul_i32 s81, s80, 43
  s_lshr_b32 s81, s81, 7
  s_mul_i32 s82, s81, 3
  s_sub_u32 s82, s80, s82
  s_cmp_lt_u32 s81, s75
  s_cselect_b32 s85, 0, 0x70000000
  s_add_u32 s81, s81, s74
  s_lshl_b32 s81, s81, 6
  s_add_u32 s81, s81, s72
  s_mul_i32 s81, s81, 3
  s_add_u32 s81, s81, s82
  s_lshl_b32 s81, s81, 10
  s_add_u32 s81, s81, 24117248
  s_or_b32 s81, s81, s85
  s_waitcnt lgkmcnt(4)
  buffer_store_dwordx4 v[108:111], v2, s[16:19], s81 offen sc1
  s_add_u32 s80, s60, 16
  s_mul_i32 s81, s80, 43
  s_lshr_b32 s81, s81, 7
  s_mul_i32 s82, s81, 3
  s_sub_u32 s82, s80, s82
  s_cmp_lt_u32 s81, s75
  s_cselect_b32 s85, 0, 0x70000000
  s_add_u32 s81, s81, s74
  s_lshl_b32 s81, s81, 6
  s_add_u32 s81, s81, s72
  s_mul_i32 s81, s81, 3
  s_add_u32 s81, s81, s82
  s_lshl_b32 s81, s81, 10
  s_add_u32 s81, s81, 24117248
  s_or_b32 s81, s81, s85
  s_waitcnt lgkmcnt(2)
  buffer_store_dwordx4 v[112:115], v2, s[16:19], s81 offen sc1
  s_add_u32 s80, s60, 20
  s_mul_i32 s81, s80, 43
  s_lshr_b32 s81, s81, 7
  s_mul_i32 s82, s81, 3
  s_sub_u32 s82, s80, s82
  s_cmp_lt_u32 s81, s75
  s_cselect_b32 s85, 0, 0x70000000
  s_add_u32 s81, s81, s74
  s_lshl_b32 s81, s81, 6
  s_add_u32 s81, s81, s72
  s_mul_i32 s81, s81, 3
  s_add_u32 s81, s81, s82
  s_lshl_b32 s81, s81, 10
  s_add_u32 s81, s81, 24117248
  s_or_b32 s81, s81, s85
  s_waitcnt lgkmcnt(0)
  buffer_store_dwordx4 v[116:119], v2, s[16:19], s81 offen sc1
  s_waitcnt lgkmcnt(0)
  s_barrier
  s_cmp_gt_u32 s77, 5
  s_cbranch_scc1 L_sk_35
  v_exp_f32 v64, v64
  v_exp_f32 v65, v65
  v_mfma_f32_32x32x16_bf16 v[80:95], a[44:47], v[228:231], v[144:159]
  v_exp_f32 v66, v66
  v_cvt_pk_bf16_f32 v192, v64, v65
  s_add_u32 m0, s79, 0
  s_add_u32 s72, s78, 0
  buffer_load_dwordx4 v19, s[12:15], s72 offen lds
  v_exp_f32 v67, v67
  v_exp_f32 v68, v68
  v_cvt_pk_bf16_f32 v193, v66, v67
  v_mfma_f32_32x32x16_bf16 v[176:191], a[80:83], v[200:203], v[176:191]
  v_exp_f32 v69, v69
  v_exp_f32 v70, v70
  v_cvt_pk_bf16_f32 v194, v68, v69
  v_exp_f32 v71, v71
  s_add_u32 m0, s79, 1024
  s_add_u32 s72, s78, 8192
  buffer_load_dwordx4 v19, s[12:15], s72 offen lds
  v_exp_f32 v72, v72
  v_cvt_pk_bf16_f32 v195, v70, v71
  v_exp_f32 v73, v73
  v_mfma_f32_32x32x16_bf16 v[176:191], a[84:87], v[204:207], v[176:191]
  v_exp_f32 v74, v74
  v_cvt_pk_bf16_f32 v196, v72, v73
  v_exp_f32 v75, v75
  s_mov_b64 exec, s[90:91]
  ds_read_b128 a[72:75], v11 offset:21504
  ds_read_b128 a[76:79], v11 offset:22016
  s_mov_b64 exec, -1
  v_exp_f32 v76, v76
  v_cvt_pk_bf16_f32 v197, v74, v75
  v_exp_f32 v77, v77
  v_exp_f32 v78, v78
  v_cvt_pk_bf16_f32 v198, v76, v77
  v_exp_f32 v79, v79
  s_nop 0
  v_cvt_pk_bf16_f32 v199, v78, v79
  v_exp_f32 v80, v80
  v_exp_f32 v81, v81
  v_mfma_f32_32x32x16_bf16 v[64:79], a[48:51], v[224:227], v[128:143]
  v_exp_f32 v82, v82
  v_cvt_pk_bf16_f32 v200, v80, v81
  s_add_u32 m0, s79, 2048
  s_add_u32 s72, s78, 16384
  buffer_load_dwordx4 v19, s[12:15], s72 offen lds
  v_exp_f32 v83, v83
  v_exp_f32 v84, v84
  v_cvt_pk_bf16_f32 v201, v82, v83
  s_waitcnt lgkmcnt(1)
  v_mfma_f32_32x32x16_bf16 v[160:175], a[72:75], v[192:195], v[160:175]
  v_exp_f32 v85, v85
  v_exp_f32 v86, v86
  v_cvt_pk_bf16_f32 v202, v84, v85
  v_exp_f32 v87, v87
  s_add_u32 m0, s79, 3072
  s_add_u32 s72, s78, 24576
  buffer_load_dwordx4 v19, s[12:15], s72 offen lds
  v_exp_f32 v88, v88
  v_cvt_pk_bf16_f32 v203, v86, v87
  v_exp_f32 v89, v89
  s_waitcnt lgkmcnt(0)
  v_mfma_f32_32x32x16_bf16 v[160:175], a[76:79], v[196:199], v[160:175]
  v_exp_f32 v90, v90
  v_cvt_pk_bf16_f32 v204, v88, v89
  v_exp_f32 v91, v91
  s_mov_b64 exec, s[90:91]
  ds_read_b128 a[80:83], v11 offset:23552
  ds_read_b128 a[84:87], v11 offset:24064
  s_mov_b64 exec, -1
  v_exp_f32 v92, v92
  v_cvt_pk_bf16_f32 v205, v90, v91
  v_exp_f32 v93, v93
  v_exp_f32 v94, v94
  v_cvt_pk_bf16_f32 v206, v92, v93
  v_exp_f32 v95, v95
  s_nop 0
  v_cvt_pk_bf16_f32 v207, v94, v95
L_bk_36:
  s_cmp_gt_u32 s77, 6
  s_cbranch_scc1 L_sk_37
  v_exp_f32 v64, v64
  v_exp_f32 v65, v65
  v_mfma_f32_32x32x16_bf16 v[80:95], a[52:55], v[228:231], v[144:159]
  v_exp_f32 v66, v66
  v_cvt_pk_bf16_f32 v192, v64, v65
  s_add_u32 m0, s79, 4096
  s_add_u32 s72, s78, 32768
  buffer_load_dwordx4 v19, s[12:15], s72 offen lds
  v_exp_f32 v67, v67
  v_exp_f32 v68, v68
  v_cvt_pk_bf16_f32 v193, v66, v67
  s_waitcnt lgkmcnt(1)
  v_mfma_f32_32x32x16_bf16 v[176:191], a[80:83], v[200:203], v[176:191]
  v_exp_f32 v69, v69
  v_exp_f32 v70, v70
  v_cvt_pk_bf16_f32 v194, v68, v69
  v_exp_f32 v71, v71
  s_add_u32 m0, s79, 5120
  s_add_u32 s72, s78, 40960
  buffer_load_dwordx4 v19, s[12:15], s72 offen lds
  v_exp_f32 v72, v72
  v_cvt_pk_bf16_f32 v195, v70, v71
  v_exp_f32 v73, v73
  s_waitcnt lgkmcnt(0)
  v_mfma_f32_32x32x16_bf16 v[176:191], a[84:87], v[204:207], v[176:191]
  v_exp_f32 v74, v74
  v_cvt_pk_bf16_f32 v196, v72, v73
  v_exp_f32 v75, v75
  s_mov_b64 exec, s[90:91]
  ds_read_b128 a[72:75], v11 offset:25600
  ds_read_b128 a[76:79], v11 offset:26112
  s_mov_b64 exec, -1
  v_exp_f32 v76, v76
  v_cvt_pk_bf16_f32 v197, v74, v75
  v_exp_f32 v77, v77
  v_exp_f32 v78, v78
  v_cvt_pk_bf16_f32 v198, v76, v77
  v_exp_f32 v79, v79
  s_nop 0
  v_cvt_pk_bf16_f32 v199, v78, v79
  v_exp_f32 v80, v80
  v_exp_f32 v81, v81
  v_mfma_f32_32x32x16_bf16 v[64:79], a[56:59], v[224:227], v[128:143]
  v_exp_f32 v82, v82
  v_cvt_pk_bf16_f32 v200, v80, v81
  s_add_u32 m0, s79, 6144
  s_add_u32 s72, s78, 49152
  buffer_load_dwordx4 v19, s[12:15], s72 offen lds
  v_exp_f32 v83, v83
  v_exp_f32 v84, v84
  v_cvt_pk_bf16_f32 v201, v82, v83
  s_waitcnt lgkmcnt(1)
  v_mfma_f32_32x32x16_bf16 v[160:175], a[72:75], v[192:195], v[160:175]
  v_exp_f32 v85, v85
  v_exp_f32 v86, v86
  v_cvt_pk_bf16_f32 v202, v84, v85
  v_exp_f32 v87, v87
  s_add_u32 m0, s79, 7168
  s_add_u32 s72, s78, 57344
  buffer_load_dwordx4 v19, s[12:15], s72 offen lds
  v_exp_f32 v88, v88
  v_cvt_pk_bf16_f32 v203, v86, v87
  v_exp_f32 v89, v89
  s_waitcnt lgkmcnt(0)
  v_mfma_f32_32x32x16_bf16 v[160:175], a[76:79], v[196:199], v[160:175]
  v_exp_f32 v90, v90
  v_cvt_pk_bf16_f32 v204, v88, v89
  v_exp_f32 v91, v91
  s_mov_b64 exec, s[90:91]
  ds_read_b128 a[80:83], v11 offset:27648
  ds_read_b128 a[84:87], v11 offset:28160
  s_mov_b64 exec, -1
  v_exp_f32 v92, v92
  v_cvt_pk_bf16_f32 v205, v90, v91
  v_exp_f32 v93, v93
  v_exp_f32 v94, v94
  v_cvt_pk_bf16_f32 v206, v92, v93
  v_exp_f32 v95, v95
  s_nop 0
  v_cvt_pk_bf16_f32 v207, v94, v95
L_bk_38:
  s_cmp_gt_u32 s77, 7
  s_cbranch_scc1 L_sk_39
  v_exp_f32 v64, v64
  v_exp_f32 v65, v65
  v_mfma_f32_32x32x16_bf16 v[80:95], a[60:63], v[228:231], v[144:159]
  v_exp_f32 v66, v66
  v_cvt_pk_bf16_f32 v192, v64, v65
  s_add_u32 m0, s79, 8192
  s_add_u32 s72, s78, 65536
  buffer_load_dwordx4 v19, s[12:15], s72 offen lds
  v_exp_f32 v67, v67
  v_exp_f32 v68, v68
  v_cvt_pk_bf16_f32 v193, v66, v67
  s_waitcnt lgkmcnt(1)
  v_mfma_f32_32x32x16_bf16 v[176:191], a[80:83], v[200:203], v[176:191]
  v_exp_f32 v69, v69
  v_exp_f32 v70, v70
  v_cvt_pk_bf16_f32 v194, v68, v69
  v_exp_f32 v71, v71
  s_add_u32 m0, s79, 9216
  s_add_u32 s72, s78, 73728
  buffer_load_dwordx4 v19, s[12:15], s72 offen lds
  v_exp_f32 v72, v72
  v_cvt_pk_bf16_f32 v195, v70, v71
  v_exp_f32 v73, v73
  s_waitcnt lgkmcnt(0)
  v_mfma_f32_32x32x16_bf16 v[176:191], a[84:87], v[204:207], v[176:191]
  v_exp_f32 v74, v74
  v_cvt_pk_bf16_f32 v196, v72, v73
  v_exp_f32 v75, v75
  s_mov_b64 exec, s[90:91]
  ds_read_b128 a[72:75], v11 offset:29696
  ds_read_b128 a[76:79], v11 offset:30208
  s_mov_b64 exec, -1
  v_exp_f32 v76, v76
  v_cvt_pk_bf16_f32 v197, v74, v75
  v_exp_f32 v77, v77
  v_exp_f32 v78, v78
  v_cvt_pk_bf16_f32 v198, v76, v77
  v_exp_f32 v79, v79
  s_nop 0
  v_cvt_pk_bf16_f32 v199, v78, v79
  v_exp_f32 v80, v80
  v_exp_f32 v81, v81
  v_mfma_f32_32x32x16_bf16 v[64:79], a[64:67], v[224:227], v[128:143]
  v_exp_f32 v82, v82
  v_cvt_pk_bf16_f32 v200, v80, v81
  s_add_u32 m0, s79, 10240
  s_add_u32 s72, s78, 81920
  buffer_load_dwordx4 v19, s[12:15], s72 offen lds
  v_exp_f32 v83, v83
  v_exp_f32 v84, v84
  v_cvt_pk_bf16_f32 v201, v82, v83
  s_waitcnt lgkmcnt(1)
  v_mfma_f32_32x32x16_bf16 v[160:175], a[72:75], v[192:195], v[160:175]
  v_exp_f32 v85, v85
  v_exp_f32 v86, v86
  v_cvt_pk_bf16_f32 v202, v84, v85
  v_exp_f32 v87, v87
  s_add_u32 m0, s79, 11264
  s_add_u32 s72, s78, 90112
  buffer_load_dwordx4 v19, s[12:15], s72 offen lds
  v_exp_f32 v88, v88
  v_cvt_pk_bf16_f32 v203, v86, v87
  v_exp_f32 v89, v89
  s_waitcnt lgkmcnt(0)
  v_mfma_f32_32x32x16_bf16 v[160:175], a[76:79], v[196:199], v[160:175]
  v_exp_f32 v90, v90
  v_cvt_pk_bf16_f32 v204, v88, v89
  v_exp_f32 v91, v91
  s_mov_b64 exec, s[90:91]
  ds_read_b128 a[80:83], v11 offset:31744
  ds_read_b128 a[84:87], v11 offset:32256
  s_mov_b64 exec, -1
  v_exp_f32 v92, v92
  v_cvt_pk_bf16_f32 v205, v90, v91
  v_exp_f32 v93, v93
  v_exp_f32 v94, v94
  v_cvt_pk_bf16_f32 v206, v92, v93
  v_exp_f32 v95, v95
  s_nop 0
  v_cvt_pk_bf16_f32 v207, v94, v95
L_bk_40:
  v_exp_f32 v64, v64
  v_exp_f32 v65, v65
  v_mfma_f32_32x32x16_bf16 v[80:95], a[68:71], v[228:231], v[144:159]
  v_exp_f32 v66, v66
  v_cvt_pk_bf16_f32 v192, v64, v65
  s_add_u32 m0, s79, 12288
  s_add_u32 s72, s78, 98304
  buffer_load_dwordx4 v19, s[12:15], s72 offen lds
  v_exp_f32 v67, v67
  v_exp_f32 v68, v68
  v_cvt_pk_bf16_f32 v193, v66, v67
  s_waitcnt lgkmcnt(1)
  v_mfma_f32_32x32x16_bf16 v[176:191], a[80:83], v[200:203], v[176:191]
  v_exp_f32 v69, v69
  v_exp_f32 v70, v70
  v_cvt_pk_bf16_f32 v194, v68, v69
  v_exp_f32 v71, v71
  s_add_u32 m0, s79, 13312
  s_add_u32 s72, s78, 106496
  buffer_load_dwordx4 v19, s[12:15], s72 offen lds
  v_exp_f32 v72, v72
  v_cvt_pk_bf16_f32 v195, v70, v71
  v_exp_f32 v73, v73
  s_waitcnt lgkmcnt(0)
  v_mfma_f32_32x32x16_bf16 v[176:191], a[84:87], v[204:207], v[176:191]
  v_exp_f32 v74, v74
  v_cvt_pk_bf16_f32 v196, v72, v73
  v_exp_f32 v75, v75
  s_mov_b64 exec, s[90:91]
  ds_read_b128 a[72:75], v11 offset:33792
  ds_read_b128 a[76:79], v11 offset:34304
  s_mov_b64 exec, -1
  v_exp_f32 v76, v76
  v_cvt_pk_bf16_f32 v197, v74, v75
  v_exp_f32 v77, v77
  v_exp_f32 v78, v78
  v_cvt_pk_bf16_f32 v198, v76, v77
  v_exp_f32 v79, v79
  s_nop 0
  v_cvt_pk_bf16_f32 v199, v78, v79
  v_and_b32 v192, v32, v192
  v_and_b32 v193, v33, v193
  v_and_b32 v194, v34, v194
  v_and_b32 v195, v35, v195
  v_and_b32 v196, v36, v196
  v_and_b32 v197, v37, v197
  v_and_b32 v198, v38, v198
  v_and_b32 v199, v39, v199
  v_exp_f32 v80, v80
  v_exp_f32 v81, v81
  v_exp_f32 v82, v82
  v_cvt_pk_bf16_f32 v200, v80, v81
  s_add_u32 m0, s79, 14336
  s_add_u32 s72, s78, 114688
  buffer_load_dwordx4 v19, s[12:15], s72 offen lds
  v_exp_f32 v83, v83
  v_exp_f32 v84, v84
  v_cvt_pk_bf16_f32 v201, v82, v83
  s_waitcnt lgkmcnt(1)
  v_mfma_f32_32x32x16_bf16 v[160:175], a[72:75], v[192:195], v[160:175]
  v_exp_f32 v85, v85
  v_exp_f32 v86, v86
  v_cvt_pk_bf16_f32 v202, v84, v85
  v_exp_f32 v87, v87
  s_add_u32 m0, s79, 15360
  s_add_u32 s72, s78, 122880
  buffer_load_dwordx4 v19, s[12:15], s72 offen lds
  v_exp_f32 v88, v88
  v_cvt_pk_bf16_f32 v203, v86, v87
  v_exp_f32 v89, v89
  s_waitcnt lgkmcnt(0)
  v_mfma_f32_32x32x16_bf16 v[160:175], a[76:79], v[196:199], v[160:175]
  v_exp_f32 v90, v90
  v_cvt_pk_bf16_f32 v204, v88, v89
  v_exp_f32 v91, v91
  s_mov_b64 exec, s[90:91]
  ds_read_b128 a[80:83], v11 offset:35840
  ds_read_b128 a[84:87], v11 offset:36352
  s_mov_b64 exec, -1
  v_exp_f32 v92, v92
  v_cvt_pk_bf16_f32 v205, v90, v91
  v_exp_f32 v93, v93
  v_exp_f32 v94, v94
  v_cvt_pk_bf16_f32 v206, v92, v93
  v_exp_f32 v95, v95
  s_nop 0
  v_cvt_pk_bf16_f32 v207, v94, v95
  v_and_b32 v200, v32, v200
  v_and_b32 v201, v33, v201
  v_and_b32 v202, v34, v202
  v_and_b32 v203, v35, v203
  v_and_b32 v204, v36, v204
  v_and_b32 v205, v37, v205
  v_and_b32 v206, v38, v206
  v_and_b32 v207, v39, v207
  s_waitcnt lgkmcnt(1)
  v_mfma_f32_32x32x16_bf16 v[176:191], a[80:83], v[200:203], v[176:191]
  s_waitcnt lgkmcnt(0)
  v_mfma_f32_32x32x16_bf16 v[176:191], a[84:87], v[204:207], v[176:191]
  v_rcp_f32 v52, v168
  s_nop 0
  v_mul_f32 v160, v52, v160
  v_mul_f32 v161, v52, v161
  v_mul_f32 v162, v52, v162
  v_mul_f32 v163, v52, v163
  v_mul_f32 v164, v52, v164
  v_mul_f32 v165, v52, v165
  v_mul_f32 v166, v52, v166
  v_mul_f32 v167, v52, v167
  v_cvt_pk_bf16_f32 v160, v160, v161
  v_cvt_pk_bf16_f32 v161, v162, v163
  v_cvt_pk_bf16_f32 v162, v164, v165
  v_cvt_pk_bf16_f32 v163, v166, v167
  v_rcp_f32 v52, v184
  s_nop 0
  v_mul_f32 v176, v52, v176
  v_mul_f32 v177, v52, v177
  v_mul_f32 v178, v52, v178
  v_mul_f32 v179, v52, v179
  v_mul_f32 v180, v52, v180
  v_mul_f32 v181, v52, v181
  v_mul_f32 v182, v52, v182
  v_mul_f32 v183, v52, v183
  v_cvt_pk_bf16_f32 v176, v176, v177
  v_cvt_pk_bf16_f32 v177, v178, v179
  v_cvt_pk_bf16_f32 v178, v180, v181
  v_cvt_pk_bf16_f32 v179, v182, v183
  s_cmp_eq_u32 s0, 0
  s_cbranch_scc1 L_slow_41
  buffer_store_dwordx4 v[160:163], v20, s[16:19], s89 offen offset:0
  buffer_store_dwordx4 v[176:179], v20, s[16:19], s89 offen offset:512
  s_branch L_dj_42
L_slow_41:
  buffer_store_dwordx4 v[160:163], v20, s[16:19], s89 offen offset:0 sc1
  buffer_store_dwordx4 v[176:179], v20, s[16:19], s89 offen offset:512 sc1
L_dj_42:
  s_barrier
  s_waitcnt vmcnt(0)
  s_barrier
  s_cmp_eq_u32 s60, 0
  s_cbranch_scc0 L_pub_43
  s_lshl_b32 s70, s61, 8
  s_add_u32 s70, s70, s2
  s_lshl_b32 s70, s70, 7
  s_add_u32 s70, s70, 69632
  v_mov_b32 v4, s62
  v_mov_b32 v5, s63
  v_mov_b32 v6, s70
  s_mov_b64 exec, 1
  s_cmp_eq_u32 s0, 0
  s_cbranch_scc1 L_slow_44
  buffer_store_dwordx2 v[4:5], v6, s[16:19], 0 offen
  s_branch L_dj_45
L_slow_44:
  buffer_store_dwordx2 v[4:5], v6, s[16:19], 0 offen sc1
L_dj_45:
  s_lshl_b32 s70, s61, 8
  s_add_u32 s70, s70, s2
  s_lshl_b32 s70, s70, 7
  s_add_u32 s70, s70, 331776
  v_mov_b32 v6, s70
  buffer_store_dwordx2 v[4:5], v6, s[16:19], 0 offen sc1
  s_mov_b64 exec, -1
L_pub_43:
  v_mov_b32 v8, s58
  v_and_b32 v9, 3, v8
  v_lshlrev_b32 v9, 3, v9
  v_add_u32 v9, v1, v9
  v_lshlrev_b32 v9, 3, v9
  v_lshrrev_b32 v7, 2, v8
  v_add_u32 v9, v9, v7
  s_lshl_b32 s70, s61, 15
  s_add_u32 s70, s70, 69632
  v_lshlrev_b32 v9, 7, v9
  v_add_u32 v9, s70, v9
  s_mov_b32 s76, 0xff
  s_mov_b32 s77, 0
  s_cmp_ge_u32 s65, 8
  s_cselect_b32 s72, 1, 0
  s_cmp_ge_u32 s65, 15
  s_addc_u32 s72, s72, 0
  s_cmp_ge_u32 s65, 22
  s_addc_u32 s72, s72, 0
  s_lshl_b32 s73, s60, 4
  s_sub_u32 s73, s73, 8
  v_add_u32 v8, s73, v1
  v_lshl_add_u32 v8, v8, 2, s72
  v_and_b32 v8, 255, v8
  v_lshlrev_b32 v8, 7, v8
  v_add_u32 v8, 331776, v8
  v_cmp_le_u32 vcc, 8, v1
  s_nop 1
  v_cndmask_b32 v9, v9, v8, vcc
  s_cmp_eq_u32 s66, 0
  s_cselect_b32 s76, s76, 0xffffff
  v_lshrrev_b32 v3, 5, v1
  v_lshlrev_b32 v3, 4, v3
  v_bfe_u32 v4, v1, 4, 1
  v_lshl_add_u32 v3, v4, 2, v3
  v_bfe_u32 v5, v1, 2, 2
  v_add_u32 v3, v3, v5
  v_bfe_u32 v5, v3, 1, 2
  v_and_b32 v6, 3, v1
  v_lshlrev_b32 v6, 3, v6
  v_lshl_add_u32 v6, v3, 7, v6
  v_xor_b32 v7, 0, v5
  v_lshl_add_u32 v10, v7, 5, v6
  v_xor_b32 v7, 1, v5
  v_lshl_add_u32 v11, v7, 5, v6
  v_xor_b32 v7, 2, v5
  v_lshl_add_u32 v12, v7, 5, v6
  v_xor_b32 v7, 3, v5
  v_lshl_add_u32 v13, v7, 5, v6
  ds_read_b64_tr_b16 v[128:129], v10 offset:0
  ds_read_b64_tr_b16 v[130:131], v10 offset:1024
  ds_read_b64_tr_b16 v[132:133], v11 offset:0
  ds_read_b64_tr_b16 v[134:135], v11 offset:1024
  ds_read_b64_tr_b16 v[136:137], v12 offset:0
  ds_read_b64_tr_b16 v[138:139], v12 offset:1024
  ds_read_b64_tr_b16 v[140:141], v13 offset:0
  ds_read_b64_tr_b16 v[142:143], v13 offset:1024
  ds_read_b64_tr_b16 v[144:145], v10 offset:4096
  ds_read_b64_tr_b16 v[146:147], v10 offset:5120
  ds_read_b64_tr_b16 v[148:149], v11 offset:4096
  ds_read_b64_tr_b16 v[150:151], v11 offset:5120
  ds_read_b64_tr_b16 v[152:153], v12 offset:4096
  ds_read_b64_tr_b16 v[154:155], v12 offset:5120
  ds_read_b64_tr_b16 v[156:157], v13 offset:4096
  ds_read_b64_tr_b16 v[158:159], v13 offset:5120
  ds_read_b64_tr_b16 v[160:161], v10 offset:8192
  ds_read_b64_tr_b16 v[162:163], v10 offset:9216
  ds_read_b64_tr_b16 v[164:165], v11 offset:8192
  ds_read_b64_tr_b16 v[166:167], v11 offset:9216
  ds_read_b64_tr_b16 v[168:169], v12 offset:8192
  ds_read_b64_tr_b16 v[170:171], v12 offset:9216
  ds_read_b64_tr_b16 v[172:173], v13 offset:8192
  ds_read_b64_tr_b16 v[174:175], v13 offset:9216
  ds_read_b64_tr_b16 v[176:177], v10 offset:12288
  ds_read_b64_tr_b16 v[178:179], v10 offset:13312
  ds_read_b64_tr_b16 v[180:181], v11 offset:12288
  ds_read_b64_tr_b16 v[182:183], v11 offset:13312
  ds_read_b64_tr_b16 v[184:185], v12 offset:12288
  ds_read_b64_tr_b16 v[186:187], v12 offset:13312
  ds_read_b64_tr_b16 v[188:189], v13 offset:12288
  ds_read_b64_tr_b16 v[190:191], v13 offset:13312
  ds_read_b64_tr_b16 v[192:193], v10 offset:16384
  ds_read_b64_tr_b16 v[194:195], v10 offset:17408
  ds_read_b64_tr_b16 v[196:197], v11 offset:16384
  ds_read_b64_tr_b16 v[198:199], v11 offset:17408
  ds_read_b64_tr_b16 v[200:201], v12 offset:16384
  ds_read_b64_tr_b16 v[202:203], v12 offset:17408
  ds_read_b64_tr_b16 v[204:205], v13 offset:16384
  ds_read_b64_tr_b16 v[206:207], v13 offset:17408
  ds_read_b64_tr_b16 v[208:209], v10 offset:20480
  ds_read_b64_tr_b16 v[210:211], v10 offset:21504
  ds_read_b64_tr_b16 v[212:213], v11 offset:20480
  ds_read_b64_tr_b16 v[214:215], v11 offset:21504
  ds_read_b64_tr_b16 v[216:217], v12 offset:20480
  ds_read_b64_tr_b16 v[218:219], v12 offset:21504
  ds_read_b64_tr_b16 v[220:221], v13 offset:20480
  ds_read_b64_tr_b16 v[222:223], v13 offset:21504
  ds_read_b64_tr_b16 v[224:225], v10 offset:24576
  ds_read_b64_tr_b16 v[226:227], v10 offset:25600
  ds_read_b64_tr_b16 v[228:229], v11 offset:24576
  ds_read_b64_tr_b16 v[230:231], v11 offset:25600
  ds_read_b64_tr_b16 v[232:233], v12 offset:24576
  ds_read_b64_tr_b16 v[234:235], v12 offset:25600
  ds_read_b64_tr_b16 v[236:237], v13 offset:24576
  ds_read_b64_tr_b16 v[238:239], v13 offset:25600
  ds_read_b64_tr_b16 v[240:241], v10 offset:28672
  ds_read_b64_tr_b16 v[242:243], v10 offset:29696
  ds_read_b64_tr_b16 v[244:245], v11 offset:28672
  ds_read_b64_tr_b16 v[246:247], v11 offset:29696
  ds_read_b64_tr_b16 v[248:249], v12 offset:28672
  ds_read_b64_tr_b16 v[250:251], v12 offset:29696
  ds_read_b64_tr_b16 v[252:253], v13 offset:28672
  ds_read_b64_tr_b16 v[254:255], v13 offset:29696
  s_mov_b64 exec, s[76:77]
  s_mov_b32 s100, 0
  s_cbranch_execz L_pok_47
L_poll_46:
  buffer_load_dwordx2 v[4:5], v9, s[16:19], 0 offen sc1
  s_waitcnt vmcnt(0)
  v_cmp_ne_u64 vcc, s[62:63], v[4:5]
  s_nop 0
  s_cbranch_vccz L_pok_47
  s_add_u32 s100, s100, 1
  s_cmp_lt_u32 s100, 400000
  s_cbranch_scc1 L_poll_46
  s_branch L_fail
L_pok_47:
  s_mov_b64 exec, -1
  s_waitcnt vmcnt(0) lgkmcnt(0)
  s_lshl_b32 s72, s58, 2
  s_add_u32 s72, s72, s60
  s_lshl_b32 s72, s72, 14
  s_lshl_b32 s73, s61, 21
  s_add_u32 s72, s72, s73
  s_add_u32 s74, s72, 9437184
  s_add_u32 s73, s74, 0
  buffer_load_dwordx4 v[64:67], v2, s[16:19], s73 offen offset:0 sc1
  buffer_load_dwordx4 v[68:71], v2, s[16:19], s73 offen offset:1024 sc1
  buffer_load_dwordx4 v[72:75], v2, s[16:19], s73 offen offset:2048 sc1
  buffer_load_dwordx4 v[76:79], v2, s[16:19], s73 offen offset:3072 sc1
  s_add_u32 s73, s74, 4096
  buffer_load_dwordx4 v[80:83], v2, s[16:19], s73 offen offset:0 sc1
  buffer_load_dwordx4 v[84:87], v2, s[16:19], s73 offen offset:1024 sc1
  buffer_load_dwordx4 v[88:91], v2, s[16:19], s73 offen offset:2048 sc1
  buffer_load_dwordx4 v[92:95], v2, s[16:19], s73 offen offset:3072 sc1
  s_add_u32 s73, s74, 8192
  buffer_load_dwordx4 v[96:99], v2, s[16:19], s73 offen offset:0 sc1
  buffer_load_dwordx4 v[100:103], v2, s[16:19], s73 offen offset:1024 sc1
  buffer_load_dwordx4 v[104:107], v2, s[16:19], s73 offen offset:2048 sc1
  s_cmp_eq_u32 s66, 0
  s_cbranch_scc1 L_oa_48
  s_lshl_b32 s76, s65, 6
  s_lshl_b32 s77, s60, 4
  s_add_u32 s76, s76, s77
  s_mul_i32 s76, s76, 3072
  s_add_u32 s76, s76, 24117248
  s_add_u32 s73, s74, 8192
  buffer_load_dwordx4 v[108:111], v2, s[16:19], s73 offen offset:3072 sc1
  s_waitcnt vmcnt(11)
  v_mfma_f32_16x16x32_bf16 v[46:49], v[128:131], v[64:67], 0
  v_mfma_f32_16x16x32_bf16 v[50:53], v[132:135], v[64:67], 0
  v_mfma_f32_16x16x32_bf16 v[54:57], v[136:139], v[64:67], 0
  v_mfma_f32_16x16x32_bf16 v[58:61], v[140:143], v[64:67], 0
  s_add_u32 s73, s74, 12288
  buffer_load_dwordx4 v[112:115], v2, s[16:19], s73 offen offset:0 sc1
  s_waitcnt vmcnt(11)
  v_mfma_f32_16x16x32_bf16 v[46:49], v[144:147], v[68:71], v[46:49]
  v_mfma_f32_16x16x32_bf16 v[50:53], v[148:151], v[68:71], v[50:53]
  v_mfma_f32_16x16x32_bf16 v[54:57], v[152:155], v[68:71], v[54:57]
  v_mfma_f32_16x16x32_bf16 v[58:61], v[156:159], v[68:71], v[58:61]
  buffer_load_dwordx4 v[116:119], v2, s[16:19], s73 offen offset:1024 sc1
  s_waitcnt vmcnt(11)
  v_mfma_f32_16x16x32_bf16 v[46:49], v[160:163], v[72:75], v[46:49]
  v_mfma_f32_16x16x32_bf16 v[50:53], v[164:167], v[72:75], v[50:53]
  v_mfma_f32_16x16x32_bf16 v[54:57], v[168:171], v[72:75], v[54:57]
  v_mfma_f32_16x16x32_bf16 v[58:61], v[172:175], v[72:75], v[58:61]
  buffer_load_dwordx4 v[120:123], v2, s[16:19], s73 offen offset:2048 sc1
  s_waitcnt vmcnt(11)
  v_mfma_f32_16x16x32_bf16 v[46:49], v[176:179], v[76:79], v[46:49]
  v_mfma_f32_16x16x32_bf16 v[50:53], v[180:183], v[76:79], v[50:53]
  v_mfma_f32_16x16x32_bf16 v[54:57], v[184:187], v[76:79], v[54:57]
  v_mfma_f32_16x16x32_bf16 v[58:61], v[188:191], v[76:79], v[58:61]
  buffer_load_dwordx4 v[124:127], v2, s[16:19], s73 offen offset:3072 sc1
  s_waitcnt vmcnt(11)
  v_mfma_f32_16x16x32_bf16 v[46:49], v[192:195], v[80:83], v[46:49]
  v_mfma_f32_16x16x32_bf16 v[50:53], v[196:199], v[80:83], v[50:53]
  s_add_u32 s77, s76, 0
  buffer_load_dwordx4 a[0:3], v2, s[16:19], s77 offen offset:0 sc1
  s_add_u32 s77, s76, 0
  buffer_load_dwordx4 a[4:7], v2, s[16:19], s77 offen offset:1024 sc1
  v_mfma_f32_16x16x32_bf16 v[54:57], v[200:203], v[80:83], v[54:57]
  v_mfma_f32_16x16x32_bf16 v[58:61], v[204:207], v[80:83], v[58:61]
  s_waitcnt vmcnt(12)
  v_mfma_f32_16x16x32_bf16 v[46:49], v[208:211], v[84:87], v[46:49]
  v_mfma_f32_16x16x32_bf16 v[50:53], v[212:215], v[84:87], v[50:53]
  s_add_u32 s77, s76, 0
  buffer_load_dwordx4 a[8:11], v2, s[16:19], s77 offen offset:2048 sc1
  s_add_u32 s77, s76, 3072
  buffer_load_dwordx4 a[12:15], v2, s[16:19], s77 offen offset:0 sc1
  v_mfma_f32_16x16x32_bf16 v[54:57], v[216:219], v[84:87], v[54:57]
  v_mfma_f32_16x16x32_bf16 v[58:61], v[220:223], v[84:87], v[58:61]
  s_waitcnt vmcnt(13)
  v_mfma_f32_16x16x32_bf16 v[46:49], v[224:227], v[88:91], v[46:49]
  ds_read_b64_tr_b16 v[14:15], v10 offset:32768
  ds_read_b64_tr_b16 v[16:17], v10 offset:33792
  v_mfma_f32_16x16x32_bf16 v[50:53], v[228:231], v[88:91], v[50:53]
  ds_read_b64_tr_b16 v[18:19], v11 offset:32768
  ds_read_b64_tr_b16 v[20:21], v11 offset:33792
  s_add_u32 s77, s76, 3072
  buffer_load_dwordx4 a[16:19], v2, s[16:19], s77 offen offset:1024 sc1
  s_add_u32 s77, s76, 3072
  buffer_load_dwordx4 a[20:23], v2, s[16:19], s77 offen offset:2048 sc1
  v_mfma_f32_16x16x32_bf16 v[54:57], v[232:235], v[88:91], v[54:57]
  ds_read_b64_tr_b16 v[22:23], v12 offset:32768
  ds_read_b64_tr_b16 v[24:25], v12 offset:33792
  v_mfma_f32_16x16x32_bf16 v[58:61], v[236:239], v[88:91], v[58:61]
  ds_read_b64_tr_b16 v[26:27], v13 offset:32768
  ds_read_b64_tr_b16 v[28:29], v13 offset:33792
  s_waitcnt vmcnt(14)
  v_mfma_f32_16x16x32_bf16 v[46:49], v[240:243], v[92:95], v[46:49]
  ds_read_b64_tr_b16 v[30:31], v10 offset:36864
  ds_read_b64_tr_b16 v[32:33], v10 offset:37888
  v_mfma_f32_16x16x32_bf16 v[50:53], v[244:247], v[92:95], v[50:53]
  ds_read_b64_tr_b16 v[34:35], v11 offset:36864
  ds_read_b64_tr_b16 v[36:37], v11 offset:37888
  s_add_u32 s77, s76, 6144
  buffer_load_dwordx4 a[24:27], v2, s[16:19], s77 offen offset:0 sc1
  s_add_u32 s77, s76, 6144
  buffer_load_dwordx4 a[28:31], v2, s[16:19], s77 offen offset:1024 sc1
  v_mfma_f32_16x16x32_bf16 v[54:57], v[248:251], v[92:95], v[54:57]
  ds_read_b64_tr_b16 v[38:39], v12 offset:36864
  ds_read_b64_tr_b16 v[40:41], v12 offset:37888
  v_mfma_f32_16x16x32_bf16 v[58:61], v[252:255], v[92:95], v[58:61]
  ds_read_b64_tr_b16 v[42:43], v13 offset:36864
  ds_read_b64_tr_b16 v[44:45], v13 offset:37888
  s_waitcnt vmcnt(15) lgkmcnt(14)
  v_mfma_f32_16x16x32_bf16 v[46:49], v[14:17], v[96:99], v[46:49]
  ds_read_b64_tr_b16 v[14:15], v10 offset:40960
  ds_read_b64_tr_b16 v[16:17], v10 offset:41984
  s_waitcnt lgkmcnt(14)
  v_mfma_f32_16x16x32_bf16 v[50:53], v[18:21], v[96:99], v[50:53]
  ds_read_b64_tr_b16 v[18:19], v11 offset:40960
  ds_read_b64_tr_b16 v[20:21], v11 offset:41984
  s_add_u32 s77, s76, 6144
  buffer_load_dwordx4 a[32:35], v2, s[16:19], s77 offen offset:2048 sc1
  s_add_u32 s77, s76, 9216
  buffer_load_dwordx4 a[36:39], v2, s[16:19], s77 offen offset:0 sc1
  s_waitcnt lgkmcnt(14)
  v_mfma_f32_16x16x32_bf16 v[54:57], v[22:25], v[96:99], v[54:57]
  ds_read_b64_tr_b16 v[22:23], v12 offset:40960
  ds_read_b64_tr_b16 v[24:25], v12 offset:41984
  s_waitcnt lgkmcnt(14)
  v_mfma_f32_16x16x32_bf16 v[58:61], v[26:29], v[96:99], v[58:61]
  ds_read_b64_tr_b16 v[26:27], v13 offset:40960
  ds_read_b64_tr_b16 v[28:29], v13 offset:41984
  s_waitcnt vmcnt(16) lgkmcnt(14)
  v_mfma_f32_16x16x32_bf16 v[46:49], v[30:33], v[100:103], v[46:49]
  ds_read_b64_tr_b16 v[30:31], v10 offset:45056
  ds_read_b64_tr_b16 v[32:33], v10 offset:46080
  s_waitcnt lgkmcnt(14)
  v_mfma_f32_16x16x32_bf16 v[50:53], v[34:37], v[100:103], v[50:53]
  ds_read_b64_tr_b16 v[34:35], v11 offset:45056
  ds_read_b64_tr_b16 v[36:37], v11 offset:46080
  s_add_u32 s77, s76, 9216
  buffer_load_dwordx4 a[40:43], v2, s[16:19], s77 offen offset:1024 sc1
  s_add_u32 s77, s76, 9216
  buffer_load_dwordx4 a[44:47], v2, s[16:19], s77 offen offset:2048 sc1
  s_waitcnt lgkmcnt(14)
  v_mfma_f32_16x16x32_bf16 v[54:57], v[38:41], v[100:103], v[54:57]
  ds_read_b64_tr_b16 v[38:39], v12 offset:45056
  ds_read_b64_tr_b16 v[40:41], v12 offset:46080
  s_waitcnt lgkmcnt(14)
  v_mfma_f32_16x16x32_bf16 v[58:61], v[42:45], v[100:103], v[58:61]
  ds_read_b64_tr_b16 v[42:43], v13 offset:45056
  ds_read_b64_tr_b16 v[44:45], v13 offset:46080
  s_waitcnt vmcnt(17) lgkmcnt(14)
  v_mfma_f32_16x16x32_bf16 v[46:49], v[14:17], v[104:107], v[46:49]
  ds_read_b64_tr_b16 v[14:15], v10 offset:49152
  ds_read_b64_tr_b16 v[16:17], v10 offset:50176
  s_waitcnt lgkmcnt(14)
  v_mfma_f32_16x16x32_bf16 v[50:53], v[18:21], v[104:107], v[50:53]
  ds_read_b64_tr_b16 v[18:19], v11 offset:49152
  ds_read_b64_tr_b16 v[20:21], v11 offset:50176
  s_add_u32 s77, s76, 12288
  buffer_load_dwordx4 a[48:51], v2, s[16:19], s77 offen offset:0 sc1
  s_add_u32 s77, s76, 12288
  buffer_load_dwordx4 a[52:55], v2, s[16:19], s77 offen offset:1024 sc1
  s_waitcnt lgkmcnt(14)
  v_mfma_f32_16x16x32_bf16 v[54:57], v[22:25], v[104:107], v[54:57]
  ds_read_b64_tr_b16 v[22:23], v12 offset:49152
  ds_read_b64_tr_b16 v[24:25], v12 offset:50176
  s_waitcnt lgkmcnt(14)
  v_mfma_f32_16x16x32_bf16 v[58:61], v[26:29], v[104:107], v[58:61]
  ds_read_b64_tr_b16 v[26:27], v13 offset:49152
  ds_read_b64_tr_b16 v[28:29], v13 offset:50176
  s_waitcnt vmcnt(18) lgkmcnt(14)
  v_mfma_f32_16x16x32_bf16 v[46:49], v[30:33], v[108:111], v[46:49]
  ds_read_b64_tr_b16 v[30:31], v10 offset:53248
  ds_read_b64_tr_b16 v[32:33], v10 offset:54272
  s_waitcnt lgkmcnt(14)
  v_mfma_f32_16x16x32_bf16 v[50:53], v[34:37], v[108:111], v[50:53]
  ds_read_b64_tr_b16 v[34:35], v11 offset:53248
  ds_read_b64_tr_b16 v[36:37], v11 offset:54272
  s_add_u32 s77, s76, 12288
  buffer_load_dwordx4 a[56:59], v2, s[16:19], s77 offen offset:2048 sc1
  s_add_u32 s77, s76, 15360
  buffer_load_dwordx4 a[60:63], v2, s[16:19], s77 offen offset:0 sc1
  s_waitcnt lgkmcnt(14)
  v_mfma_f32_16x16x32_bf16 v[54:57], v[38:41], v[108:111], v[54:57]
  ds_read_b64_tr_b16 v[38:39], v12 offset:53248
  ds_read_b64_tr_b16 v[40:41], v12 offset:54272
  s_waitcnt lgkmcnt(14)
  v_mfma_f32_16x16x32_bf16 v[58:61], v[42:45], v[108:111], v[58:61]
  ds_read_b64_tr_b16 v[42:43], v13 offset:53248
  ds_read_b64_tr_b16 v[44:45], v13 offset:54272
  s_waitcnt vmcnt(19) lgkmcnt(14)
  v_mfma_f32_16x16x32_bf16 v[46:49], v[14:17], v[112:115], v[46:49]
  ds_read_b64_tr_b16 v[14:15], v10 offset:57344
  ds_read_b64_tr_b16 v[16:17], v10 offset:58368
  s_waitcnt lgkmcnt(14)
  v_mfma_f32_16x16x32_bf16 v[50:53], v[18:21], v[112:115], v[50:53]
  ds_read_b64_tr_b16 v[18:19], v11 offset:57344
  ds_read_b64_tr_b16 v[20:21], v11 offset:58368
  s_waitcnt lgkmcnt(14)
  v_mfma_f32_16x16x32_bf16 v[54:57], v[22:25], v[112:115], v[54:57]
  ds_read_b64_tr_b16 v[22:23], v12 offset:57344
  ds_read_b64_tr_b16 v[24:25], v12 offset:58368
  s_waitcnt lgkmcnt(14)
  v_mfma_f32_16x16x32_bf16 v[58:61], v[26:29], v[112:115], v[58:61]
  ds_read_b64_tr_b16 v[26:27], v13 offset:57344
  ds_read_b64_tr_b16 v[28:29], v13 offset:58368
  s_waitcnt vmcnt(18) lgkmcnt(14)
  v_mfma_f32_16x16x32_bf16 v[46:49], v[30:33], v[116:119], v[46:49]
  ds_read_b64_tr_b16 v[30:31], v10 offset:61440
  ds_read_b64_tr_b16 v[32:33], v10 offset:62464
  s_waitcnt lgkmcnt(14)
  v_mfma_f32_16x16x32_bf16 v[50:53], v[34:37], v[116:119], v[50:53]
  ds_read_b64_tr_b16 v[34:35], v11 offset:61440
  ds_read_b64_tr_b16 v[36:37], v11 offset:62464
  s_waitcnt lgkmcnt(14)
  v_mfma_f32_16x16x32_bf16 v[54:57], v[38:41], v[116:119], v[54:57]
  ds_read_b64_tr_b16 v[38:39], v12 offset:61440
  ds_read_b64_tr_b16 v[40:41], v12 offset:62464
  s_waitcnt lgkmcnt(14)
  v_mfma_f32_16x16x32_bf16 v[58:61], v[42:45], v[116:119], v[58:61]
  ds_read_b64_tr_b16 v[42:43], v13 offset:61440
  ds_read_b64_tr_b16 v[44:45], v13 offset:62464
  s_waitcnt vmcnt(17) lgkmcnt(14)
  v_mfma_f32_16x16x32_bf16 v[46:49], v[14:17], v[120:123], v[46:49]
  s_waitcnt lgkmcnt(12)
  v_mfma_f32_16x16x32_bf16 v[50:53], v[18:21], v[120:123], v[50:53]
  s_waitcnt lgkmcnt(10)
  v_mfma_f32_16x16x32_bf16 v[54:57], v[22:25], v[120:123], v[54:57]
  s_waitcnt lgkmcnt(8)
  v_mfma_f32_16x16x32_bf16 v[58:61], v[26:29], v[120:123], v[58:61]
  s_waitcnt vmcnt(16) lgkmcnt(6)
  v_mfma_f32_16x16x32_bf16 v[46:49], v[30:33], v[124:127], v[46:49]
  s_waitcnt lgkmcnt(4)
  v_mfma_f32_16x16x32_bf16 v[50:53], v[34:37], v[124:127], v[50:53]
  s_waitcnt lgkmcnt(2)
  v_mfma_f32_16x16x32_bf16 v[54:57], v[38:41], v[124:127], v[54:57]
  s_waitcnt lgkmcnt(0)
  v_mfma_f32_16x16x32_bf16 v[58:61], v[42:45], v[124:127], v[58:61]
L_ob_49:
  v_and_b32 v3, 15, v1
  s_lshl_b32 s72, s60, 4
  v_add_u32 v14, s72, v3
  v_lshrrev_b32 v4, 4, v1
  v_mul_u32_u24 v5, 144, v14
  v_lshl_add_u32 v5, v4, 3, v5
  v_add_u32 v15, 147456, v5
  ds_read_b64 v[176:177], v15 offset:0
  ds_read_b64 v[178:179], v15 offset:32
  ds_read_b64 v[180:181], v15 offset:64
  ds_read_b64 v[182:183], v15 offset:96
  s_waitcnt lgkmcnt(3)
  v_lshlrev_b32 v192, 16, v176
  v_and_b32 v193, 0xffff0000, v176
  v_lshlrev_b32 v194, 16, v177
  v_and_b32 v195, 0xffff0000, v177
  s_waitcnt lgkmcnt(2)
  v_lshlrev_b32 v196, 16, v178
  v_and_b32 v197, 0xffff0000, v178
  v_lshlrev_b32 v198, 16, v179
  v_and_b32 v199, 0xffff0000, v179
  s_waitcnt lgkmcnt(1)
  v_lshlrev_b32 v200, 16, v180
  v_and_b32 v201, 0xffff0000, v180
  v_lshlrev_b32 v202, 16, v181
  v_and_b32 v203, 0xffff0000, v181
  s_waitcnt lgkmcnt(0)
  v_lshlrev_b32 v204, 16, v182
  v_and_b32 v205, 0xffff0000, v182
  v_lshlrev_b32 v206, 16, v183
  v_and_b32 v207, 0xffff0000, v183
  v_add_f32 v192, v192, v46
  v_add_f32 v193, v193, v47
  v_add_f32 v194, v194, v48
  v_add_f32 v195, v195, v49
  v_add_f32 v196, v196, v50
  v_add_f32 v197, v197, v51
  v_add_f32 v198, v198, v52
  v_add_f32 v199, v199, v53
  v_add_f32 v200, v200, v54
  v_add_f32 v201, v201, v55
  v_add_f32 v202, v202, v56
  v_add_f32 v203, v203, v57
  v_add_f32 v204, v204, v58
  v_add_f32 v205, v205, v59
  v_add_f32 v206, v206, v60
  v_add_f32 v207, v207, v61
  v_cvt_pk_bf16_f32 v176, v192, v193
  v_cvt_pk_bf16_f32 v177, v194, v195
  v_cvt_pk_bf16_f32 v178, v196, v197
  v_cvt_pk_bf16_f32 v179, v198, v199
  v_cvt_pk_bf16_f32 v180, v200, v201
  v_cvt_pk_bf16_f32 v181, v202, v203
  v_cvt_pk_bf16_f32 v182, v204, v205
  v_cvt_pk_bf16_f32 v183, v206, v207
  ds_write_b64 v15, v[176:177] offset:0
  ds_write_b64 v15, v[178:179] offset:32
  ds_write_b64 v15, v[180:181] offset:64
  ds_write_b64 v15, v[182:183] offset:96
  v_add_f32 v16, v192, v193
  v_mul_f32 v17, v192, v192
  v_fmac_f32 v17, v193, v193
  v_add_f32 v16, v16, v194
  v_fmac_f32 v17, v194, v194
  v_add_f32 v16, v16, v195
  v_fmac_f32 v17, v195, v195
  v_add_f32 v16, v16, v196
  v_fmac_f32 v17, v196, v196
  v_add_f32 v16, v16, v197
  v_fmac_f32 v17, v197, v197
  v_add_f32 v16, v16, v198
  v_fmac_f32 v17, v198, v198
  v_add_f32 v16, v16, v199
  v_fmac_f32 v17, v199, v199
  v_add_f32 v16, v16, v200
  v_fmac_f32 v17, v200, v200
  v_add_f32 v16, v16, v201
  v_fmac_f32 v17, v201, v201
  v_add_f32 v16, v16, v202
  v_fmac_f32 v17, v202, v202
  v_add_f32 v16, v16, v203
  v_fmac_f32 v17, v203, v203
  v_add_f32 v16, v16, v204
  v_fmac_f32 v17, v204, v204
  v_add_f32 v16, v16, v205
  v_fmac_f32 v17, v205, v205
  v_add_f32 v16, v16, v206
  v_fmac_f32 v17, v206, v206
  v_add_f32 v16, v16, v207
  v_fmac_f32 v17, v207, v207
  v_mov_b32 v20, v16
  v_mov_b32 v21, v17
  s_nop 0
  v_permlane16_swap_b32 v16, v20
  v_permlane16_swap_b32 v17, v21
  v_add_f32 v16, v16, v20
  v_add_f32 v17, v17, v21
  v_mov_b32 v20, v16
  v_mov_b32 v21, v17
  s_nop 0
  v_permlane32_swap_b32 v16, v20
  v_permlane32_swap_b32 v17, v21
  v_add_f32 v16, v16, v20
  v_add_f32 v17, v17, v21
  v_mov_b32 v18, s62
  v_mov_b32 v19, s63
  s_lshl_b32 s72, s61, 5
  s_add_u32 s72, s72, s58
  s_lshl_b32 s72, s72, 13
  s_add_u32 s72, s72, 524288
  s_lshl_b32 s73, s59, 10
  s_add_u32 s73, s73, s72
  v_lshlrev_b32 v22, 4, v14
  s_mov_b64 exec, 0xffff
  s_cmp_eq_u32 s0, 0
  s_cbranch_scc1 L_slow_50
  buffer_store_dwordx4 v[16:19], v22, s[16:19], s73 offen
  s_branch L_dj_51
L_slow_50:
  buffer_store_dwordx4 v[16:19], v22, s[16:19], s73 offen sc1
L_dj_51:
  s_mov_b64 exec, -1
  v_lshrrev_b32 v4, 4, v1
  s_lshl_b32 s72, s61, 5
  s_add_u32 s72, s72, s58
  s_lshl_b32 s72, s72, 13
  s_add_u32 s72, s72, 524288
  v_lshl_add_u32 v23, v4, 11, v22
  s_mov_b32 s100, 0
L_stp_52:
  buffer_load_dwordx4 v[24:27], v23, s[16:19], s72 offen sc1
  buffer_load_dwordx4 v[28:31], v23, s[16:19], s72 offen offset:1024 sc1
  s_waitcnt vmcnt(0)
  v_cmp_ne_u64 vcc, s[62:63], v[26:27]
  v_cmp_ne_u64 s[74:75], s[62:63], v[30:31]
  s_or_b64 vcc, vcc, s[74:75]
  s_cbranch_vccz L_sto_53
  s_add_u32 s100, s100, 1
  s_cmp_lt_u32 s100, 400000
  s_cbranch_scc1 L_stp_52
  s_branch L_fail
L_sto_53:
  s_lshl_b32 s90, s65, 6
  s_lshl_b32 s91, s60, 4
  s_add_u32 s90, s90, s91
  s_mul_i32 s90, s90, 3072
  s_add_u32 s90, s90, 24117248
  s_cmp_eq_u32 s66, 0
  s_cselect_b32 s90, 0x70000000, s90
  s_add_u32 s91, s90, 15360
  buffer_load_dwordx4 a[64:67], v2, s[16:19], s91 offen offset:1024 sc1
  v_add_f32 v16, v24, v28
  v_add_f32 v17, v25, v29
  v_mov_b32 v20, v16
  v_mov_b32 v21, v17
  s_nop 0
  v_permlane16_swap_b32 v16, v20
  v_permlane16_swap_b32 v17, v21
  v_add_f32 v16, v16, v20
  buffer_load_dwordx4 a[68:71], v2, s[16:19], s91 offen offset:2048 sc1
  v_add_f32 v17, v17, v21
  v_mov_b32 v20, v16
  v_mov_b32 v21, v17
  s_nop 0
  v_permlane32_swap_b32 v16, v20
  v_permlane32_swap_b32 v17, v21
  v_add_f32 v16, v16, v20
  v_add_f32 v17, v17, v21
  s_add_u32 s91, s90, 18432
  buffer_load_dwordx4 a[72:75], v2, s[16:19], s91 offen offset:0 sc1
  v_mul_f32 v16, 0x3b000000, v16
  v_mul_f32 v17, 0x3b000000, v17
  v_fma_f32 v17, -v16, v16, v17
  v_max_f32 v17, 0, v17
  v_add_f32 v18, 0x3727c5ac, v17
  v_rsq_f32 v18, v18
  s_nop 0
  v_mul_f32 v19, v18, v18
  buffer_load_dwordx4 a[76:79], v2, s[16:19], s91 offen offset:1024 sc1
  v_mul_f32 v19, v19, v17
  v_add_f32 v19, 0x3727c5ac, v19
  v_rsq_f32 v19, v19
  s_nop 0
  v_mul_f32 v18, v18, v19
  v_sub_f32 v192, v192, v16
  v_sub_f32 v193, v193, v16
  v_sub_f32 v194, v194, v16
  buffer_load_dwordx4 a[80:83], v2, s[16:19], s91 offen offset:2048 sc1
  v_sub_f32 v195, v195, v16
  v_sub_f32 v196, v196, v16
  v_sub_f32 v197, v197, v16
  v_sub_f32 v198, v198, v16
  v_sub_f32 v199, v199, v16
  v_sub_f32 v200, v200, v16
  v_sub_f32 v201, v201, v16
  s_add_u32 s91, s90, 21504
  buffer_load_dwordx4 a[84:87], v2, s[16:19], s91 offen offset:0 sc1
  v_sub_f32 v202, v202, v16
  v_sub_f32 v203, v203, v16
  v_sub_f32 v204, v204, v16
  v_sub_f32 v205, v205, v16
  v_sub_f32 v206, v206, v16
  v_sub_f32 v207, v207, v16
  v_mul_f32 v192, v18, v192
  buffer_load_dwordx4 a[88:91], v2, s[16:19], s91 offen offset:1024 sc1
  v_mul_f32 v193, v18, v193
  v_mul_f32 v194, v18, v194
  v_mul_f32 v195, v18, v195
  v_mul_f32 v196, v18, v196
  v_mul_f32 v197, v18, v197
  v_mul_f32 v198, v18, v198
  v_mul_f32 v199, v18, v199
  buffer_load_dwordx4 a[92:95], v2, s[16:19], s91 offen offset:2048 sc1
  v_mul_f32 v200, v18, v200
  v_mul_f32 v201, v18, v201
  v_mul_f32 v202, v18, v202
  v_mul_f32 v203, v18, v203
  v_mul_f32 v204, v18, v204
  v_mul_f32 v205, v18, v205
  v_mul_f32 v206, v18, v206
  s_add_u32 s91, s90, 24576
  buffer_load_dwordx4 a[96:99], v2, s[16:19], s91 offen offset:0 sc1
  v_mul_f32 v207, v18, v207
  v_cvt_pk_bf16_f32 v176, v192, v193
  v_cvt_pk_bf16_f32 v177, v194, v195
  v_cvt_pk_bf16_f32 v178, v196, v197
  v_cvt_pk_bf16_f32 v179, v198, v199
  v_cvt_pk_bf16_f32 v180, v200, v201
  v_cvt_pk_bf16_f32 v181, v202, v203
  buffer_load_dwordx4 a[100:103], v2, s[16:19], s91 offen offset:1024 sc1
  v_cvt_pk_bf16_f32 v182, v204, v205
  v_cvt_pk_bf16_f32 v183, v206, v207
  v_mul_u32_u24 v5, 160, v14
  v_lshl_add_u32 v5, v4, 3, v5
  v_add_u32 v5, 65536, v5
  ds_write_b64 v5, v[176:177] offset:0
  ds_write_b64 v5, v[178:179] offset:32
  buffer_load_dwordx4 a[104:107], v2, s[16:19], s91 offen offset:2048 sc1
  ds_write_b64 v5, v[180:181] offset:64
  ds_write_b64 v5, v[182:183] offset:96
  v_lshrrev_b32 v3, 4, v1
  v_lshlrev_b32 v3, 3, v3
  v_bfe_u32 v6, v1, 2, 2
  v_add_u32 v3, v3, v6
  s_lshl_b32 s72, s68, 5
  s_add_u32 s91, s90, 27648
  buffer_load_dwordx4 a[108:111], v2, s[16:19], s91 offen offset:0 sc1
  v_add_u32 v3, s72, v3
  v_mul_u32_u24 v3, 160, v3
  v_and_b32 v6, 3, v1
  v_lshl_add_u32 v3, v6, 3, v3
  s_lshl_b32 s72, s67, 6
  s_add_u32 s72, s72, 65536
  v_add_u32 v3, s72, v3
  s_waitcnt lgkmcnt(0)
  s_barrier
  ds_read_b64_tr_b16 v[184:185], v3 offset:0
  ds_read_b64_tr_b16 v[186:187], v3 offset:640
  ds_read_b64_tr_b16 v[188:189], v3 offset:32
  ds_read_b64_tr_b16 v[190:191], v3 offset:672
  s_lshl_b32 s72, s59, 6
  s_lshl_b32 s73, s58, 1
  s_add_u32 s72, s72, s73
  s_add_u32 s72, s72, s68
  s_lshl_b32 s72, s72, 2
  s_lshl_b32 s73, s67, 1
  s_add_u32 s72, s72, s73
  s_lshl_b32 s72, s72, 10
  s_lshl_b32 s73, s61, 21
  s_add_u32 s72, s72, s73
  s_add_u32 s72, s72, 13631488
  s_waitcnt lgkmcnt(2)
  buffer_store_dwordx4 v[184:187], v2, s[16:19], s72 offen offset:0 sc1
  s_waitcnt lgkmcnt(0)
  buffer_store_dwordx4 v[188:191], v2, s[16:19], s72 offen offset:1024 sc1
  s_cmp_eq_u32 s66, 0
  s_cbranch_scc1 L_e1_54
  s_lshl_b32 s72, s65, 6
  s_lshl_b32 s73, s60, 4
  s_add_u32 s72, s72, s73
  s_mul_i32 s72, s72, 3072
  s_add_u32 s72, s72, 24117248
  s_add_u32 s73, s72, 27648
  buffer_load_dwordx4 a[112:115], v2, s[16:19], s73 offen offset:1024 sc1
  buffer_load_dwordx4 a[116:119], v2, s[16:19], s73 offen offset:2048 sc1
  s_add_u32 s73, s72, 30720
  buffer_load_dwordx4 a[120:123], v2, s[16:19], s73 offen offset:0 sc1
  buffer_load_dwordx4 a[124:127], v2, s[16:19], s73 offen offset:1024 sc1
  buffer_load_dwordx4 a[128:131], v2, s[16:19], s73 offen offset:2048 sc1
  s_add_u32 s73, s72, 33792
  buffer_load_dwordx4 a[132:135], v2, s[16:19], s73 offen offset:0 sc1
  buffer_load_dwordx4 a[136:139], v2, s[16:19], s73 offen offset:1024 sc1
  buffer_load_dwordx4 a[140:143], v2, s[16:19], s73 offen offset:2048 sc1
  s_add_u32 s73, s72, 36864
  buffer_load_dwordx4 a[144:147], v2, s[16:19], s73 offen offset:0 sc1
  buffer_load_dwordx4 a[148:151], v2, s[16:19], s73 offen offset:1024 sc1
  buffer_load_dwordx4 a[152:155], v2, s[16:19], s73 offen offset:2048 sc1
  s_add_u32 s73, s72, 39936
  buffer_load_dwordx4 a[156:159], v2, s[16:19], s73 offen offset:0 sc1
L_e1_54:
  s_cmp_eq_u32 s66, 1
  s_cbranch_scc1 L_dr_55
  s_waitcnt vmcnt(0)
L_dr_55:
  s_waitcnt vmcnt(12)
  s_barrier
  s_cmp_eq_u32 s60, 0
  s_cbranch_scc0 L_pub_56
  s_lshl_b32 s70, s61, 8
  s_add_u32 s70, s70, s2
  s_lshl_b32 s70, s70, 7
  s_add_u32 s70, s70, 135168
  v_mov_b32 v4, s62
  v_mov_b32 v5, s63
  v_mov_b32 v6, s70
  s_mov_b64 exec, 1
  buffer_store_dwordx2 v[4:5], v6, s[16:19], 0 offen sc1
  s_mov_b64 exec, -1
L_pub_56:
  v_lshrrev_b32 v3, 3, v1
  v_lshlrev_b32 v3, 12, v3
  v_bfe_u32 v4, v1, 1, 2
  v_bfe_u32 v5, v1, 4, 1
  v_and_b32 v6, 1, v1
  v_or_b32 v7, 0, v5
  v_xor_b32 v7, v4, v7
  v_lshl_add_u32 v7, v7, 1, v6
  v_lshl_add_u32 v40, v7, 4, v3
  v_or_b32 v7, 2, v5
  v_xor_b32 v7, v4, v7
  v_lshl_add_u32 v7, v7, 1, v6
  v_lshl_add_u32 v41, v7, 4, v3
  v_lshrrev_b32 v3, 4, v1
  v_lshlrev_b32 v4, 3, v3
  v_bfe_u32 v5, v1, 2, 2
  v_add_u32 v4, v4, v5
  v_lshlrev_b32 v4, 7, v4
  v_and_b32 v5, 3, v1
  v_lshl_add_u32 v4, v5, 3, v4
  v_and_b32 v3, 1, v3
  v_lshlrev_b32 v3, 1, v3
  v_bfe_u32 v5, v1, 3, 1
  v_or_b32 v3, v3, v5
  v_xor_b32 v5, 0, v3
  v_lshl_add_u32 v42, v5, 5, v4
  v_xor_b32 v5, 1, v3
  v_lshl_add_u32 v43, v5, 5, v4
  v_xor_b32 v5, 2, v3
  v_lshl_add_u32 v44, v5, 5, v4
  v_xor_b32 v5, 3, v3
  v_lshl_add_u32 v45, v5, 5, v4
  s_mul_i32 s89, s60, 1441792
  s_lshl_b32 s88, s58, 7
  s_add_u32 s89, s89, s88
  s_mul_i32 s86, s60, 20480
  s_add_u32 s86, s86, 65536
  s_lshl_b32 s87, s60, 14
  s_add_u32 s87, s87, 0
  s_cmp_eq_u32 s66, 0
  s_cbranch_scc1 L_m1o_58
  s_lshl_b32 s90, s65, 6
  s_lshl_b32 s91, s60, 4
  s_add_u32 s90, s90, s91
  s_mul_i32 s90, s90, 3072
  s_add_u32 s90, s90, 24117248
  s_add_u32 s91, s90, 39936
  buffer_load_dwordx4 a[160:163], v2, s[16:19], s91 offen offset:1024 sc1
  s_mov_b32 s32, s46
  s_mov_b32 s33, s47
  s_mov_b32 s34, 2752
  s_mov_b32 s35, 0x20000
  s_mul_i32 s72, s65, 96
  v_and_b32 v3, 1, v1
  v_lshlrev_b32 v3, 3, v3
  s_mul_i32 s73, s60, 3
  s_add_u32 s74, s73, 0
  s_lshr_b32 s74, s74, 1
  s_lshl_b32 s74, s74, 4
  s_add_u32 s74, s74, s72
  buffer_load_dwordx2 v[14:15], v3, s[32:35], s74 offen
  s_add_u32 s74, s73, 1
  s_lshr_b32 s74, s74, 1
  s_lshl_b32 s74, s74, 4
  s_add_u32 s74, s74, s72
  buffer_load_dwordx4 a[164:167], v2, s[16:19], s91 offen offset:2048 sc1
  buffer_load_dwordx2 v[16:17], v3, s[32:35], s74 offen
  s_add_u32 s74, s73, 2
  s_lshr_b32 s74, s74, 1
  s_lshl_b32 s74, s74, 4
  s_add_u32 s74, s74, s72
  buffer_load_dwordx2 v[18:19], v3, s[32:35], s74 offen
  s_lshl_b32 s73, s60, 3
  v_add_u32 v8, s73, v1
  v_and_b32 v9, 3, v8
  v_lshlrev_b32 v9, 3, v9
  v_add_u32 v9, s64, v9
  v_lshlrev_b32 v9, 3, v9
  v_lshrrev_b32 v7, 2, v8
  v_add_u32 v9, v9, v7
  s_lshl_b32 s70, s61, 15
  s_add_u32 s70, s70, 135168
  v_lshlrev_b32 v9, 7, v9
  s_add_u32 s91, s90, 43008
  buffer_load_dwordx4 a[168:171], v2, s[16:19], s91 offen offset:0 sc1
  v_add_u32 v9, s70, v9
  v_and_b32 v3, 15, v1
  v_mul_u32_u24 v3, 208, v3
  v_lshrrev_b32 v4, 4, v1
  v_lshl_add_u32 v3, v4, 4, v3
  s_mul_i32 s72, s60, 13312
  v_add_u32 v13, s72, v3
  v_lshrrev_b32 v3, 1, v1
  v_mul_u32_u24 v10, 208, v3
  v_and_b32 v4, 1, v1
  v_lshl_add_u32 v10, v4, 4, v10
  v_lshrrev_b32 v5, 5, v1
  v_lshlrev_b32 v11, 10, v5
  v_and_b32 v3, 15, v3
  v_lshl_add_u32 v11, v3, 4, v11
  v_lshl_add_u32 v11, v4, 3, v11
  s_mul_i32 s76, s60, 3
  buffer_load_dwordx4 a[172:175], v2, s[16:19], s91 offen offset:1024 sc1
  s_mov_b32 s84, 0xbdd2d3e8
  s_mov_b32 s85, 0xc0135761
  s_add_u32 s72, s76, 0
  s_lshr_b32 s73, s72, 1
  s_and_b32 s72, s72, 1
  s_mul_i32 s74, s72, 6656
  s_lshl_b32 s75, s73, 5
  s_add_u32 s74, s74, s75
  v_add_u32 v20, s74, v10
  s_add_u32 s72, s76, 1
  s_lshr_b32 s73, s72, 1
  s_and_b32 s72, s72, 1
  s_mul_i32 s74, s72, 6656
  s_lshl_b32 s75, s73, 5
  s_add_u32 s74, s74, s75
  v_add_u32 v21, s74, v10
  s_add_u32 s72, s76, 2
  buffer_load_dwordx4 a[176:179], v2, s[16:19], s91 offen offset:2048 sc1
  s_lshr_b32 s73, s72, 1
  s_and_b32 s72, s72, 1
  s_mul_i32 s74, s72, 6656
  s_lshl_b32 s75, s73, 5
  s_add_u32 s74, s74, s75
  v_add_u32 v22, s74, v10
  s_mul_i32 s76, s60, 3
  s_mul_i32 s77, s64, 176128
  s_lshl_b32 s73, s61, 21
  s_add_u32 s77, s77, s73
  s_add_u32 s77, s77, 17825792
  s_add_u32 s72, s76, 0
  s_lshr_b32 s73, s72, 1
  s_and_b32 s72, s72, 1
  s_mul_i32 s74, s65, 6
  s_add_u32 s74, s74, s73
  s_lshr_b32 s75, s74, 2
  s_add_u32 s91, s90, 46080
  buffer_load_dwordx4 a[180:183], v2, s[16:19], s91 offen offset:0 sc1
  s_and_b32 s79, s74, 3
  s_lshl_b32 s75, s75, 12
  s_lshl_b32 s79, s79, 8
  s_add_u32 s75, s75, s79
  s_lshl_b32 s72, s72, 11
  s_add_u32 s75, s75, s72
  s_add_u32 s75, s75, s77
  s_cmp_ge_u32 s74, 172
  s_cselect_b32 s79, 0x70000000, 0
  s_or_b32 s75, s75, s79
  s_cmp_eq_u32 s66, 0
  s_cselect_b32 s80, 0x70000000, s75
  s_add_u32 s72, s76, 1
  s_lshr_b32 s73, s72, 1
  s_and_b32 s72, s72, 1
  s_mul_i32 s74, s65, 6
  s_add_u32 s74, s74, s73
  buffer_load_dwordx4 a[184:187], v2, s[16:19], s91 offen offset:1024 sc1
  s_lshr_b32 s75, s74, 2
  s_and_b32 s79, s74, 3
  s_lshl_b32 s75, s75, 12
  s_lshl_b32 s79, s79, 8
  s_add_u32 s75, s75, s79
  s_lshl_b32 s72, s72, 11
  s_add_u32 s75, s75, s72
  s_add_u32 s75, s75, s77
  s_cmp_ge_u32 s74, 172
  s_cselect_b32 s79, 0x70000000, 0
  s_or_b32 s75, s75, s79
  s_cmp_eq_u32 s66, 0
  s_cselect_b32 s81, 0x70000000, s75
  s_add_u32 s72, s76, 2
  s_lshr_b32 s73, s72, 1
  s_and_b32 s72, s72, 1
  s_mul_i32 s74, s65, 6
  buffer_load_dwordx4 a[188:191], v2, s[16:19], s91 offen offset:2048 sc1
  s_add_u32 s74, s74, s73
  s_lshr_b32 s75, s74, 2
  s_and_b32 s79, s74, 3
  s_lshl_b32 s75, s75, 12
  s_lshl_b32 s79, s79, 8
  s_add_u32 s75, s75, s79
  s_lshl_b32 s72, s72, 11
  s_add_u32 s75, s75, s72
  s_add_u32 s75, s75, s77
  s_cmp_ge_u32 s74, 172
  s_cselect_b32 s79, 0x70000000, 0
  s_or_b32 s75, s75, s79
  s_cmp_eq_u32 s66, 0
  s_cselect_b32 s82, 0x70000000, s75
  s_lshl_b32 s72, s64, 6
  s_lshl_b32 s73, s60, 4
  s_add_u32 s72, s72, s73
  s_lshl_b32 s72, s72, 12
  s_lshl_b32 s73, s61, 21
  s_add_u32 s72, s72, s73
  s_add_u32 s43, s72, 13631488
  s_mov_b64 exec, 0xff
  s_mov_b32 s100, 0
  s_cbranch_execz L_pok_60
L_poll_59:
  buffer_load_dwordx2 v[4:5], v9, s[16:19], 0 offen sc1
  s_waitcnt vmcnt(0)
  v_cmp_ne_u64 vcc, s[62:63], v[4:5]
  s_nop 0
  s_cbranch_vccz L_pok_60
  s_add_u32 s100, s100, 1
  s_cmp_lt_u32 s100, 400000
  s_cbranch_scc1 L_poll_59
  s_branch L_fail
L_pok_60:
  s_mov_b64 exec, -1
  s_mov_b32 s72, s43
  buffer_load_dwordx4 v[64:67], v2, s[16:19], s72 offen offset:0 sc1
  buffer_load_dwordx4 v[68:71], v2, s[16:19], s72 offen offset:1024 sc1
  buffer_load_dwordx4 v[72:75], v2, s[16:19], s72 offen offset:2048 sc1
  buffer_load_dwordx4 v[76:79], v2, s[16:19], s72 offen offset:3072 sc1
  s_add_u32 s72, s72, 4096
  buffer_load_dwordx4 v[80:83], v2, s[16:19], s72 offen offset:0 sc1
  buffer_load_dwordx4 v[84:87], v2, s[16:19], s72 offen offset:1024 sc1
  buffer_load_dwordx4 v[88:91], v2, s[16:19], s72 offen offset:2048 sc1
  buffer_load_dwordx4 v[92:95], v2, s[16:19], s72 offen offset:3072 sc1
  s_add_u32 s72, s72, 4096
  buffer_load_dwordx4 v[96:99], v2, s[16:19], s72 offen offset:0 sc1
  buffer_load_dwordx4 v[100:103], v2, s[16:19], s72 offen offset:1024 sc1
  buffer_load_dwordx4 v[104:107], v2, s[16:19], s72 offen offset:2048 sc1
  buffer_load_dwordx4 v[108:111], v2, s[16:19], s72 offen offset:3072 sc1
  s_add_u32 s72, s72, 4096
  buffer_load_dwordx4 v[112:115], v2, s[16:19], s72 offen offset:0 sc1
  buffer_load_dwordx4 v[116:119], v2, s[16:19], s72 offen offset:1024 sc1
  buffer_load_dwordx4 v[120:123], v2, s[16:19], s72 offen offset:2048 sc1
  s_waitcnt vmcnt(14)
  v_mfma_f32_16x16x32_bf16 a[192:195], a[0:3], v[64:67], 0
  v_mfma_f32_16x16x32_bf16 a[208:211], a[4:7], v[64:67], 0
  v_mfma_f32_16x16x32_bf16 a[224:227], a[8:11], v[64:67], 0
  buffer_load_dwordx4 v[124:127], v2, s[16:19], s72 offen offset:3072 sc1
  s_add_u32 s72, s72, 4096
  s_waitcnt vmcnt(14)
  v_mfma_f32_16x16x32_bf16 a[196:199], a[0:3], v[68:71], 0
  v_mfma_f32_16x16x32_bf16 a[212:215], a[4:7], v[68:71], 0
  v_mfma_f32_16x16x32_bf16 a[228:231], a[8:11], v[68:71], 0
  buffer_load_dwordx4 v[128:131], v2, s[16:19], s72 offen offset:0 sc1
  s_waitcnt vmcnt(14)
  v_mfma_f32_16x16x32_bf16 a[200:203], a[0:3], v[72:75], 0
  v_mfma_f32_16x16x32_bf16 a[216:219], a[4:7], v[72:75], 0
  v_mfma_f32_16x16x32_bf16 a[232:235], a[8:11], v[72:75], 0
  buffer_load_dwordx4 v[132:135], v2, s[16:19], s72 offen offset:1024 sc1
  s_waitcnt vmcnt(14)
  v_mfma_f32_16x16x32_bf16 a[204:207], a[0:3], v[76:79], 0
  v_mfma_f32_16x16x32_bf16 a[220:223], a[4:7], v[76:79], 0
  v_mfma_f32_16x16x32_bf16 a[236:239], a[8:11], v[76:79], 0
  buffer_load_dwordx4 v[136:139], v2, s[16:19], s72 offen offset:2048 sc1
  s_waitcnt vmcnt(14)
  v_mfma_f32_16x16x32_bf16 a[192:195], a[12:15], v[80:83], a[192:195]
  v_mfma_f32_16x16x32_bf16 a[208:211], a[16:19], v[80:83], a[208:211]
  v_mfma_f32_16x16x32_bf16 a[224:227], a[20:23], v[80:83], a[224:227]
  buffer_load_dwordx4 v[140:143], v2, s[16:19], s72 offen offset:3072 sc1
  s_add_u32 s72, s72, 4096
  s_waitcnt vmcnt(14)
  v_mfma_f32_16x16x32_bf16 a[196:199], a[12:15], v[84:87], a[196:199]
  v_mfma_f32_16x16x32_bf16 a[212:215], a[16:19], v[84:87], a[212:215]
  v_mfma_f32_16x16x32_bf16 a[228:231], a[20:23], v[84:87], a[228:231]
  buffer_load_dwordx4 v[144:147], v2, s[16:19], s72 offen offset:0 sc1
  s_waitcnt vmcnt(14)
  v_mfma_f32_16x16x32_bf16 a[200:203], a[12:15], v[88:91], a[200:203]
  v_mfma_f32_16x16x32_bf16 a[216:219], a[16:19], v[88:91], a[216:219]
  v_mfma_f32_16x16x32_bf16 a[232:235], a[20:23], v[88:91], a[232:235]
  buffer_load_dwordx4 v[148:151], v2, s[16:19], s72 offen offset:1024 sc1
  s_waitcnt vmcnt(14)
  v_mfma_f32_16x16x32_bf16 a[204:207], a[12:15], v[92:95], a[204:207]
  v_mfma_f32_16x16x32_bf16 a[220:223], a[16:19], v[92:95], a[220:223]
  v_mfma_f32_16x16x32_bf16 a[236:239], a[20:23], v[92:95], a[236:239]
  buffer_load_dwordx4 v[152:155], v2, s[16:19], s72 offen offset:2048 sc1
  s_waitcnt vmcnt(14)
  v_mfma_f32_16x16x32_bf16 a[192:195], a[24:27], v[96:99], a[192:195]
  v_mfma_f32_16x16x32_bf16 a[208:211], a[28:31], v[96:99], a[208:211]
  v_mfma_f32_16x16x32_bf16 a[224:227], a[32:35], v[96:99], a[224:227]
  buffer_load_dwordx4 v[156:159], v2, s[16:19], s72 offen offset:3072 sc1
  s_add_u32 s72, s72, 4096
  s_waitcnt vmcnt(14)
  v_mfma_f32_16x16x32_bf16 a[196:199], a[24:27], v[100:103], a[196:199]
  v_mfma_f32_16x16x32_bf16 a[212:215], a[28:31], v[100:103], a[212:215]
  v_mfma_f32_16x16x32_bf16 a[228:231], a[32:35], v[100:103], a[228:231]
  buffer_load_dwordx4 v[64:67], v2, s[16:19], s72 offen offset:0 sc1
  s_waitcnt vmcnt(14)
  v_mfma_f32_16x16x32_bf16 a[200:203], a[24:27], v[104:107], a[200:203]
  v_mfma_f32_16x16x32_bf16 a[216:219], a[28:31], v[104:107], a[216:219]
  v_mfma_f32_16x16x32_bf16 a[232:235], a[32:35], v[104:107], a[232:235]
  buffer_load_dwordx4 v[68:71], v2, s[16:19], s72 offen offset:1024 sc1
  s_waitcnt vmcnt(14)
  v_mfma_f32_16x16x32_bf16 a[204:207], a[24:27], v[108:111], a[204:207]
  v_mfma_f32_16x16x32_bf16 a[220:223], a[28:31], v[108:111], a[220:223]
  v_mfma_f32_16x16x32_bf16 a[236:239], a[32:35], v[108:111], a[236:239]
  buffer_load_dwordx4 v[72:75], v2, s[16:19], s72 offen offset:2048 sc1
  s_waitcnt vmcnt(14)
  v_mfma_f32_16x16x32_bf16 a[192:195], a[36:39], v[112:115], a[192:195]
  v_mfma_f32_16x16x32_bf16 a[208:211], a[40:43], v[112:115], a[208:211]
  v_mfma_f32_16x16x32_bf16 a[224:227], a[44:47], v[112:115], a[224:227]
  buffer_load_dwordx4 v[76:79], v2, s[16:19], s72 offen offset:3072 sc1
  s_add_u32 s72, s72, 4096
  s_waitcnt vmcnt(14)
  v_mfma_f32_16x16x32_bf16 a[196:199], a[36:39], v[116:119], a[196:199]
  v_mfma_f32_16x16x32_bf16 a[212:215], a[40:43], v[116:119], a[212:215]
  v_mfma_f32_16x16x32_bf16 a[228:231], a[44:47], v[116:119], a[228:231]
  buffer_load_dwordx4 v[80:83], v2, s[16:19], s72 offen offset:0 sc1
  s_waitcnt vmcnt(14)
  v_mfma_f32_16x16x32_bf16 a[200:203], a[36:39], v[120:123], a[200:203]
  v_mfma_f32_16x16x32_bf16 a[216:219], a[40:43], v[120:123], a[216:219]
  v_mfma_f32_16x16x32_bf16 a[232:235], a[44:47], v[120:123], a[232:235]
  buffer_load_dwordx4 v[84:87], v2, s[16:19], s72 offen offset:1024 sc1
  s_waitcnt vmcnt(14)
  v_mfma_f32_16x16x32_bf16 a[204:207], a[36:39], v[124:127], a[204:207]
  v_mfma_f32_16x16x32_bf16 a[220:223], a[40:43], v[124:127], a[220:223]
  v_mfma_f32_16x16x32_bf16 a[236:239], a[44:47], v[124:127], a[236:239]
  buffer_load_dwordx4 v[88:91], v2, s[16:19], s72 offen offset:2048 sc1
  s_waitcnt vmcnt(14)
  v_mfma_f32_16x16x32_bf16 a[192:195], a[48:51], v[128:131], a[192:195]
  v_mfma_f32_16x16x32_bf16 a[208:211], a[52:55], v[128:131], a[208:211]
  v_mfma_f32_16x16x32_bf16 a[224:227], a[56:59], v[128:131], a[224:227]
  buffer_load_dwordx4 v[92:95], v2, s[16:19], s72 offen offset:3072 sc1
  s_add_u32 s72, s72, 4096
  s_waitcnt vmcnt(14)
  v_mfma_f32_16x16x32_bf16 a[196:199], a[48:51], v[132:135], a[196:199]
  v_mfma_f32_16x16x32_bf16 a[212:215], a[52:55], v[132:135], a[212:215]
  v_mfma_f32_16x16x32_bf16 a[228:231], a[56:59], v[132:135], a[228:231]
  buffer_load_dwordx4 v[96:99], v2, s[16:19], s72 offen offset:0 sc1
  s_waitcnt vmcnt(14)
  v_mfma_f32_16x16x32_bf16 a[200:203], a[48:51], v[136:139], a[200:203]
  v_mfma_f32_16x16x32_bf16 a[216:219], a[52:55], v[136:139], a[216:219]
  v_mfma_f32_16x16x32_bf16 a[232:235], a[56:59], v[136:139], a[232:235]
  buffer_load_dwordx4 v[100:103], v2, s[16:19], s72 offen offset:1024 sc1
  s_waitcnt vmcnt(14)
  v_mfma_f32_16x16x32_bf16 a[204:207], a[48:51], v[140:143], a[204:207]
  v_mfma_f32_16x16x32_bf16 a[220:223], a[52:55], v[140:143], a[220:223]
  v_mfma_f32_16x16x32_bf16 a[236:239], a[56:59], v[140:143], a[236:239]
  buffer_load_dwordx4 v[104:107], v2, s[16:19], s72 offen offset:2048 sc1
  s_waitcnt vmcnt(14)
  v_mfma_f32_16x16x32_bf16 a[192:195], a[60:63], v[144:147], a[192:195]
  v_mfma_f32_16x16x32_bf16 a[208:211], a[64:67], v[144:147], a[208:211]
  v_mfma_f32_16x16x32_bf16 a[224:227], a[68:71], v[144:147], a[224:227]
  buffer_load_dwordx4 v[108:111], v2, s[16:19], s72 offen offset:3072 sc1
  s_add_u32 s72, s72, 4096
  s_waitcnt vmcnt(14)
  v_mfma_f32_16x16x32_bf16 a[196:199], a[60:63], v[148:151], a[196:199]
  v_mfma_f32_16x16x32_bf16 a[212:215], a[64:67], v[148:151], a[212:215]
  v_mfma_f32_16x16x32_bf16 a[228:231], a[68:71], v[148:151], a[228:231]
  buffer_load_dwordx4 v[112:115], v2, s[16:19], s72 offen offset:0 sc1
  s_waitcnt vmcnt(14)
  v_mfma_f32_16x16x32_bf16 a[200:203], a[60:63], v[152:155], a[200:203]
  v_mfma_f32_16x16x32_bf16 a[216:219], a[64:67], v[152:155], a[216:219]
  v_mfma_f32_16x16x32_bf16 a[232:235], a[68:71], v[152:155], a[232:235]
  buffer_load_dwordx4 v[116:119], v2, s[16:19], s72 offen offset:1024 sc1
  s_waitcnt vmcnt(14)
  v_mfma_f32_16x16x32_bf16 a[204:207], a[60:63], v[156:159], a[204:207]
  v_mfma_f32_16x16x32_bf16 a[220:223], a[64:67], v[156:159], a[220:223]
  v_mfma_f32_16x16x32_bf16 a[236:239], a[68:71], v[156:159], a[236:239]
  buffer_load_dwordx4 v[120:123], v2, s[16:19], s72 offen offset:2048 sc1
  s_waitcnt vmcnt(14)
  v_mfma_f32_16x16x32_bf16 a[192:195], a[72:75], v[64:67], a[192:195]
  v_mfma_f32_16x16x32_bf16 a[208:211], a[76:79], v[64:67], a[208:211]
  v_mfma_f32_16x16x32_bf16 a[224:227], a[80:83], v[64:67], a[224:227]
  buffer_load_dwordx4 v[124:127], v2, s[16:19], s72 offen offset:3072 sc1
  s_add_u32 s72, s72, 4096
  s_waitcnt vmcnt(14)
  v_mfma_f32_16x16x32_bf16 a[196:199], a[72:75], v[68:71], a[196:199]
  v_mfma_f32_16x16x32_bf16 a[212:215], a[76:79], v[68:71], a[212:215]
  v_mfma_f32_16x16x32_bf16 a[228:231], a[80:83], v[68:71], a[228:231]
  buffer_load_dwordx4 v[128:131], v2, s[16:19], s72 offen offset:0 sc1
  s_waitcnt vmcnt(14)
  v_mfma_f32_16x16x32_bf16 a[200:203], a[72:75], v[72:75], a[200:203]
  v_mfma_f32_16x16x32_bf16 a[216:219], a[76:79], v[72:75], a[216:219]
  v_mfma_f32_16x16x32_bf16 a[232:235], a[80:83], v[72:75], a[232:235]
  buffer_load_dwordx4 v[132:135], v2, s[16:19], s72 offen offset:1024 sc1
  s_waitcnt vmcnt(14)
  v_mfma_f32_16x16x32_bf16 a[204:207], a[72:75], v[76:79], a[204:207]
  v_mfma_f32_16x16x32_bf16 a[220:223], a[76:79], v[76:79], a[220:223]
  v_mfma_f32_16x16x32_bf16 a[236:239], a[80:83], v[76:79], a[236:239]
  buffer_load_dwordx4 v[136:139], v2, s[16:19], s72 offen offset:2048 sc1
  s_waitcnt vmcnt(14)
  v_mfma_f32_16x16x32_bf16 a[192:195], a[84:87], v[80:83], a[192:195]
  v_mfma_f32_16x16x32_bf16 a[208:211], a[88:91], v[80:83], a[208:211]
  v_mfma_f32_16x16x32_bf16 a[224:227], a[92:95], v[80:83], a[224:227]
  buffer_load_dwordx4 v[140:143], v2, s[16:19], s72 offen offset:3072 sc1
  s_add_u32 s72, s72, 4096
  s_waitcnt vmcnt(14)
  v_mfma_f32_16x16x32_bf16 a[196:199], a[84:87], v[84:87], a[196:199]
  v_mfma_f32_16x16x32_bf16 a[212:215], a[88:91], v[84:87], a[212:215]
  v_mfma_f32_16x16x32_bf16 a[228:231], a[92:95], v[84:87], a[228:231]
  buffer_load_dwordx4 v[144:147], v2, s[16:19], s72 offen offset:0 sc1
  s_waitcnt vmcnt(14)
  v_mfma_f32_16x16x32_bf16 a[200:203], a[84:87], v[88:91], a[200:203]
  v_mfma_f32_16x16x32_bf16 a[216:219], a[88:91], v[88:91], a[216:219]
  v_mfma_f32_16x16x32_bf16 a[232:235], a[92:95], v[88:91], a[232:235]
  buffer_load_dwordx4 v[148:151], v2, s[16:19], s72 offen offset:1024 sc1
  s_waitcnt vmcnt(14)
  v_mfma_f32_16x16x32_bf16 a[204:207], a[84:87], v[92:95], a[204:207]
  v_mfma_f32_16x16x32_bf16 a[220:223], a[88:91], v[92:95], a[220:223]
  v_mfma_f32_16x16x32_bf16 a[236:239], a[92:95], v[92:95], a[236:239]
  buffer_load_dwordx4 v[152:155], v2, s[16:19], s72 offen offset:2048 sc1
  s_waitcnt vmcnt(14)
  v_mfma_f32_16x16x32_bf16 a[192:195], a[96:99], v[96:99], a[192:195]
  v_mfma_f32_16x16x32_bf16 a[208:211], a[100:103], v[96:99], a[208:211]
  v_mfma_f32_16x16x32_bf16 a[224:227], a[104:107], v[96:99], a[224:227]
  buffer_load_dwordx4 v[156:159], v2, s[16:19], s72 offen offset:3072 sc1
  s_add_u32 s72, s72, 4096
  s_waitcnt vmcnt(14)
  v_mfma_f32_16x16x32_bf16 a[196:199], a[96:99], v[100:103], a[196:199]
  v_mfma_f32_16x16x32_bf16 a[212:215], a[100:103], v[100:103], a[212:215]
  v_mfma_f32_16x16x32_bf16 a[228:231], a[104:107], v[100:103], a[228:231]
  buffer_load_dwordx4 v[64:67], v2, s[16:19], s72 offen offset:0 sc1
  s_waitcnt vmcnt(14)
  v_mfma_f32_16x16x32_bf16 a[200:203], a[96:99], v[104:107], a[200:203]
  v_mfma_f32_16x16x32_bf16 a[216:219], a[100:103], v[104:107], a[216:219]
  v_mfma_f32_16x16x32_bf16 a[232:235], a[104:107], v[104:107], a[232:235]
  buffer_load_dwordx4 v[68:71], v2, s[16:19], s72 offen offset:1024 sc1
  s_waitcnt vmcnt(14)
  v_mfma_f32_16x16x32_bf16 a[204:207], a[96:99], v[108:111], a[204:207]
  v_mfma_f32_16x16x32_bf16 a[220:223], a[100:103], v[108:111], a[220:223]
  v_mfma_f32_16x16x32_bf16 a[236:239], a[104:107], v[108:111], a[236:239]
  buffer_load_dwordx4 v[72:75], v2, s[16:19], s72 offen offset:2048 sc1
  s_waitcnt vmcnt(14)
  v_mfma_f32_16x16x32_bf16 a[192:195], a[108:111], v[112:115], a[192:195]
  v_mfma_f32_16x16x32_bf16 a[208:211], a[112:115], v[112:115], a[208:211]
  v_mfma_f32_16x16x32_bf16 a[224:227], a[116:119], v[112:115], a[224:227]
  buffer_load_dwordx4 v[76:79], v2, s[16:19], s72 offen offset:3072 sc1
  s_add_u32 s72, s72, 4096
  s_waitcnt vmcnt(14)
  v_mfma_f32_16x16x32_bf16 a[196:199], a[108:111], v[116:119], a[196:199]
  v_mfma_f32_16x16x32_bf16 a[212:215], a[112:115], v[116:119], a[212:215]
  v_mfma_f32_16x16x32_bf16 a[228:231], a[116:119], v[116:119], a[228:231]
  buffer_load_dwordx4 v[80:83], v2, s[16:19], s72 offen offset:0 sc1
  s_waitcnt vmcnt(14)
  v_mfma_f32_16x16x32_bf16 a[200:203], a[108:111], v[120:123], a[200:203]
  v_mfma_f32_16x16x32_bf16 a[216:219], a[112:115], v[120:123], a[216:219]
  v_mfma_f32_16x16x32_bf16 a[232:235], a[116:119], v[120:123], a[232:235]
  buffer_load_dwordx4 v[84:87], v2, s[16:19], s72 offen offset:1024 sc1
  s_waitcnt vmcnt(14)
  v_mfma_f32_16x16x32_bf16 a[204:207], a[108:111], v[124:127], a[204:207]
  v_mfma_f32_16x16x32_bf16 a[220:223], a[112:115], v[124:127], a[220:223]
  v_mfma_f32_16x16x32_bf16 a[236:239], a[116:119], v[124:127], a[236:239]
  buffer_load_dwordx4 v[88:91], v2, s[16:19], s72 offen offset:2048 sc1
  s_waitcnt vmcnt(14)
  v_mfma_f32_16x16x32_bf16 a[192:195], a[120:123], v[128:131], a[192:195]
  v_mfma_f32_16x16x32_bf16 a[208:211], a[124:127], v[128:131], a[208:211]
  v_mfma_f32_16x16x32_bf16 a[224:227], a[128:131], v[128:131], a[224:227]
  buffer_load_dwordx4 v[92:95], v2, s[16:19], s72 offen offset:3072 sc1
  s_add_u32 s72, s72, 4096
  s_waitcnt vmcnt(14)
  v_mfma_f32_16x16x32_bf16 a[196:199], a[120:123], v[132:135], a[196:199]
  v_mfma_f32_16x16x32_bf16 a[212:215], a[124:127], v[132:135], a[212:215]
  v_mfma_f32_16x16x32_bf16 a[228:231], a[128:131], v[132:135], a[228:231]
  buffer_load_dwordx4 v[96:99], v2, s[16:19], s72 offen offset:0 sc1
  s_waitcnt vmcnt(14)
  v_mfma_f32_16x16x32_bf16 a[200:203], a[120:123], v[136:139], a[200:203]
  v_mfma_f32_16x16x32_bf16 a[216:219], a[124:127], v[136:139], a[216:219]
  v_mfma_f32_16x16x32_bf16 a[232:235], a[128:131], v[136:139], a[232:235]
  buffer_load_dwordx4 v[100:103], v2, s[16:19], s72 offen offset:1024 sc1
  s_waitcnt vmcnt(14)
  v_mfma_f32_16x16x32_bf16 a[204:207], a[120:123], v[140:143], a[204:207]
  v_mfma_f32_16x16x32_bf16 a[220:223], a[124:127], v[140:143], a[220:223]
  v_mfma_f32_16x16x32_bf16 a[236:239], a[128:131], v[140:143], a[236:239]
  buffer_load_dwordx4 v[104:107], v2, s[16:19], s72 offen offset:2048 sc1
  s_waitcnt vmcnt(14)
  v_mfma_f32_16x16x32_bf16 a[192:195], a[132:135], v[144:147], a[192:195]
  v_mfma_f32_16x16x32_bf16 a[208:211], a[136:139], v[144:147], a[208:211]
  v_mfma_f32_16x16x32_bf16 a[224:227], a[140:143], v[144:147], a[224:227]
  buffer_load_dwordx4 v[108:111], v2, s[16:19], s72 offen offset:3072 sc1
  s_add_u32 s72, s72, 4096
  s_waitcnt vmcnt(14)
  v_mfma_f32_16x16x32_bf16 a[196:199], a[132:135], v[148:151], a[196:199]
  v_mfma_f32_16x16x32_bf16 a[212:215], a[136:139], v[148:151], a[212:215]
  v_mfma_f32_16x16x32_bf16 a[228:231], a[140:143], v[148:151], a[228:231]
  buffer_load_dwordx4 v[112:115], v2, s[16:19], s72 offen offset:0 sc1
  s_waitcnt vmcnt(14)
  v_mfma_f32_16x16x32_bf16 a[200:203], a[132:135], v[152:155], a[200:203]
  v_mfma_f32_16x16x32_bf16 a[216:219], a[136:139], v[152:155], a[216:219]
  v_mfma_f32_16x16x32_bf16 a[232:235], a[140:143], v[152:155], a[232:235]
  buffer_load_dwordx4 v[116:119], v2, s[16:19], s72 offen offset:1024 sc1
  s_waitcnt vmcnt(14)
  v_mfma_f32_16x16x32_bf16 a[204:207], a[132:135], v[156:159], a[204:207]
  v_mfma_f32_16x16x32_bf16 a[220:223], a[136:139], v[156:159], a[220:223]
  v_mfma_f32_16x16x32_bf16 a[236:239], a[140:143], v[156:159], a[236:239]
  buffer_load_dwordx4 v[120:123], v2, s[16:19], s72 offen offset:2048 sc1
  s_waitcnt vmcnt(14)
  v_mfma_f32_16x16x32_bf16 a[192:195], a[144:147], v[64:67], a[192:195]
  v_mfma_f32_16x16x32_bf16 a[208:211], a[148:151], v[64:67], a[208:211]
  v_mfma_f32_16x16x32_bf16 a[224:227], a[152:155], v[64:67], a[224:227]
  buffer_load_dwordx4 v[124:127], v2, s[16:19], s72 offen offset:3072 sc1
  s_add_u32 s72, s72, 4096
  s_waitcnt vmcnt(14)
  v_mfma_f32_16x16x32_bf16 a[196:199], a[144:147], v[68:71], a[196:199]
  v_mfma_f32_16x16x32_bf16 a[212:215], a[148:151], v[68:71], a[212:215]
  v_mfma_f32_16x16x32_bf16 a[228:231], a[152:155], v[68:71], a[228:231]
  s_waitcnt vmcnt(13)
  v_mfma_f32_16x16x32_bf16 a[200:203], a[144:147], v[72:75], a[200:203]
  v_mfma_f32_16x16x32_bf16 a[216:219], a[148:151], v[72:75], a[216:219]
  v_mfma_f32_16x16x32_bf16 a[232:235], a[152:155], v[72:75], a[232:235]
  s_waitcnt vmcnt(12)
  v_mfma_f32_16x16x32_bf16 a[204:207], a[144:147], v[76:79], a[204:207]
  v_mfma_f32_16x16x32_bf16 a[220:223], a[148:151], v[76:79], a[220:223]
  v_mfma_f32_16x16x32_bf16 a[236:239], a[152:155], v[76:79], a[236:239]
  s_waitcnt vmcnt(11)
  v_mfma_f32_16x16x32_bf16 a[192:195], a[156:159], v[80:83], a[192:195]
  v_mfma_f32_16x16x32_bf16 a[208:211], a[160:163], v[80:83], a[208:211]
  v_mfma_f32_16x16x32_bf16 a[224:227], a[164:167], v[80:83], a[224:227]
  s_waitcnt vmcnt(10)
  v_mfma_f32_16x16x32_bf16 a[196:199], a[156:159], v[84:87], a[196:199]
  v_mfma_f32_16x16x32_bf16 a[212:215], a[160:163], v[84:87], a[212:215]
  v_mfma_f32_16x16x32_bf16 a[228:231], a[164:167], v[84:87], a[228:231]
  s_waitcnt vmcnt(9)
  v_mfma_f32_16x16x32_bf16 a[200:203], a[156:159], v[88:91], a[200:203]
  v_mfma_f32_16x16x32_bf16 a[216:219], a[160:163], v[88:91], a[216:219]
  v_mfma_f32_16x16x32_bf16 a[232:235], a[164:167], v[88:91], a[232:235]
  s_waitcnt vmcnt(8)
  v_mfma_f32_16x16x32_bf16 a[204:207], a[156:159], v[92:95], a[204:207]
  v_mfma_f32_16x16x32_bf16 a[220:223], a[160:163], v[92:95], a[220:223]
  v_mfma_f32_16x16x32_bf16 a[236:239], a[164:167], v[92:95], a[236:239]
  s_waitcnt vmcnt(7)
  v_mfma_f32_16x16x32_bf16 a[192:195], a[168:171], v[96:99], a[192:195]
  v_mfma_f32_16x16x32_bf16 a[208:211], a[172:175], v[96:99], a[208:211]
  v_mfma_f32_16x16x32_bf16 a[224:227], a[176:179], v[96:99], a[224:227]
  s_waitcnt vmcnt(6)
  v_mfma_f32_16x16x32_bf16 a[196:199], a[168:171], v[100:103], a[196:199]
  v_mfma_f32_16x16x32_bf16 a[212:215], a[172:175], v[100:103], a[212:215]
  v_mfma_f32_16x16x32_bf16 a[228:231], a[176:179], v[100:103], a[228:231]
  s_waitcnt vmcnt(5)
  v_mfma_f32_16x16x32_bf16 a[200:203], a[168:171], v[104:107], a[200:203]
  v_mfma_f32_16x16x32_bf16 a[216:219], a[172:175], v[104:107], a[216:219]
  v_mfma_f32_16x16x32_bf16 a[232:235], a[176:179], v[104:107], a[232:235]
  s_waitcnt vmcnt(4)
  v_mfma_f32_16x16x32_bf16 a[204:207], a[168:171], v[108:111], a[204:207]
  v_mfma_f32_16x16x32_bf16 a[220:223], a[172:175], v[108:111], a[220:223]
  v_mfma_f32_16x16x32_bf16 a[236:239], a[176:179], v[108:111], a[236:239]
  s_waitcnt vmcnt(3)
  v_mfma_f32_16x16x32_bf16 a[192:195], a[180:183], v[112:115], a[192:195]
  v_mfma_f32_16x16x32_bf16 a[208:211], a[184:187], v[112:115], a[208:211]
  v_mfma_f32_16x16x32_bf16 a[224:227], a[188:191], v[112:115], a[224:227]
  s_waitcnt vmcnt(2)
  v_mfma_f32_16x16x32_bf16 a[196:199], a[180:183], v[116:119], a[196:199]
  v_mfma_f32_16x16x32_bf16 a[212:215], a[184:187], v[116:119], a[212:215]
  v_mfma_f32_16x16x32_bf16 a[228:231], a[188:191], v[116:119], a[228:231]
  s_nop 1
  ds_write_b128 v13, a[192:195] offset:0
  ds_write_b128 v13, a[208:211] offset:64
  ds_write_b128 v13, a[224:227] offset:128
  s_waitcnt vmcnt(1)
  v_mfma_f32_16x16x32_bf16 a[200:203], a[180:183], v[120:123], a[200:203]
  v_mfma_f32_16x16x32_bf16 a[216:219], a[184:187], v[120:123], a[216:219]
  v_mfma_f32_16x16x32_bf16 a[232:235], a[188:191], v[120:123], a[232:235]
  ds_write_b128 v13, a[196:199] offset:3328
  ds_write_b128 v13, a[212:215] offset:3392
  ds_write_b128 v13, a[228:231] offset:3456
  s_waitcnt vmcnt(0)
  v_mfma_f32_16x16x32_bf16 a[204:207], a[180:183], v[124:127], a[204:207]
  v_mfma_f32_16x16x32_bf16 a[220:223], a[184:187], v[124:127], a[220:223]
  v_mfma_f32_16x16x32_bf16 a[236:239], a[188:191], v[124:127], a[236:239]
  ds_write_b128 v13, a[200:203] offset:6656
  ds_write_b128 v13, a[216:219] offset:6720
  ds_write_b128 v13, a[232:235] offset:6784
  s_lshl_b32 s72, s2, 2
  s_add_u32 s72, s72, s60
  s_mul_i32 s73, s72, 5504
  v_lshlrev_b32 v7, 7, v1
  s_mov_b32 exec_lo, -1
  s_mov_b32 exec_hi, 0x7ff
  buffer_load_dword v60, v7, s[28:31], s73 offen
  s_mov_b64 exec, -1
  v_lshrrev_b32 v6, 3, v0
  v_and_b32 v3, 7, v0
  v_lshlrev_b32 v6, 10, v6
  v_lshl_add_u32 v6, v3, 4, v6
  s_lshl_b32 s72, s58, 16
  s_lshl_b32 s73, s59, 7
  s_add_u32 s72, s72, s73
  s_add_u32 s73, s72, 32768
  buffer_load_dword v23, v6, s[20:23], s72 offen sc1
  buffer_load_dword v24, v6, s[20:23], s73 offen sc1
  s_add_u32 s72, s58, 32
  s_lshl_b32 s72, s72, 3
  s_add_u32 s72, s72, s59
  s_lshl_b32 s72, s72, 10
  s_add_u32 s72, s72, 36700160
  buffer_load_dword v25, v2, s[16:19], s72 offen sc1
  ds_write_b128 v13, a[204:207] offset:9984
  ds_write_b128 v13, a[220:223] offset:10048
  ds_write_b128 v13, a[236:239] offset:10112
  s_waitcnt lgkmcnt(0)
  s_barrier
  ds_read_b128 v[64:67], v20 offset:0
  ds_read_b128 v[68:71], v20 offset:13312
  ds_read_b128 v[72:75], v20 offset:26624
  ds_read_b128 v[76:79], v20 offset:39936
  ds_read_b128 v[80:83], v21 offset:0
  ds_read_b128 v[84:87], v21 offset:13312
  ds_read_b128 v[88:91], v21 offset:26624
  ds_read_b128 v[92:95], v21 offset:39936
  ds_read_b128 v[96:99], v22 offset:0
  ds_read_b128 v[100:103], v22 offset:13312
  ds_read_b128 v[104:107], v22 offset:26624
  ds_read_b128 v[108:111], v22 offset:39936
  s_or_b32 s72, s2, s60
  s_cmp_eq_u32 s72, 0
  s_cbranch_scc0 L_ep_61
  v_mov_b32 v4, s62
  v_mov_b32 v5, 0
  s_mov_b64 exec, 1
  buffer_store_dword v4, v5, s[16:19], 0 offen sc1
  s_mov_b64 exec, -1
L_ep_61:
  s_waitcnt lgkmcnt(10)
  v_add_f32 v64, v64, v68
  s_waitcnt lgkmcnt(8)
  v_add_f32 v72, v72, v76
  v_add_f32 v65, v65, v69
  v_add_f32 v73, v73, v77
  v_add_f32 v66, v66, v70
  v_add_f32 v74, v74, v78
  v_add_f32 v67, v67, v71
  v_add_f32 v75, v75, v79
  s_add_u32 m0, s86, 0
  s_add_u32 s88, s89, 0
  buffer_load_dwordx4 v40, s[28:31], s88 offen lds
  v_lshlrev_b32 v68, 16, v14
  v_and_b32 v69, 0xffff0000, v14
  v_lshlrev_b32 v70, 16, v15
  v_and_b32 v71, 0xffff0000, v15
  v_add_f32 v64, v64, v72
  v_add_f32 v65, v65, v73
  v_add_f32 v66, v66, v74
  v_add_f32 v67, v67, v75
  s_add_u32 m0, s86, 1024
  s_add_u32 s88, s89, 32768
  buffer_load_dwordx4 v41, s[28:31], s88 offen lds
  v_add_f32 v64, v64, v68
  v_add_f32 v65, v65, v69
  v_add_f32 v66, v66, v70
  v_add_f32 v67, v67, v71
  v_mul_f32 v68, v64, v64
  v_mov_b32 v72, s85
  v_mul_f32 v69, v65, v65
  v_mov_b32 v73, s85
  v_mul_f32 v70, v66, v66
  v_mov_b32 v74, s85
  v_mul_f32 v71, v67, v67
  v_mov_b32 v75, s85
  s_add_u32 m0, s86, 2048
  s_add_u32 s88, s89, 65536
  buffer_load_dwordx4 v40, s[28:31], s88 offen lds
  v_fmac_f32 v72, s84, v68
  v_fmac_f32 v73, s84, v69
  v_fmac_f32 v74, s84, v70
  v_fmac_f32 v75, s84, v71
  v_mul_f32 v72, v72, v64
  v_mul_f32 v73, v73, v65
  v_mul_f32 v74, v74, v66
  v_mul_f32 v75, v75, v67
  v_exp_f32 v72, v72
  v_exp_f32 v73, v73
  v_exp_f32 v74, v74
  v_exp_f32 v75, v75
  s_add_u32 m0, s86, 3072
  s_add_u32 s88, s89, 98304
  buffer_load_dwordx4 v41, s[28:31], s88 offen lds
  v_add_f32 v72, 1.0, v72
  v_add_f32 v73, 1.0, v73
  v_add_f32 v74, 1.0, v74
  v_add_f32 v75, 1.0, v75
  v_rcp_f32 v72, v72
  v_rcp_f32 v73, v73
  v_rcp_f32 v74, v74
  v_rcp_f32 v75, v75
  v_mul_f32 v64, v64, v72
  v_mul_f32 v65, v65, v73
  v_mul_f32 v66, v66, v74
  v_mul_f32 v67, v67, v75
  v_cvt_pk_bf16_f32 v68, v64, v65
  v_cvt_pk_bf16_f32 v69, v66, v67
  buffer_store_dwordx2 v[68:69], v11, s[16:19], s80 offen sc1
  s_waitcnt lgkmcnt(6)
  v_add_f32 v80, v80, v84
  s_waitcnt lgkmcnt(4)
  v_add_f32 v88, v88, v92
  v_add_f32 v81, v81, v85
  v_add_f32 v89, v89, v93
  v_add_f32 v82, v82, v86
  v_add_f32 v90, v90, v94
  v_add_f32 v83, v83, v87
  v_add_f32 v91, v91, v95
  s_add_u32 m0, s86, 4096
  s_add_u32 s88, s89, 131072
  buffer_load_dwordx4 v40, s[28:31], s88 offen lds
  v_lshlrev_b32 v84, 16, v16
  v_and_b32 v85, 0xffff0000, v16
  v_lshlrev_b32 v86, 16, v17
  v_and_b32 v87, 0xffff0000, v17
  v_add_f32 v80, v80, v88
  v_add_f32 v81, v81, v89
  v_add_f32 v82, v82, v90
  v_add_f32 v83, v83, v91
  s_add_u32 m0, s86, 5120
  s_add_u32 s88, s89, 163840
  buffer_load_dwordx4 v41, s[28:31], s88 offen lds
  v_add_f32 v80, v80, v84
  v_add_f32 v81, v81, v85
  v_add_f32 v82, v82, v86
  v_add_f32 v83, v83, v87
  v_mul_f32 v84, v80, v80
  v_mov_b32 v88, s85
  v_mul_f32 v85, v81, v81
  v_mov_b32 v89, s85
  v_mul_f32 v86, v82, v82
  v_mov_b32 v90, s85
  v_mul_f32 v87, v83, v83
  v_mov_b32 v91, s85
  s_add_u32 m0, s86, 6144
  s_add_u32 s88, s89, 196608
  buffer_load_dwordx4 v40, s[28:31], s88 offen lds
  v_fmac_f32 v88, s84, v84
  v_fmac_f32 v89, s84, v85
  v_fmac_f32 v90, s84, v86
  v_fmac_f32 v91, s84, v87
  v_mul_f32 v88, v88, v80
  v_mul_f32 v89, v89, v81
  v_mul_f32 v90, v90, v82
  v_mul_f32 v91, v91, v83
  v_exp_f32 v88, v88
  v_exp_f32 v89, v89
  v_exp_f32 v90, v90
  v_exp_f32 v91, v91
  s_add_u32 m0, s86, 7168
  s_add_u32 s88, s89, 229376
  buffer_load_dwordx4 v41, s[28:31], s88 offen lds
  v_add_f32 v88, 1.0, v88
  v_add_f32 v89, 1.0, v89
  v_add_f32 v90, 1.0, v90
  v_add_f32 v91, 1.0, v91
  v_rcp_f32 v88, v88
  v_rcp_f32 v89, v89
  v_rcp_f32 v90, v90
  v_rcp_f32 v91, v91
  v_mul_f32 v80, v80, v88
  v_mul_f32 v81, v81, v89
  v_mul_f32 v82, v82, v90
  v_mul_f32 v83, v83, v91
  v_cvt_pk_bf16_f32 v84, v80, v81
  v_cvt_pk_bf16_f32 v85, v82, v83
  buffer_store_dwordx2 v[84:85], v11, s[16:19], s81 offen sc1
  s_waitcnt lgkmcnt(2)
  v_add_f32 v96, v96, v100
  s_waitcnt lgkmcnt(0)
  v_add_f32 v104, v104, v108
  v_add_f32 v97, v97, v101
  v_add_f32 v105, v105, v109
  v_add_f32 v98, v98, v102
  v_add_f32 v106, v106, v110
  v_add_f32 v99, v99, v103
  v_add_f32 v107, v107, v111
  s_add_u32 m0, s86, 8192
  s_add_u32 s88, s89, 262144
  buffer_load_dwordx4 v40, s[28:31], s88 offen lds
  v_lshlrev_b32 v100, 16, v18
  v_and_b32 v101, 0xffff0000, v18
  v_lshlrev_b32 v102, 16, v19
  v_and_b32 v103, 0xffff0000, v19
  v_add_f32 v96, v96, v104
  v_add_f32 v97, v97, v105
  v_add_f32 v98, v98, v106
  v_add_f32 v99, v99, v107
  s_add_u32 m0, s86, 9216
  s_add_u32 s88, s89, 294912
  buffer_load_dwordx4 v41, s[28:31], s88 offen lds
  v_add_f32 v96, v96, v100
  v_add_f32 v97, v97, v101
  v_add_f32 v98, v98, v102
  v_add_f32 v99, v99, v103
  v_mul_f32 v100, v96, v96
  v_mov_b32 v104, s85
  v_mul_f32 v101, v97, v97
  v_mov_b32 v105, s85
  v_mul_f32 v102, v98, v98
  v_mov_b32 v106, s85
  v_mul_f32 v103, v99, v99
  v_mov_b32 v107, s85
  s_add_u32 m0, s86, 10240
  s_add_u32 s88, s89, 327680
  buffer_load_dwordx4 v40, s[28:31], s88 offen lds
  v_fmac_f32 v104, s84, v100
  v_fmac_f32 v105, s84, v101
  v_fmac_f32 v106, s84, v102
  v_fmac_f32 v107, s84, v103
  v_mul_f32 v104, v104, v96
  v_mul_f32 v105, v105, v97
  v_mul_f32 v106, v106, v98
  v_mul_f32 v107, v107, v99
  v_exp_f32 v104, v104
  v_exp_f32 v105, v105
  v_exp_f32 v106, v106
  v_exp_f32 v107, v107
  s_add_u32 m0, s86, 11264
  s_add_u32 s88, s89, 360448
  buffer_load_dwordx4 v41, s[28:31], s88 offen lds
  v_add_f32 v104, 1.0, v104
  v_add_f32 v105, 1.0, v105
  v_add_f32 v106, 1.0, v106
  v_add_f32 v107, 1.0, v107
  v_rcp_f32 v104, v104
  v_rcp_f32 v105, v105
  v_rcp_f32 v106, v106
  v_rcp_f32 v107, v107
  v_mul_f32 v96, v96, v104
  v_mul_f32 v97, v97, v105
  v_mul_f32 v98, v98, v106
  v_mul_f32 v99, v99, v107
  v_cvt_pk_bf16_f32 v100, v96, v97
  v_cvt_pk_bf16_f32 v101, v98, v99
  buffer_store_dwordx2 v[100:101], v11, s[16:19], s82 offen sc1
  s_add_u32 m0, s86, 12288
  s_add_u32 s88, s89, 393216
  buffer_load_dwordx4 v40, s[28:31], s88 offen lds
  s_add_u32 m0, s86, 13312
  s_add_u32 s88, s89, 425984
  buffer_load_dwordx4 v41, s[28:31], s88 offen lds
  s_add_u32 m0, s86, 14336
  s_add_u32 s88, s89, 458752
  buffer_load_dwordx4 v40, s[28:31], s88 offen lds
  s_add_u32 m0, s86, 15360
  s_add_u32 s88, s89, 491520
  buffer_load_dwordx4 v41, s[28:31], s88 offen lds
  s_add_u32 m0, s86, 16384
  s_add_u32 s88, s89, 524288
  buffer_load_dwordx4 v40, s[28:31], s88 offen lds
  s_add_u32 m0, s86, 17408
  s_add_u32 s88, s89, 557056
  buffer_load_dwordx4 v41, s[28:31], s88 offen lds
  s_add_u32 m0, s86, 18432
  s_add_u32 s88, s89, 589824
  buffer_load_dwordx4 v40, s[28:31], s88 offen lds
  s_add_u32 m0, s86, 19456
  s_add_u32 s88, s89, 622592
  buffer_load_dwordx4 v41, s[28:31], s88 offen lds
  s_waitcnt vmcnt(8)
  s_barrier
  s_cmp_eq_u32 s60, 0
  s_cbranch_scc0 L_pub_62
  s_lshl_b32 s70, s61, 8
  s_add_u32 s70, s70, s2
  s_lshl_b32 s70, s70, 7
  s_add_u32 s70, s70, 200704
  v_mov_b32 v4, s62
  v_mov_b32 v5, s63
  v_mov_b32 v6, s70
  s_mov_b64 exec, 1
  buffer_store_dwordx2 v[4:5], v6, s[16:19], 0 offen sc1
  s_mov_b64 exec, -1
L_pub_62:
L_m1_57:
  s_waitcnt vmcnt(0)
  s_add_u32 m0, s87, 0
  s_add_u32 s88, s89, 655360
  buffer_load_dwordx4 v40, s[28:31], s88 offen lds
  v_add_u32 v32, s86, v42
  v_add_u32 v33, s86, v43
  v_add_u32 v34, s86, v44
  v_add_u32 v35, s86, v45
  ds_read_b64_tr_b16 a[0:1], v32 offset:0
  ds_read_b64_tr_b16 a[2:3], v32 offset:512
  s_add_u32 m0, s87, 1024
  s_add_u32 s88, s89, 688128
  buffer_load_dwordx4 v41, s[28:31], s88 offen lds
  ds_read_b64_tr_b16 a[4:5], v33 offset:0
  ds_read_b64_tr_b16 a[6:7], v33 offset:512
  ds_read_b64_tr_b16 a[8:9], v34 offset:0
  ds_read_b64_tr_b16 a[10:11], v34 offset:512
  ds_read_b64_tr_b16 a[12:13], v35 offset:0
  ds_read_b64_tr_b16 a[14:15], v35 offset:512
  s_add_u32 m0, s87, 2048
  s_add_u32 s88, s89, 720896
  buffer_load_dwordx4 v40, s[28:31], s88 offen lds
  ds_read_b64_tr_b16 a[16:17], v32 offset:4096
  ds_read_b64_tr_b16 a[18:19], v32 offset:4608
  ds_read_b64_tr_b16 a[20:21], v33 offset:4096
  ds_read_b64_tr_b16 a[22:23], v33 offset:4608
  ds_read_b64_tr_b16 a[24:25], v34 offset:4096
  ds_read_b64_tr_b16 a[26:27], v34 offset:4608
  s_add_u32 m0, s87, 3072
  s_add_u32 s88, s89, 753664
  buffer_load_dwordx4 v41, s[28:31], s88 offen lds
  ds_read_b64_tr_b16 a[28:29], v35 offset:4096
  ds_read_b64_tr_b16 a[30:31], v35 offset:4608
  ds_read_b64_tr_b16 a[32:33], v32 offset:8192
  ds_read_b64_tr_b16 a[34:35], v32 offset:8704
  ds_read_b64_tr_b16 a[36:37], v33 offset:8192
  ds_read_b64_tr_b16 a[38:39], v33 offset:8704
  s_add_u32 m0, s87, 4096
  s_add_u32 s88, s89, 786432
  buffer_load_dwordx4 v40, s[28:31], s88 offen lds
  ds_read_b64_tr_b16 a[40:41], v34 offset:8192
  ds_read_b64_tr_b16 a[42:43], v34 offset:8704
  ds_read_b64_tr_b16 a[44:45], v35 offset:8192
  ds_read_b64_tr_b16 a[46:47], v35 offset:8704
  ds_read_b64_tr_b16 a[48:49], v32 offset:12288
  ds_read_b64_tr_b16 a[50:51], v32 offset:12800
  s_add_u32 m0, s87, 5120
  s_add_u32 s88, s89, 819200
  buffer_load_dwordx4 v41, s[28:31], s88 offen lds
  ds_read_b64_tr_b16 a[52:53], v33 offset:12288
  ds_read_b64_tr_b16 a[54:55], v33 offset:12800
  ds_read_b64_tr_b16 a[56:57], v34 offset:12288
  ds_read_b64_tr_b16 a[58:59], v34 offset:12800
  ds_read_b64_tr_b16 a[60:61], v35 offset:12288
  ds_read_b64_tr_b16 a[62:63], v35 offset:12800
  s_add_u32 m0, s87, 6144
  s_add_u32 s88, s89, 851968
  buffer_load_dwordx4 v40, s[28:31], s88 offen lds
  ds_read_b64_tr_b16 a[64:65], v32 offset:16384
  ds_read_b64_tr_b16 a[66:67], v32 offset:16896
  ds_read_b64_tr_b16 a[68:69], v33 offset:16384
  ds_read_b64_tr_b16 a[70:71], v33 offset:16896
  ds_read_b64_tr_b16 a[72:73], v34 offset:16384
  ds_read_b64_tr_b16 a[74:75], v34 offset:16896
  s_add_u32 m0, s87, 7168
  s_add_u32 s88, s89, 884736
  buffer_load_dwordx4 v41, s[28:31], s88 offen lds
  ds_read_b64_tr_b16 a[76:77], v35 offset:16384
  ds_read_b64_tr_b16 a[78:79], v35 offset:16896
  s_mov_b32 s32, s50
  s_mov_b32 s33, s51
  s_mov_b32 s34, 4096
  s_mov_b32 s35, 0x20000
  s_add_u32 m0, s87, 8192
  s_add_u32 s88, s89, 917504
  buffer_load_dwordx4 v40, s[28:31], s88 offen lds
  v_lshrrev_b32 v10, 3, v0
  s_lshl_b32 s72, s58, 7
  v_lshl_add_u32 v11, v10, 1, s72
  buffer_load_ushort v12, v11, s[32:35], 0 offen
  buffer_load_ushort v13, v11, s[32:35], 0 offen offset:64
  s_mul_i32 s72, s59, 176128
  s_add_u32 m0, s87, 9216
  s_add_u32 s88, s89, 950272
  buffer_load_dwordx4 v41, s[28:31], s88 offen lds
  s_lshl_b32 s73, s61, 21
  s_add_u32 s72, s72, s73
  s_add_u32 s72, s72, 17825792
  s_add_u32 s24, s56, s72
  s_addc_u32 s25, s57, 0
  s_mov_b32 s26, 176128
  s_add_u32 m0, s87, 10240
  s_add_u32 s88, s89, 983040
  buffer_load_dwordx4 v40, s[28:31], s88 offen lds
  s_mov_b32 s27, 0x20000
  v_and_b32 v3, 15, v1
  v_lshrrev_b32 v4, 4, v1
  v_and_b32 v5, 7, v1
  s_lshl_b32 s72, s60, 14
  v_add_u32 v6, 0, v4
  s_add_u32 m0, s87, 11264
  s_add_u32 s88, s89, 1015808
  buffer_load_dwordx4 v41, s[28:31], s88 offen lds
  v_xor_b32 v6, v6, v5
  v_lshlrev_b32 v6, 4, v6
  v_lshl_add_u32 v6, v3, 8, v6
  v_add_u32 v14, s72, v6
  v_add_u32 v6, 4, v4
  v_xor_b32 v6, v6, v5
  s_add_u32 m0, s87, 12288
  s_add_u32 s88, s89, 1048576
  buffer_load_dwordx4 v40, s[28:31], s88 offen lds
  v_lshlrev_b32 v6, 4, v6
  v_lshl_add_u32 v6, v3, 8, v6
  v_add_u32 v15, s72, v6
  v_add_u32 v6, 8, v4
  v_xor_b32 v6, v6, v5
  v_lshlrev_b32 v6, 4, v6
  s_add_u32 m0, s87, 13312
  s_add_u32 s88, s89, 1081344
  buffer_load_dwordx4 v41, s[28:31], s88 offen lds
  v_lshl_add_u32 v6, v3, 8, v6
  v_add_u32 v16, s72, v6
  v_add_u32 v6, 12, v4
  v_xor_b32 v6, v6, v5
  v_lshlrev_b32 v6, 4, v6
  v_lshl_add_u32 v6, v3, 8, v6
  s_add_u32 m0, s87, 14336
  s_add_u32 s88, s89, 1114112
  buffer_load_dwordx4 v40, s[28:31], s88 offen lds
  v_add_u32 v17, s72, v6
  s_add_u32 m0, s87, 15360
  s_add_u32 s88, s89, 1146880
  buffer_load_dwordx4 v41, s[28:31], s88 offen lds
  s_waitcnt lgkmcnt(0)
  v_and_b32 v3, 7, v0
  v_and_b32 v4, 7, v10
  v_lshlrev_b32 v5, 1, v3
  v_add_u32 v6, 0, v5
  v_xor_b32 v6, v6, v4
  v_lshlrev_b32 v6, 4, v6
  v_lshl_add_u32 v18, v10, 8, v6
  v_add_u32 v6, 1, v5
  v_xor_b32 v6, v6, v4
  v_lshlrev_b32 v6, 4, v6
  v_lshl_add_u32 v19, v10, 8, v6
  v_mul_u32_u24 v20, 144, v10
  v_lshl_add_u32 v20, v3, 4, v20
  v_add_u32 v20, 147456, v20
  v_lshlrev_b32 v21, 10, v10
  v_lshl_add_u32 v21, v3, 4, v21
  s_mul_i32 s72, s60, 352
  s_mul_hi_u32 s72, s72, 89478486
  s_sub_u32 s72, s72, 0
  v_add_u32 v8, s72, v1
  v_max_i32 v8, 0, v8
  v_min_u32 v8, 28, v8
  v_cmp_le_u32 vcc, 8, v8
  s_nop 1
  v_cndmask_b32 v6, 0, 1, vcc
  v_cmp_le_u32 vcc, 15, v8
  s_nop 1
  v_addc_co_u32 v6, vcc, 0, v6, vcc
  v_cmp_le_u32 vcc, 22, v8
  s_nop 1
  v_addc_co_u32 v6, vcc, 0, v6, vcc
  v_mul_u32_u24 v7, 7, v6
  v_min_u32 v9, 1, v6
  v_add_u32 v7, v7, v9
  v_sub_u32 v7, v8, v7
  s_and_b32 s72, s59, 3
  s_lshr_b32 s73, s59, 2
  v_lshl_add_u32 v7, v7, 2, s72
  v_lshlrev_b32 v7, 3, v7
  v_lshl_add_u32 v9, v6, 1, v7
  v_add_u32 v9, s73, v9
  s_lshl_b32 s70, s61, 15
  s_add_u32 s70, s70, 200704
  v_lshlrev_b32 v9, 7, v9
  v_add_u32 v9, s70, v9
  s_mov_b64 exec, 0xff
  buffer_load_dwordx2 v[26:27], v9, s[16:19], 0 offen sc1
  s_mov_b64 exec, -1
  s_add_u32 m0, s86, 0
  s_add_u32 s88, s89, 1179648
  buffer_load_dwordx4 v40, s[28:31], s88 offen lds
  s_add_u32 m0, s86, 1024
  s_add_u32 s88, s89, 1212416
  buffer_load_dwordx4 v41, s[28:31], s88 offen lds
  s_add_u32 m0, s86, 2048
  s_add_u32 s88, s89, 1245184
  buffer_load_dwordx4 v40, s[28:31], s88 offen lds
  s_add_u32 m0, s86, 3072
  s_add_u32 s88, s89, 1277952
  buffer_load_dwordx4 v41, s[28:31], s88 offen lds
  s_add_u32 m0, s86, 4096
  s_add_u32 s88, s89, 1310720
  buffer_load_dwordx4 v40, s[28:31], s88 offen lds
  s_add_u32 m0, s86, 5120
  s_add_u32 s88, s89, 1343488
  buffer_load_dwordx4 v41, s[28:31], s88 offen lds
  s_add_u32 m0, s86, 6144
  s_add_u32 s88, s89, 1376256
  buffer_load_dwordx4 v40, s[28:31], s88 offen lds
  s_add_u32 m0, s86, 7168
  s_add_u32 s88, s89, 1409024
  buffer_load_dwordx4 v41, s[28:31], s88 offen lds
  s_mov_b64 exec, 0xff
  s_waitcnt vmcnt(8)
  v_cmp_ne_u64 vcc, s[62:63], v[26:27]
  s_mov_b64 exec, -1
  s_cbranch_vccz L_upr_63
  s_mov_b64 exec, 0xff
  s_mov_b32 s100, 0
  s_cbranch_execz L_pok_65
L_poll_64:
  buffer_load_dwordx2 v[4:5], v9, s[16:19], 0 offen sc1
  s_waitcnt vmcnt(0)
  v_cmp_ne_u64 vcc, s[62:63], v[4:5]
  s_nop 0
  s_cbranch_vccz L_pok_65
  s_add_u32 s100, s100, 1
  s_cmp_lt_u32 s100, 400000
  s_cbranch_scc1 L_poll_64
  s_branch L_fail
L_pok_65:
  s_mov_b64 exec, -1
L_upr_63:
  s_mul_i32 s85, s60, 45056
  s_add_u32 s84, s85, 0
  buffer_load_dwordx4 v[64:67], v2, s[24:27], s84 offen offset:0 sc1
  v_add_u32 v32, s87, v42
  v_add_u32 v33, s87, v43
  v_add_u32 v34, s87, v44
  v_add_u32 v35, s87, v45
  buffer_load_dwordx4 v[68:71], v2, s[24:27], s84 offen offset:1024 sc1
  ds_read_b64_tr_b16 a[80:81], v32 offset:0
  ds_read_b64_tr_b16 a[82:83], v32 offset:512
  ds_read_b64_tr_b16 a[84:85], v33 offset:0
  ds_read_b64_tr_b16 a[86:87], v33 offset:512
  buffer_load_dwordx4 v[72:75], v2, s[24:27], s84 offen offset:2048 sc1
  ds_read_b64_tr_b16 a[88:89], v34 offset:0
  ds_read_b64_tr_b16 a[90:91], v34 offset:512
  ds_read_b64_tr_b16 a[92:93], v35 offset:0
  ds_read_b64_tr_b16 a[94:95], v35 offset:512
  buffer_load_dwordx4 v[76:79], v2, s[24:27], s84 offen offset:3072 sc1
  ds_read_b64_tr_b16 a[96:97], v32 offset:4096
  ds_read_b64_tr_b16 a[98:99], v32 offset:4608
  ds_read_b64_tr_b16 a[100:101], v33 offset:4096
  ds_read_b64_tr_b16 a[102:103], v33 offset:4608
  s_add_u32 s84, s85, 4096
  buffer_load_dwordx4 v[80:83], v2, s[24:27], s84 offen offset:0 sc1
  ds_read_b64_tr_b16 a[104:105], v34 offset:4096
  ds_read_b64_tr_b16 a[106:107], v34 offset:4608
  ds_read_b64_tr_b16 a[108:109], v35 offset:4096
  ds_read_b64_tr_b16 a[110:111], v35 offset:4608
  buffer_load_dwordx4 v[84:87], v2, s[24:27], s84 offen offset:1024 sc1
  ds_read_b64_tr_b16 a[112:113], v32 offset:8192
  ds_read_b64_tr_b16 a[114:115], v32 offset:8704
  ds_read_b64_tr_b16 a[116:117], v33 offset:8192
  ds_read_b64_tr_b16 a[118:119], v33 offset:8704
  buffer_load_dwordx4 v[88:91], v2, s[24:27], s84 offen offset:2048 sc1
  ds_read_b64_tr_b16 a[120:121], v34 offset:8192
  ds_read_b64_tr_b16 a[122:123], v34 offset:8704
  ds_read_b64_tr_b16 a[124:125], v35 offset:8192
  ds_read_b64_tr_b16 a[126:127], v35 offset:8704
  buffer_load_dwordx4 v[92:95], v2, s[24:27], s84 offen offset:3072 sc1
  ds_read_b64_tr_b16 a[128:129], v32 offset:12288
  ds_read_b64_tr_b16 a[130:131], v32 offset:12800
  ds_read_b64_tr_b16 a[132:133], v33 offset:12288
  ds_read_b64_tr_b16 a[134:135], v33 offset:12800
  s_add_u32 s84, s85, 8192
  buffer_load_dwordx4 v[96:99], v2, s[24:27], s84 offen offset:0 sc1
  ds_read_b64_tr_b16 a[136:137], v34 offset:12288
  ds_read_b64_tr_b16 a[138:139], v34 offset:12800
  ds_read_b64_tr_b16 a[140:141], v35 offset:12288
  ds_read_b64_tr_b16 a[142:143], v35 offset:12800
  buffer_load_dwordx4 v[100:103], v2, s[24:27], s84 offen offset:1024 sc1
  s_waitcnt vmcnt(10)
  buffer_load_dwordx4 v[104:107], v2, s[24:27], s84 offen offset:2048 sc1
  v_add_u32 v32, s86, v42
  v_add_u32 v33, s86, v43
  v_add_u32 v34, s86, v44
  v_add_u32 v35, s86, v45
  ds_read_b64_tr_b16 a[144:145], v32 offset:0
  buffer_load_dwordx4 v[108:111], v2, s[24:27], s84 offen offset:3072 sc1
  ds_read_b64_tr_b16 a[146:147], v32 offset:512
  ds_read_b64_tr_b16 a[148:149], v33 offset:0
  ds_read_b64_tr_b16 a[150:151], v33 offset:512
  ds_read_b64_tr_b16 a[152:153], v34 offset:0
  ds_read_b64_tr_b16 a[154:155], v34 offset:512
  s_add_u32 s84, s85, 12288
  buffer_load_dwordx4 v[112:115], v2, s[24:27], s84 offen offset:0 sc1
  ds_read_b64_tr_b16 a[156:157], v35 offset:0
  ds_read_b64_tr_b16 a[158:159], v35 offset:512
  ds_read_b64_tr_b16 a[160:161], v32 offset:4096
  ds_read_b64_tr_b16 a[162:163], v32 offset:4608
  ds_read_b64_tr_b16 a[164:165], v33 offset:4096
  buffer_load_dwordx4 v[116:119], v2, s[24:27], s84 offen offset:1024 sc1
  ds_read_b64_tr_b16 a[166:167], v33 offset:4608
  ds_read_b64_tr_b16 a[168:169], v34 offset:4096
  ds_read_b64_tr_b16 a[170:171], v34 offset:4608
  ds_read_b64_tr_b16 a[172:173], v35 offset:4096
  ds_read_b64_tr_b16 a[174:175], v35 offset:4608
  s_waitcnt vmcnt(13)
  v_mfma_f32_16x16x32_bf16 a[192:195], v[64:67], a[0:3], 0
  v_mfma_f32_16x16x32_bf16 a[196:199], v[64:67], a[4:7], 0
  buffer_load_dwordx4 v[120:123], v2, s[24:27], s84 offen offset:2048 sc1
  v_mfma_f32_16x16x32_bf16 a[200:203], v[64:67], a[8:11], 0
  v_mfma_f32_16x16x32_bf16 a[204:207], v[64:67], a[12:15], 0
  s_waitcnt vmcnt(13)
  v_mfma_f32_16x16x32_bf16 a[208:211], v[68:71], a[0:3], 0
  v_mfma_f32_16x16x32_bf16 a[212:215], v[68:71], a[4:7], 0
  buffer_load_dwordx4 v[124:127], v2, s[24:27], s84 offen offset:3072 sc1
  v_mfma_f32_16x16x32_bf16 a[216:219], v[68:71], a[8:11], 0
  v_mfma_f32_16x16x32_bf16 a[220:223], v[68:71], a[12:15], 0
  s_waitcnt vmcnt(13)
  v_mfma_f32_16x16x32_bf16 a[224:227], v[72:75], a[0:3], 0
  v_mfma_f32_16x16x32_bf16 a[228:231], v[72:75], a[4:7], 0
  s_add_u32 s84, s85, 16384
  buffer_load_dwordx4 v[128:131], v2, s[24:27], s84 offen offset:0 sc1
  v_mfma_f32_16x16x32_bf16 a[232:235], v[72:75], a[8:11], 0
  v_mfma_f32_16x16x32_bf16 a[236:239], v[72:75], a[12:15], 0
  s_waitcnt vmcnt(13)
  v_mfma_f32_16x16x32_bf16 a[240:243], v[76:79], a[0:3], 0
  v_mfma_f32_16x16x32_bf16 a[244:247], v[76:79], a[4:7], 0
  buffer_load_dwordx4 v[132:135], v2, s[24:27], s84 offen offset:1024 sc1
  v_mfma_f32_16x16x32_bf16 a[248:251], v[76:79], a[8:11], 0
  v_mfma_f32_16x16x32_bf16 a[252:255], v[76:79], a[12:15], 0
  s_waitcnt vmcnt(13)
  v_mfma_f32_16x16x32_bf16 a[192:195], v[80:83], a[16:19], a[192:195]
  v_mfma_f32_16x16x32_bf16 a[196:199], v[80:83], a[20:23], a[196:199]
  buffer_load_dwordx4 v[136:139], v2, s[24:27], s84 offen offset:2048 sc1
  v_mfma_f32_16x16x32_bf16 a[200:203], v[80:83], a[24:27], a[200:203]
  v_mfma_f32_16x16x32_bf16 a[204:207], v[80:83], a[28:31], a[204:207]
  s_waitcnt vmcnt(13)
  v_mfma_f32_16x16x32_bf16 a[208:211], v[84:87], a[16:19], a[208:211]
  v_mfma_f32_16x16x32_bf16 a[212:215], v[84:87], a[20:23], a[212:215]
  buffer_load_dwordx4 v[140:143], v2, s[24:27], s84 offen offset:3072 sc1
  v_mfma_f32_16x16x32_bf16 a[216:219], v[84:87], a[24:27], a[216:219]
  v_mfma_f32_16x16x32_bf16 a[220:223], v[84:87], a[28:31], a[220:223]
  s_waitcnt vmcnt(13)
  v_mfma_f32_16x16x32_bf16 a[224:227], v[88:91], a[16:19], a[224:227]
  v_mfma_f32_16x16x32_bf16 a[228:231], v[88:91], a[20:23], a[228:231]
  s_add_u32 s84, s85, 20480
  buffer_load_dwordx4 v[144:147], v2, s[24:27], s84 offen offset:0 sc1
  v_mfma_f32_16x16x32_bf16 a[232:235], v[88:91], a[24:27], a[232:235]
  v_mfma_f32_16x16x32_bf16 a[236:239], v[88:91], a[28:31], a[236:239]
  s_waitcnt vmcnt(13)
  v_mfma_f32_16x16x32_bf16 a[240:243], v[92:95], a[16:19], a[240:243]
  v_mfma_f32_16x16x32_bf16 a[244:247], v[92:95], a[20:23], a[244:247]
  buffer_load_dwordx4 v[148:151], v2, s[24:27], s84 offen offset:1024 sc1
  v_mfma_f32_16x16x32_bf16 a[248:251], v[92:95], a[24:27], a[248:251]
  v_mfma_f32_16x16x32_bf16 a[252:255], v[92:95], a[28:31], a[252:255]
  s_waitcnt vmcnt(13)
  v_mfma_f32_16x16x32_bf16 a[192:195], v[96:99], a[32:35], a[192:195]
  v_mfma_f32_16x16x32_bf16 a[196:199], v[96:99], a[36:39], a[196:199]
  buffer_load_dwordx4 v[152:155], v2, s[24:27], s84 offen offset:2048 sc1
  v_mfma_f32_16x16x32_bf16 a[200:203], v[96:99], a[40:43], a[200:203]
  v_mfma_f32_16x16x32_bf16 a[204:207], v[96:99], a[44:47], a[204:207]
  s_waitcnt vmcnt(13)
  v_mfma_f32_16x16x32_bf16 a[208:211], v[100:103], a[32:35], a[208:211]
  v_mfma_f32_16x16x32_bf16 a[212:215], v[100:103], a[36:39], a[212:215]
  buffer_load_dwordx4 v[156:159], v2, s[24:27], s84 offen offset:3072 sc1
  v_mfma_f32_16x16x32_bf16 a[216:219], v[100:103], a[40:43], a[216:219]
  v_mfma_f32_16x16x32_bf16 a[220:223], v[100:103], a[44:47], a[220:223]
  s_waitcnt vmcnt(13)
  v_mfma_f32_16x16x32_bf16 a[224:227], v[104:107], a[32:35], a[224:227]
  v_mfma_f32_16x16x32_bf16 a[228:231], v[104:107], a[36:39], a[228:231]
  s_add_u32 s84, s85, 24576
  buffer_load_dwordx4 v[160:163], v2, s[24:27], s84 offen offset:0 sc1
  v_mfma_f32_16x16x32_bf16 a[232:235], v[104:107], a[40:43], a[232:235]
  v_mfma_f32_16x16x32_bf16 a[236:239], v[104:107], a[44:47], a[236:239]
  s_waitcnt vmcnt(13)
  v_mfma_f32_16x16x32_bf16 a[240:243], v[108:111], a[32:35], a[240:243]
  v_mfma_f32_16x16x32_bf16 a[244:247], v[108:111], a[36:39], a[244:247]
  buffer_load_dwordx4 v[164:167], v2, s[24:27], s84 offen offset:1024 sc1
  v_mfma_f32_16x16x32_bf16 a[248:251], v[108:111], a[40:43], a[248:251]
  v_mfma_f32_16x16x32_bf16 a[252:255], v[108:111], a[44:47], a[252:255]
  s_waitcnt vmcnt(13)
  v_mfma_f32_16x16x32_bf16 a[192:195], v[112:115], a[48:51], a[192:195]
  v_mfma_f32_16x16x32_bf16 a[196:199], v[112:115], a[52:55], a[196:199]
  buffer_load_dwordx4 v[168:171], v2, s[24:27], s84 offen offset:2048 sc1
  v_mfma_f32_16x16x32_bf16 a[200:203], v[112:115], a[56:59], a[200:203]
  v_mfma_f32_16x16x32_bf16 a[204:207], v[112:115], a[60:63], a[204:207]
  s_waitcnt vmcnt(13)
  v_mfma_f32_16x16x32_bf16 a[208:211], v[116:119], a[48:51], a[208:211]
  v_mfma_f32_16x16x32_bf16 a[212:215], v[116:119], a[52:55], a[212:215]
  buffer_load_dwordx4 v[172:175], v2, s[24:27], s84 offen offset:3072 sc1
  v_mfma_f32_16x16x32_bf16 a[216:219], v[116:119], a[56:59], a[216:219]
  v_mfma_f32_16x16x32_bf16 a[220:223], v[116:119], a[60:63], a[220:223]
  s_waitcnt vmcnt(13)
  v_mfma_f32_16x16x32_bf16 a[224:227], v[120:123], a[48:51], a[224:227]
  v_mfma_f32_16x16x32_bf16 a[228:231], v[120:123], a[52:55], a[228:231]
  s_add_u32 s84, s85, 28672
  buffer_load_dwordx4 v[176:179], v2, s[24:27], s84 offen offset:0 sc1
  v_mfma_f32_16x16x32_bf16 a[232:235], v[120:123], a[56:59], a[232:235]
  v_mfma_f32_16x16x32_bf16 a[236:239], v[120:123], a[60:63], a[236:239]
  s_waitcnt vmcnt(13)
  v_mfma_f32_16x16x32_bf16 a[240:243], v[124:127], a[48:51], a[240:243]
  v_mfma_f32_16x16x32_bf16 a[244:247], v[124:127], a[52:55], a[244:247]
  buffer_load_dwordx4 v[180:183], v2, s[24:27], s84 offen offset:1024 sc1
  v_mfma_f32_16x16x32_bf16 a[248:251], v[124:127], a[56:59], a[248:251]
  v_mfma_f32_16x16x32_bf16 a[252:255], v[124:127], a[60:63], a[252:255]
  s_waitcnt vmcnt(13)
  v_mfma_f32_16x16x32_bf16 a[192:195], v[128:131], a[64:67], a[192:195]
  v_mfma_f32_16x16x32_bf16 a[196:199], v[128:131], a[68:71], a[196:199]
  buffer_load_dwordx4 v[184:187], v2, s[24:27], s84 offen offset:2048 sc1
  v_mfma_f32_16x16x32_bf16 a[200:203], v[128:131], a[72:75], a[200:203]
  v_mfma_f32_16x16x32_bf16 a[204:207], v[128:131], a[76:79], a[204:207]
  s_waitcnt vmcnt(13)
  v_mfma_f32_16x16x32_bf16 a[208:211], v[132:135], a[64:67], a[208:211]
  v_mfma_f32_16x16x32_bf16 a[212:215], v[132:135], a[68:71], a[212:215]
  buffer_load_dwordx4 v[188:191], v2, s[24:27], s84 offen offset:3072 sc1
  v_mfma_f32_16x16x32_bf16 a[216:219], v[132:135], a[72:75], a[216:219]
  v_mfma_f32_16x16x32_bf16 a[220:223], v[132:135], a[76:79], a[220:223]
  s_waitcnt vmcnt(13)
  v_mfma_f32_16x16x32_bf16 a[224:227], v[136:139], a[64:67], a[224:227]
  v_mfma_f32_16x16x32_bf16 a[228:231], v[136:139], a[68:71], a[228:231]
  s_add_u32 s84, s85, 32768
  buffer_load_dwordx4 v[192:195], v2, s[24:27], s84 offen offset:0 sc1
  v_mfma_f32_16x16x32_bf16 a[232:235], v[136:139], a[72:75], a[232:235]
  v_mfma_f32_16x16x32_bf16 a[236:239], v[136:139], a[76:79], a[236:239]
  s_waitcnt vmcnt(13)
  v_mfma_f32_16x16x32_bf16 a[240:243], v[140:143], a[64:67], a[240:243]
  v_mfma_f32_16x16x32_bf16 a[244:247], v[140:143], a[68:71], a[244:247]
  buffer_load_dwordx4 v[196:199], v2, s[24:27], s84 offen offset:1024 sc1
  v_mfma_f32_16x16x32_bf16 a[248:251], v[140:143], a[72:75], a[248:251]
  v_mfma_f32_16x16x32_bf16 a[252:255], v[140:143], a[76:79], a[252:255]
  s_waitcnt vmcnt(13) lgkmcnt(15)
  v_mfma_f32_16x16x32_bf16 a[192:195], v[144:147], a[80:83], a[192:195]
  s_waitcnt lgkmcnt(15)
  v_mfma_f32_16x16x32_bf16 a[196:199], v[144:147], a[84:87], a[196:199]
  buffer_load_dwordx4 v[200:203], v2, s[24:27], s84 offen offset:2048 sc1
  s_waitcnt lgkmcnt(15)
  v_mfma_f32_16x16x32_bf16 a[200:203], v[144:147], a[88:91], a[200:203]
  s_waitcnt lgkmcnt(15)
  v_mfma_f32_16x16x32_bf16 a[204:207], v[144:147], a[92:95], a[204:207]
  s_waitcnt vmcnt(13)
  v_mfma_f32_16x16x32_bf16 a[208:211], v[148:151], a[80:83], a[208:211]
  v_mfma_f32_16x16x32_bf16 a[212:215], v[148:151], a[84:87], a[212:215]
  buffer_load_dwordx4 v[204:207], v2, s[24:27], s84 offen offset:3072 sc1
  v_mfma_f32_16x16x32_bf16 a[216:219], v[148:151], a[88:91], a[216:219]
  v_mfma_f32_16x16x32_bf16 a[220:223], v[148:151], a[92:95], a[220:223]
  s_waitcnt vmcnt(13)
  v_mfma_f32_16x16x32_bf16 a[224:227], v[152:155], a[80:83], a[224:227]
  v_mfma_f32_16x16x32_bf16 a[228:231], v[152:155], a[84:87], a[228:231]
  s_add_u32 s84, s85, 36864
  buffer_load_dwordx4 v[208:211], v2, s[24:27], s84 offen offset:0 sc1
  v_mfma_f32_16x16x32_bf16 a[232:235], v[152:155], a[88:91], a[232:235]
  v_mfma_f32_16x16x32_bf16 a[236:239], v[152:155], a[92:95], a[236:239]
  s_waitcnt vmcnt(13)
  v_mfma_f32_16x16x32_bf16 a[240:243], v[156:159], a[80:83], a[240:243]
  v_mfma_f32_16x16x32_bf16 a[244:247], v[156:159], a[84:87], a[244:247]
  buffer_load_dwordx4 v[212:215], v2, s[24:27], s84 offen offset:1024 sc1
  v_mfma_f32_16x16x32_bf16 a[248:251], v[156:159], a[88:91], a[248:251]
  v_mfma_f32_16x16x32_bf16 a[252:255], v[156:159], a[92:95], a[252:255]
  s_waitcnt vmcnt(13) lgkmcnt(15)
  v_mfma_f32_16x16x32_bf16 a[192:195], v[160:163], a[96:99], a[192:195]
  s_waitcnt lgkmcnt(15)
  v_mfma_f32_16x16x32_bf16 a[196:199], v[160:163], a[100:103], a[196:199]
  buffer_load_dwordx4 v[216:219], v2, s[24:27], s84 offen offset:2048 sc1
  s_waitcnt lgkmcnt(15)
  v_mfma_f32_16x16x32_bf16 a[200:203], v[160:163], a[104:107], a[200:203]
  s_waitcnt lgkmcnt(15)
  v_mfma_f32_16x16x32_bf16 a[204:207], v[160:163], a[108:111], a[204:207]
  s_waitcnt vmcnt(13)
  v_mfma_f32_16x16x32_bf16 a[208:211], v[164:167], a[96:99], a[208:211]
  v_mfma_f32_16x16x32_bf16 a[212:215], v[164:167], a[100:103], a[212:215]
  buffer_load_dwordx4 v[220:223], v2, s[24:27], s84 offen offset:3072 sc1
  v_mfma_f32_16x16x32_bf16 a[216:219], v[164:167], a[104:107], a[216:219]
  v_mfma_f32_16x16x32_bf16 a[220:223], v[164:167], a[108:111], a[220:223]
  s_waitcnt vmcnt(13)
  v_mfma_f32_16x16x32_bf16 a[224:227], v[168:171], a[96:99], a[224:227]
  v_mfma_f32_16x16x32_bf16 a[228:231], v[168:171], a[100:103], a[228:231]
  s_add_u32 s84, s85, 40960
  buffer_load_dwordx4 v[224:227], v2, s[24:27], s84 offen offset:0 sc1
  v_mfma_f32_16x16x32_bf16 a[232:235], v[168:171], a[104:107], a[232:235]
  v_mfma_f32_16x16x32_bf16 a[236:239], v[168:171], a[108:111], a[236:239]
  s_waitcnt vmcnt(13)
  v_mfma_f32_16x16x32_bf16 a[240:243], v[172:175], a[96:99], a[240:243]
  v_mfma_f32_16x16x32_bf16 a[244:247], v[172:175], a[100:103], a[244:247]
  buffer_load_dwordx4 v[228:231], v2, s[24:27], s84 offen offset:1024 sc1
  v_mfma_f32_16x16x32_bf16 a[248:251], v[172:175], a[104:107], a[248:251]
  v_mfma_f32_16x16x32_bf16 a[252:255], v[172:175], a[108:111], a[252:255]
  s_waitcnt vmcnt(13) lgkmcnt(15)
  v_mfma_f32_16x16x32_bf16 a[192:195], v[176:179], a[112:115], a[192:195]
  s_waitcnt lgkmcnt(15)
  v_mfma_f32_16x16x32_bf16 a[196:199], v[176:179], a[116:119], a[196:199]
  buffer_load_dwordx4 v[232:235], v2, s[24:27], s84 offen offset:2048 sc1
  s_waitcnt lgkmcnt(15)
  v_mfma_f32_16x16x32_bf16 a[200:203], v[176:179], a[120:123], a[200:203]
  s_waitcnt lgkmcnt(15)
  v_mfma_f32_16x16x32_bf16 a[204:207], v[176:179], a[124:127], a[204:207]
  s_waitcnt vmcnt(13)
  v_mfma_f32_16x16x32_bf16 a[208:211], v[180:183], a[112:115], a[208:211]
  v_mfma_f32_16x16x32_bf16 a[212:215], v[180:183], a[116:119], a[212:215]
  buffer_load_dwordx4 v[236:239], v2, s[24:27], s84 offen offset:3072 sc1
  v_mfma_f32_16x16x32_bf16 a[216:219], v[180:183], a[120:123], a[216:219]
  v_mfma_f32_16x16x32_bf16 a[220:223], v[180:183], a[124:127], a[220:223]
  s_waitcnt vmcnt(13)
  v_mfma_f32_16x16x32_bf16 a[224:227], v[184:187], a[112:115], a[224:227]
  v_mfma_f32_16x16x32_bf16 a[228:231], v[184:187], a[116:119], a[228:231]
  v_mfma_f32_16x16x32_bf16 a[232:235], v[184:187], a[120:123], a[232:235]
  v_mfma_f32_16x16x32_bf16 a[236:239], v[184:187], a[124:127], a[236:239]
  s_waitcnt vmcnt(12)
  v_mfma_f32_16x16x32_bf16 a[240:243], v[188:191], a[112:115], a[240:243]
  v_mfma_f32_16x16x32_bf16 a[244:247], v[188:191], a[116:119], a[244:247]
  v_mfma_f32_16x16x32_bf16 a[248:251], v[188:191], a[120:123], a[248:251]
  v_mfma_f32_16x16x32_bf16 a[252:255], v[188:191], a[124:127], a[252:255]
  s_waitcnt vmcnt(11) lgkmcnt(15)
  v_mfma_f32_16x16x32_bf16 a[192:195], v[192:195], a[128:131], a[192:195]
  s_waitcnt lgkmcnt(15)
  v_mfma_f32_16x16x32_bf16 a[196:199], v[192:195], a[132:135], a[196:199]
  s_waitcnt lgkmcnt(15)
  v_mfma_f32_16x16x32_bf16 a[200:203], v[192:195], a[136:139], a[200:203]
  s_waitcnt lgkmcnt(15)
  v_mfma_f32_16x16x32_bf16 a[204:207], v[192:195], a[140:143], a[204:207]
  s_waitcnt vmcnt(10)
  v_mfma_f32_16x16x32_bf16 a[208:211], v[196:199], a[128:131], a[208:211]
  v_mfma_f32_16x16x32_bf16 a[212:215], v[196:199], a[132:135], a[212:215]
  v_mfma_f32_16x16x32_bf16 a[216:219], v[196:199], a[136:139], a[216:219]
  v_mfma_f32_16x16x32_bf16 a[220:223], v[196:199], a[140:143], a[220:223]
  s_waitcnt vmcnt(9)
  v_mfma_f32_16x16x32_bf16 a[224:227], v[200:203], a[128:131], a[224:227]
  v_mfma_f32_16x16x32_bf16 a[228:231], v[200:203], a[132:135], a[228:231]
  v_mfma_f32_16x16x32_bf16 a[232:235], v[200:203], a[136:139], a[232:235]
  v_mfma_f32_16x16x32_bf16 a[236:239], v[200:203], a[140:143], a[236:239]
  s_waitcnt vmcnt(8)
  v_mfma_f32_16x16x32_bf16 a[240:243], v[204:207], a[128:131], a[240:243]
  v_mfma_f32_16x16x32_bf16 a[244:247], v[204:207], a[132:135], a[244:247]
  v_mfma_f32_16x16x32_bf16 a[248:251], v[204:207], a[136:139], a[248:251]
  v_mfma_f32_16x16x32_bf16 a[252:255], v[204:207], a[140:143], a[252:255]
  s_waitcnt vmcnt(7) lgkmcnt(14)
  v_mfma_f32_16x16x32_bf16 a[192:195], v[208:211], a[144:147], a[192:195]
  s_waitcnt lgkmcnt(12)
  v_mfma_f32_16x16x32_bf16 a[196:199], v[208:211], a[148:151], a[196:199]
  s_waitcnt lgkmcnt(10)
  v_mfma_f32_16x16x32_bf16 a[200:203], v[208:211], a[152:155], a[200:203]
  s_waitcnt lgkmcnt(8)
  v_mfma_f32_16x16x32_bf16 a[204:207], v[208:211], a[156:159], a[204:207]
  s_waitcnt vmcnt(6)
  v_mfma_f32_16x16x32_bf16 a[208:211], v[212:215], a[144:147], a[208:211]
  v_mfma_f32_16x16x32_bf16 a[212:215], v[212:215], a[148:151], a[212:215]
  v_mfma_f32_16x16x32_bf16 a[216:219], v[212:215], a[152:155], a[216:219]
  v_mfma_f32_16x16x32_bf16 a[220:223], v[212:215], a[156:159], a[220:223]
  s_waitcnt vmcnt(5)
  v_mfma_f32_16x16x32_bf16 a[224:227], v[216:219], a[144:147], a[224:227]
  v_mfma_f32_16x16x32_bf16 a[228:231], v[216:219], a[148:151], a[228:231]
  v_mfma_f32_16x16x32_bf16 a[232:235], v[216:219], a[152:155], a[232:235]
  v_mfma_f32_16x16x32_bf16 a[236:239], v[216:219], a[156:159], a[236:239]
  s_waitcnt vmcnt(4)
  v_mfma_f32_16x16x32_bf16 a[240:243], v[220:223], a[144:147], a[240:243]
  v_mfma_f32_16x16x32_bf16 a[244:247], v[220:223], a[148:151], a[244:247]
  v_mfma_f32_16x16x32_bf16 a[248:251], v[220:223], a[152:155], a[248:251]
  v_mfma_f32_16x16x32_bf16 a[252:255], v[220:223], a[156:159], a[252:255]
  s_waitcnt vmcnt(3) lgkmcnt(6)
  v_mfma_f32_16x16x32_bf16 a[192:195], v[224:227], a[160:163], a[192:195]
  s_waitcnt lgkmcnt(4)
  v_mfma_f32_16x16x32_bf16 a[196:199], v[224:227], a[164:167], a[196:199]
  s_waitcnt lgkmcnt(2)
  v_mfma_f32_16x16x32_bf16 a[200:203], v[224:227], a[168:171], a[200:203]
  s_waitcnt lgkmcnt(0)
  v_mfma_f32_16x16x32_bf16 a[204:207], v[224:227], a[172:175], a[204:207]
  s_waitcnt vmcnt(2)
  v_mfma_f32_16x16x32_bf16 a[208:211], v[228:231], a[160:163], a[208:211]
  v_mfma_f32_16x16x32_bf16 a[212:215], v[228:231], a[164:167], a[212:215]
  v_mfma_f32_16x16x32_bf16 a[216:219], v[228:231], a[168:171], a[216:219]
  v_mfma_f32_16x16x32_bf16 a[220:223], v[228:231], a[172:175], a[220:223]
  ds_write_b128 v14, a[192:195] offset:0
  ds_write_b128 v14, a[196:199] offset:4096
  ds_write_b128 v14, a[200:203] offset:8192
  ds_write_b128 v14, a[204:207] offset:12288
  s_waitcnt vmcnt(1)
  v_mfma_f32_16x16x32_bf16 a[224:227], v[232:235], a[160:163], a[224:227]
  v_mfma_f32_16x16x32_bf16 a[228:231], v[232:235], a[164:167], a[228:231]
  v_mfma_f32_16x16x32_bf16 a[232:235], v[232:235], a[168:171], a[232:235]
  v_mfma_f32_16x16x32_bf16 a[236:239], v[232:235], a[172:175], a[236:239]
  ds_write_b128 v15, a[208:211] offset:0
  ds_write_b128 v15, a[212:215] offset:4096
  ds_write_b128 v15, a[216:219] offset:8192
  ds_write_b128 v15, a[220:223] offset:12288
  s_waitcnt vmcnt(0)
  v_mfma_f32_16x16x32_bf16 a[240:243], v[236:239], a[160:163], a[240:243]
  v_mfma_f32_16x16x32_bf16 a[244:247], v[236:239], a[164:167], a[244:247]
  v_mfma_f32_16x16x32_bf16 a[248:251], v[236:239], a[168:171], a[248:251]
  v_mfma_f32_16x16x32_bf16 a[252:255], v[236:239], a[172:175], a[252:255]
  ds_write_b128 v16, a[224:227] offset:0
  ds_write_b128 v16, a[228:231] offset:4096
  ds_write_b128 v16, a[232:235] offset:8192
  ds_write_b128 v16, a[236:239] offset:12288
  s_nop 0
  ds_write_b128 v17, a[240:243] offset:0
  ds_write_b128 v17, a[244:247] offset:4096
  ds_write_b128 v17, a[248:251] offset:8192
  ds_write_b128 v17, a[252:255] offset:12288
  s_waitcnt lgkmcnt(0)
  s_barrier
  s_lshl_b32 s72, s58, 16
  s_lshl_b32 s73, s59, 7
  s_add_u32 s72, s72, s73
  ds_read_b128 v[64:67], v18 offset:0
  ds_read_b128 v[68:71], v19 offset:0
  ds_read_b128 v[72:75], v18 offset:16384
  ds_read_b128 v[76:79], v19 offset:16384
  ds_read_b128 v[80:83], v18 offset:32768
  ds_read_b128 v[84:87], v19 offset:32768
  ds_read_b128 v[88:91], v18 offset:49152
  ds_read_b128 v[92:95], v19 offset:49152
  ds_read_b128 v[96:99], v20 offset:0
  ds_read_b128 v[112:115], v18 offset:8192
  ds_read_b128 v[116:119], v19 offset:8192
  ds_read_b128 v[120:123], v18 offset:24576
  ds_read_b128 v[124:127], v19 offset:24576
  ds_read_b128 v[128:131], v18 offset:40960
  ds_read_b128 v[132:135], v19 offset:40960
  ds_read_b128 v[136:139], v18 offset:57344
  ds_read_b128 v[140:143], v19 offset:57344
  ds_read_b128 v[144:147], v20 offset:4608
  v_lshrrev_b32 v3, 3, v1
  v_mul_u32_u24 v46, 3072, v3
  v_bfe_u32 v4, v1, 4, 1
  v_lshlrev_b32 v4, 2, v4
  v_and_b32 v5, 7, v1
  v_xor_b32 v5, v5, v4
  v_lshl_add_u32 v46, v5, 4, v46
  s_mul_i32 s80, s60, 24576
  s_lshl_b32 s82, s59, 7
  s_add_u32 s80, s80, s82
  s_lshl_b32 s81, s60, 10
  v_lshlrev_b32 v22, 16, v12
  s_waitcnt lgkmcnt(15)
  v_add_f32 v64, v64, v72
  s_waitcnt lgkmcnt(11)
  v_add_f32 v80, v80, v88
  v_add_f32 v65, v65, v73
  v_add_f32 v81, v81, v89
  s_add_u32 m0, s81, 65536
  s_add_u32 s82, s80, 1024
  buffer_load_dwordx4 v46, s[8:11], s82 offen lds
  v_add_f32 v66, v66, v74
  v_add_f32 v82, v82, v90
  v_add_f32 v67, v67, v75
  v_add_f32 v83, v83, v91
  s_add_u32 m0, s81, 69632
  s_add_u32 s82, s80, 99328
  buffer_load_dwordx4 v46, s[8:11], s82 offen lds
  v_add_f32 v68, v68, v76
  s_waitcnt lgkmcnt(10)
  v_add_f32 v84, v84, v92
  v_add_f32 v69, v69, v77
  v_add_f32 v85, v85, v93
  s_add_u32 m0, s81, 73728
  s_add_u32 s82, s80, 2048
  buffer_load_dwordx4 v46, s[8:11], s82 offen lds
  v_add_f32 v70, v70, v78
  v_add_f32 v86, v86, v94
  v_add_f32 v71, v71, v79
  v_add_f32 v87, v87, v95
  s_add_u32 m0, s81, 77824
  s_add_u32 s82, s80, 100352
  buffer_load_dwordx4 v46, s[8:11], s82 offen lds
  v_add_f32 v64, v64, v80
  v_add_f32 v65, v65, v81
  v_add_f32 v66, v66, v82
  v_add_f32 v67, v67, v83
  v_add_f32 v68, v68, v84
  v_add_f32 v69, v69, v85
  v_add_f32 v70, v70, v86
  v_add_f32 v71, v71, v87
  s_add_u32 m0, s81, 81920
  s_add_u32 s82, s80, 197632
  buffer_load_dwordx4 v46, s[8:11], s82 offen lds
  v_add_f32 v64, v64, v22
  v_add_f32 v65, v65, v22
  v_add_f32 v66, v66, v22
  v_add_f32 v67, v67, v22
  v_add_f32 v68, v68, v22
  v_add_f32 v69, v69, v22
  v_add_f32 v70, v70, v22
  v_add_f32 v71, v71, v22
  s_add_u32 m0, s81, 86016
  s_add_u32 s82, s80, 295936
  buffer_load_dwordx4 v46, s[8:11], s82 offen lds
  s_waitcnt lgkmcnt(9)
  v_lshlrev_b32 v72, 16, v96
  v_and_b32 v73, 0xffff0000, v96
  v_lshlrev_b32 v74, 16, v97
  v_and_b32 v75, 0xffff0000, v97
  v_lshlrev_b32 v76, 16, v98
  v_and_b32 v77, 0xffff0000, v98
  v_lshlrev_b32 v78, 16, v99
  v_and_b32 v79, 0xffff0000, v99
  s_add_u32 m0, s81, 90112
  s_add_u32 s82, s80, 198656
  buffer_load_dwordx4 v46, s[8:11], s82 offen lds
  v_add_f32 v64, v64, v72
  v_add_f32 v65, v65, v73
  v_add_f32 v66, v66, v74
  v_add_f32 v67, v67, v75
  v_add_f32 v68, v68, v76
  v_add_f32 v69, v69, v77
  v_add_f32 v70, v70, v78
  v_add_f32 v71, v71, v79
  s_add_u32 m0, s81, 94208
  s_add_u32 s82, s80, 296960
  buffer_load_dwordx4 v46, s[8:11], s82 offen lds
  v_cvt_pk_bf16_f32 v100, v64, v65
  v_cvt_pk_bf16_f32 v101, v66, v67
  v_cvt_pk_bf16_f32 v102, v68, v69
  v_cvt_pk_bf16_f32 v103, v70, v71
  ds_write_b128 v20, v[100:103] offset:0
  s_cmp_eq_u32 s0, 0
  s_cbranch_scc1 L_slow_66
  buffer_store_dwordx4 v[100:103], v21, s[20:23], s72 offen
  s_branch L_dj_67
L_slow_66:
  buffer_store_dwordx4 v[100:103], v21, s[20:23], s72 offen sc1
L_dj_67:
  s_add_u32 s72, s72, 32768
  v_add_f32 v104, v64, v65
  v_mul_f32 v105, v64, v64
  v_fmac_f32 v105, v65, v65
  v_add_f32 v104, v104, v66
  v_fmac_f32 v105, v66, v66
  v_add_f32 v104, v104, v67
  v_fmac_f32 v105, v67, v67
  v_add_f32 v104, v104, v68
  v_fmac_f32 v105, v68, v68
  v_add_f32 v104, v104, v69
  v_fmac_f32 v105, v69, v69
  v_add_f32 v104, v104, v70
  v_fmac_f32 v105, v70, v70
  v_add_f32 v104, v104, v71
  v_fmac_f32 v105, v71, v71
  s_add_u32 m0, s81, 98304
  s_add_u32 s82, s80, 394240
  buffer_load_dwordx4 v46, s[8:11], s82 offen lds
  s_add_u32 m0, s81, 102400
  s_add_u32 s82, s80, 492544
  buffer_load_dwordx4 v46, s[8:11], s82 offen lds
  v_lshlrev_b32 v22, 16, v13
  s_waitcnt lgkmcnt(7)
  v_add_f32 v112, v112, v120
  s_waitcnt lgkmcnt(3)
  v_add_f32 v128, v128, v136
  v_add_f32 v113, v113, v121
  v_add_f32 v129, v129, v137
  s_add_u32 m0, s81, 106496
  s_add_u32 s82, s80, 395264
  buffer_load_dwordx4 v46, s[8:11], s82 offen lds
  v_add_f32 v114, v114, v122
  v_add_f32 v130, v130, v138
  v_add_f32 v115, v115, v123
  v_add_f32 v131, v131, v139
  s_add_u32 m0, s81, 110592
  s_add_u32 s82, s80, 493568
  buffer_load_dwordx4 v46, s[8:11], s82 offen lds
  v_add_f32 v116, v116, v124
  s_waitcnt lgkmcnt(2)
  v_add_f32 v132, v132, v140
  v_add_f32 v117, v117, v125
  v_add_f32 v133, v133, v141
  s_add_u32 m0, s81, 114688
  s_add_u32 s82, s80, 590848
  buffer_load_dwordx4 v46, s[8:11], s82 offen lds
  v_add_f32 v118, v118, v126
  v_add_f32 v134, v134, v142
  v_add_f32 v119, v119, v127
  v_add_f32 v135, v135, v143
  s_add_u32 m0, s81, 118784
  s_add_u32 s82, s80, 689152
  buffer_load_dwordx4 v46, s[8:11], s82 offen lds
  v_add_f32 v112, v112, v128
  v_add_f32 v113, v113, v129
  v_add_f32 v114, v114, v130
  v_add_f32 v115, v115, v131
  v_add_f32 v116, v116, v132
  v_add_f32 v117, v117, v133
  v_add_f32 v118, v118, v134
  v_add_f32 v119, v119, v135
  s_add_u32 m0, s81, 122880
  s_add_u32 s82, s80, 591872
  buffer_load_dwordx4 v46, s[8:11], s82 offen lds
  v_add_f32 v112, v112, v22
  v_add_f32 v113, v113, v22
  v_add_f32 v114, v114, v22
  v_add_f32 v115, v115, v22
  v_add_f32 v116, v116, v22
  v_add_f32 v117, v117, v22
  v_add_f32 v118, v118, v22
  v_add_f32 v119, v119, v22
  s_add_u32 m0, s81, 126976
  s_add_u32 s82, s80, 690176
  buffer_load_dwordx4 v46, s[8:11], s82 offen lds
  s_waitcnt lgkmcnt(1)
  v_lshlrev_b32 v120, 16, v144
  v_and_b32 v121, 0xffff0000, v144
  v_lshlrev_b32 v122, 16, v145
  v_and_b32 v123, 0xffff0000, v145
  v_lshlrev_b32 v124, 16, v146
  v_and_b32 v125, 0xffff0000, v146
  v_lshlrev_b32 v126, 16, v147
  v_and_b32 v127, 0xffff0000, v147
  s_add_u32 m0, s81, 131072
  s_add_u32 s82, s80, 787456
  buffer_load_dwordx4 v46, s[8:11], s82 offen lds
  v_add_f32 v112, v112, v120
  v_add_f32 v113, v113, v121
  v_add_f32 v114, v114, v122
  v_add_f32 v115, v115, v123
  v_add_f32 v116, v116, v124
  v_add_f32 v117, v117, v125
  v_add_f32 v118, v118, v126
  v_add_f32 v119, v119, v127
  s_add_u32 m0, s81, 135168
  s_add_u32 s82, s80, 885760
  buffer_load_dwordx4 v46, s[8:11], s82 offen lds
  v_cvt_pk_bf16_f32 v148, v112, v113
  v_cvt_pk_bf16_f32 v149, v114, v115
  v_cvt_pk_bf16_f32 v150, v116, v117
  v_cvt_pk_bf16_f32 v151, v118, v119
  ds_write_b128 v20, v[148:151] offset:4608
  s_cmp_eq_u32 s0, 0
  s_cbranch_scc1 L_slow_68
  buffer_store_dwordx4 v[148:151], v21, s[20:23], s72 offen
  s_branch L_dj_69
L_slow_68:
  buffer_store_dwordx4 v[148:151], v21, s[20:23], s72 offen sc1
L_dj_69:
  v_add_f32 v152, v112, v113
  v_mul_f32 v153, v112, v112
  v_fmac_f32 v153, v113, v113
  v_add_f32 v152, v152, v114
  v_fmac_f32 v153, v114, v114
  v_add_f32 v152, v152, v115
  v_fmac_f32 v153, v115, v115
  v_add_f32 v152, v152, v116
  v_fmac_f32 v153, v116, v116
  v_add_f32 v152, v152, v117
  v_fmac_f32 v153, v117, v117
  v_add_f32 v152, v152, v118
  v_fmac_f32 v153, v118, v118
  v_add_f32 v152, v152, v119
  v_fmac_f32 v153, v119, v119
  s_add_u32 m0, s81, 139264
  s_add_u32 s82, s80, 788480
  buffer_load_dwordx4 v46, s[8:11], s82 offen lds
  s_add_u32 m0, s81, 143360
  s_add_u32 s82, s80, 886784
  buffer_load_dwordx4 v46, s[8:11], s82 offen lds
  v_mov_b32 v12, v46
  v_add_f32_dpp v104, v104, v104 quad_perm:[1,0,3,2] row_mask:0xf bank_mask:0xf
  v_add_f32_dpp v105, v105, v105 quad_perm:[1,0,3,2] row_mask:0xf bank_mask:0xf
  v_add_f32_dpp v152, v152, v152 quad_perm:[1,0,3,2] row_mask:0xf bank_mask:0xf
  v_add_f32_dpp v153, v153, v153 quad_perm:[1,0,3,2] row_mask:0xf bank_mask:0xf
  v_add_f32_dpp v104, v104, v104 quad_perm:[2,3,0,1] row_mask:0xf bank_mask:0xf
  v_add_f32_dpp v105, v105, v105 quad_perm:[2,3,0,1] row_mask:0xf bank_mask:0xf
  v_add_f32_dpp v152, v152, v152 quad_perm:[2,3,0,1] row_mask:0xf bank_mask:0xf
  v_add_f32_dpp v153, v153, v153 quad_perm:[2,3,0,1] row_mask:0xf bank_mask:0xf
  v_add_f32_dpp v104, v104, v104 row_half_mirror row_mask:0xf bank_mask:0xf
  v_add_f32_dpp v105, v105, v105 row_half_mirror row_mask:0xf bank_mask:0xf
  v_add_f32_dpp v152, v152, v152 row_half_mirror row_mask:0xf bank_mask:0xf
  v_add_f32_dpp v153, v153, v153 row_half_mirror row_mask:0xf bank_mask:0xf
  v_mov_b32 v106, s62
  v_mov_b32 v107, s63
  v_mov_b32 v154, s62
  v_mov_b32 v155, s63
  s_add_u32 s72, s58, 32
  s_lshl_b32 s72, s72, 3
  s_add_u32 s72, s72, s59
  s_lshl_b32 s72, s72, 10
  s_add_u32 s72, s72, 36700160
  v_lshrrev_b32 v3, 3, v0
  v_lshlrev_b32 v3, 4, v3
  v_and_b32 v4, 7, v0
  v_cmp_eq_u32 vcc, 0, v4
  s_mov_b64 exec, vcc
  s_cmp_eq_u32 s0, 0
  s_cbranch_scc1 L_slow_70
  buffer_store_dwordx4 v[104:107], v3, s[16:19], s72 offen offset:0
  buffer_store_dwordx4 v[152:155], v3, s[16:19], s72 offen offset:512
  s_branch L_dj_71
L_slow_70:
  buffer_store_dwordx4 v[104:107], v3, s[16:19], s72 offen offset:0 sc1
  buffer_store_dwordx4 v[152:155], v3, s[16:19], s72 offen offset:512 sc1
L_dj_71:
  s_mov_b64 exec, -1
  s_add_u32 s4, s56, 22020096
  s_addc_u32 s5, s57, 0
  s_mov_b32 s6, 2097152
  s_mov_b32 s7, 0x20000
  s_mov_b32 s20, s52
  s_mov_b32 s21, s53
  s_mov_b32 s22, 2097152
  s_mov_b32 s23, 0x20000
  s_mov_b32 s61, 1
  s_waitcnt lgkmcnt(0)
L_layer1:
  v_lshrrev_b32 v3, 3, v1
  s_lshl_b32 s72, s60, 4
  s_add_u32 s72, s72, 0
  v_add_u32 v6, s72, v3
  v_bfe_u32 v7, v6, 1, 3
  v_and_b32 v5, 7, v1
  v_xor_b32 v5, v5, v7
  v_lshlrev_b32 v6, 10, v6
  v_lshl_add_u32 v10, v5, 4, v6
  s_lshl_b32 s72, s60, 4
  s_add_u32 s72, s72, 8
  v_add_u32 v6, s72, v3
  v_bfe_u32 v7, v6, 1, 3
  v_and_b32 v5, 7, v1
  v_xor_b32 v5, v5, v7
  v_lshlrev_b32 v6, 10, v6
  v_lshl_add_u32 v11, v5, 4, v6
  s_lshl_b32 s76, s58, 16
  s_lshl_b32 s77, s60, 11
  v_and_b32 v3, 31, v1
  s_lshl_b32 s72, s68, 5
  v_add_u32 v3, s72, v3
  v_bfe_u32 v4, v3, 1, 3
  v_lshrrev_b32 v5, 5, v1
  s_xor_b32 s72, s69, 0
  s_lshl_b32 s72, s72, 1
  v_add_u32 v6, s72, v5
  v_xor_b32 v6, v6, v4
  v_lshlrev_b32 v6, 4, v6
  v_lshl_add_u32 v13, v3, 7, v6
  s_xor_b32 s72, s69, 1
  s_lshl_b32 s72, s72, 1
  v_add_u32 v6, s72, v5
  v_xor_b32 v6, v6, v4
  v_lshlrev_b32 v6, 4, v6
  v_lshl_add_u32 v14, v3, 7, v6
  s_xor_b32 s72, s69, 2
  s_lshl_b32 s72, s72, 1
  v_add_u32 v6, s72, v5
  v_xor_b32 v6, v6, v4
  v_lshlrev_b32 v6, 4, v6
  v_lshl_add_u32 v15, v3, 7, v6
  s_xor_b32 s72, s69, 3
  s_lshl_b32 s72, s72, 1
  v_add_u32 v6, s72, v5
  v_xor_b32 v6, v6, v4
  v_lshlrev_b32 v6, 4, v6
  v_lshl_add_u32 v16, v3, 7, v6
  v_and_b32 v3, 15, v1
  v_lshrrev_b32 v4, 2, v3
  v_lshrrev_b32 v5, 5, v1
  v_lshl_add_u32 v4, v5, 3, v4
  v_bfe_u32 v5, v1, 4, 1
  v_lshlrev_b32 v5, 1, v5
  v_bfe_u32 v6, v1, 1, 1
  v_add_u32 v5, v5, v6
  s_lshl_b32 s72, s67, 2
  v_add_u32 v5, s72, v5
  v_bfe_u32 v6, v1, 3, 1
  v_lshlrev_b32 v6, 2, v6
  v_xor_b32 v5, v5, v6
  v_lshlrev_b32 v5, 4, v5
  v_lshl_add_u32 v5, v4, 7, v5
  v_and_b32 v6, 1, v1
  v_lshl_add_u32 v5, v6, 3, v5
  s_xor_b32 s72, s69, 0
  s_lshl_b32 s72, s72, 11
  s_add_u32 s72, s72, 65536
  v_add_u32 v17, s72, v5
  v_add_u32 v19, 49152, v17
  s_xor_b32 s72, s69, 1
  s_lshl_b32 s72, s72, 11
  s_add_u32 s72, s72, 65536
  v_add_u32 v18, s72, v5
  v_add_u32 v20, 49152, v18
  v_mov_b32 v21, 0
  v_mov_b32 v24, 0
  v_mov_b32 v25, 0
  s_mov_b32 s74, 0x3f803f80
  s_lshl_b32 s72, s61, 5
  s_add_u32 s72, s72, s58
  s_lshl_b32 s75, s72, 13
  s_add_u32 s75, s75, 36700160
  v_and_b32 v3, 31, v1
  s_lshl_b32 s72, s68, 5
  v_add_u32 v3, s72, v3
  v_lshlrev_b32 v3, 4, v3
  v_lshrrev_b32 v4, 5, v1
  v_lshl_add_u32 v61, v4, 12, v3
  v_mov_b32 v8, s58
  v_and_b32 v9, 3, v8
  v_lshlrev_b32 v9, 3, v9
  v_add_u32 v9, v1, v9
  v_lshlrev_b32 v9, 3, v9
  v_lshrrev_b32 v7, 2, v8
  v_add_u32 v9, v9, v7
  v_lshlrev_b32 v9, 7, v9
  v_add_u32 v9, 266240, v9
  s_waitcnt vmcnt(4)
  s_mov_b32 s61, 0
  s_barrier
  s_cmp_eq_u32 s60, 0
  s_cbranch_scc0 L_pub_72
  s_lshl_b32 s70, s61, 8
  s_add_u32 s70, s70, s2
  s_lshl_b32 s70, s70, 7
  s_add_u32 s70, s70, 266240
  v_mov_b32 v4, s62
  v_mov_b32 v5, s63
  v_mov_b32 v6, s70
  s_mov_b64 exec, 1
  s_cmp_eq_u32 s0, 0
  s_cbranch_scc1 L_slow_73
  buffer_store_dwordx2 v[4:5], v6, s[16:19], 0 offen
  s_branch L_dj_74
L_slow_73:
  buffer_store_dwordx2 v[4:5], v6, s[16:19], 0 offen sc1
L_dj_74:
  s_mov_b64 exec, -1
L_pub_72:
  s_mov_b32 s61, 1
  s_mov_b64 exec, 0xff
  s_mov_b32 s100, 0
  s_cbranch_execz L_pok_76
L_poll_75:
  buffer_load_dwordx2 v[4:5], v9, s[16:19], 0 offen sc1
  s_waitcnt vmcnt(0)
  v_cmp_ne_u64 vcc, s[62:63], v[4:5]
  s_nop 0
  s_cbranch_vccz L_pok_76
  s_add_u32 s100, s100, 1
  s_cmp_lt_u32 s100, 400000
  s_cbranch_scc1 L_poll_75
  s_branch L_fail
L_pok_76:
  s_mov_b64 exec, -1
  buffer_load_dwordx4 v[240:243], v61, s[16:19], s75 offen offset:0 sc1
  buffer_load_dwordx4 v[244:247], v61, s[16:19], s75 offen offset:1024 sc1
  buffer_load_dwordx4 v[248:251], v61, s[16:19], s75 offen offset:2048 sc1
  buffer_load_dwordx4 v[252:255], v61, s[16:19], s75 offen offset:3072 sc1
  s_add_u32 m0, s77, 0
  s_add_u32 s72, s76, 0
  buffer_load_dwordx4 v10, s[4:7], s72 offen sc1 lds
  v_and_b32 v3, 31, v1
  v_lshrrev_b32 v5, 5, v1
  s_mul_i32 s73, s67, 768
  s_add_u32 s73, s73, 157696
  v_lshl_add_u32 v56, v5, 4, s73
  v_lshl_add_u32 v57, v3, 2, s73
  s_add_u32 m0, s77, 1024
  s_add_u32 s72, s76, 0
  buffer_load_dwordx4 v11, s[4:7], s72 offen sc1 lds
  ds_read_b128 v[192:195], v56 offset:0
  ds_read_b128 v[196:199], v56 offset:32
  ds_read_b128 v[200:203], v56 offset:64
  ds_read_b128 v[204:207], v56 offset:96
  ds_read_b128 v[32:35], v56 offset:384
  ds_read_b128 v[36:39], v56 offset:416
  s_add_u32 m0, s77, 8192
  s_add_u32 s72, s76, 128
  buffer_load_dwordx4 v10, s[4:7], s72 offen sc1 lds
  ds_read_b128 v[40:43], v56 offset:448
  ds_read_b128 v[44:47], v56 offset:480
  ds_read_b128 v[224:227], v56 offset:256
  ds_read_b128 v[228:231], v56 offset:288
  ds_read_b128 v[232:235], v56 offset:320
  ds_read_b128 v[236:239], v56 offset:352
  s_add_u32 m0, s77, 9216
  s_add_u32 s72, s76, 128
  buffer_load_dwordx4 v11, s[4:7], s72 offen sc1 lds
  ds_read_b128 v[208:211], v56 offset:640
  ds_read_b128 v[212:215], v56 offset:672
  ds_read_b128 v[216:219], v56 offset:704
  ds_read_b128 v[220:223], v56 offset:736
  ds_read_b32 v58, v57 offset:128
  ds_read_b32 v59, v57 offset:512
  s_mov_b32 s100, 0
L_s2p_77:
  s_waitcnt vmcnt(7)
  v_cmp_ne_u64 vcc, s[62:63], v[242:243]
  s_waitcnt vmcnt(6)
  v_cmp_ne_u64 s[72:73], s[62:63], v[246:247]
  s_or_b64 vcc, vcc, s[72:73]
  s_waitcnt vmcnt(5)
  v_cmp_ne_u64 s[72:73], s[62:63], v[250:251]
  s_or_b64 vcc, vcc, s[72:73]
  s_waitcnt vmcnt(4)
  v_cmp_ne_u64 s[72:73], s[62:63], v[254:255]
  s_or_b64 vcc, vcc, s[72:73]
  s_cbranch_vccz L_s2o_78
  buffer_load_dwordx4 v[240:243], v61, s[16:19], s75 offen offset:0 sc1
  buffer_load_dwordx4 v[244:247], v61, s[16:19], s75 offen offset:1024 sc1
  buffer_load_dwordx4 v[248:251], v61, s[16:19], s75 offen offset:2048 sc1
  buffer_load_dwordx4 v[252:255], v61, s[16:19], s75 offen offset:3072 sc1
  s_waitcnt vmcnt(0)
  s_add_u32 s100, s100, 1
  s_cmp_lt_u32 s100, 400000
  s_cbranch_scc1 L_s2p_77
  s_branch L_fail
L_s2o_78:
  v_add_f32 v26, v240, v244
  v_add_f32 v27, v241, v245
  v_add_f32 v28, v248, v252
  v_add_f32 v29, v249, v253
  v_add_f32 v26, v26, v28
  v_add_f32 v27, v27, v29
  v_mov_b32 v28, v26
  v_mov_b32 v29, v27
  s_nop 0
  v_permlane32_swap_b32 v26, v28
  v_permlane32_swap_b32 v27, v29
  v_add_f32 v26, v26, v28
  v_add_f32 v27, v27, v29
  v_mul_f32 v26, 0x3b000000, v26
  v_mul_f32 v27, 0x3b000000, v27
  v_fma_f32 v27, -v26, v26, v27
  v_max_f32 v27, 0, v27
  v_add_f32 v27, 0x3727c5ac, v27
  v_rsq_f32 v27, v27
  s_add_u32 m0, s77, 16384
  s_add_u32 s72, s76, 256
  buffer_load_dwordx4 v10, s[4:7], s72 offen sc1 lds
  s_lshl_b32 s73, s60, 8
  s_add_u32 s73, s73, 159232
  v_lshl_add_u32 v4, v3, 2, s73
  ds_write_b32 v4, v26
  ds_write_b32 v4, v27 offset:128
  v_lshl_add_u32 v60, v5, 4, s73
  s_waitcnt lgkmcnt(15)
  v_add_f32 v192, v192, v32
  s_waitcnt lgkmcnt(7)
  v_add_f32 v224, v224, v208
  s_add_u32 m0, s77, 17408
  s_add_u32 s72, s76, 256
  buffer_load_dwordx4 v11, s[4:7], s72 offen sc1 lds
  v_add_f32 v193, v193, v33
  v_add_f32 v225, v225, v209
  v_add_f32 v194, v194, v34
  v_add_f32 v226, v226, v210
  v_add_f32 v195, v195, v35
  v_add_f32 v227, v227, v211
  v_add_f32 v196, v196, v36
  s_waitcnt lgkmcnt(6)
  v_add_f32 v228, v228, v212
  s_add_u32 m0, s77, 24576
  s_add_u32 s72, s76, 384
  buffer_load_dwordx4 v10, s[4:7], s72 offen sc1 lds
  v_add_f32 v197, v197, v37
  v_add_f32 v229, v229, v213
  v_add_f32 v198, v198, v38
  v_add_f32 v230, v230, v214
  v_add_f32 v199, v199, v39
  v_add_f32 v231, v231, v215
  v_add_f32 v200, v200, v40
  s_waitcnt lgkmcnt(5)
  v_add_f32 v232, v232, v216
  s_add_u32 m0, s77, 25600
  s_add_u32 s72, s76, 384
  buffer_load_dwordx4 v11, s[4:7], s72 offen sc1 lds
  v_add_f32 v201, v201, v41
  v_add_f32 v233, v233, v217
  v_add_f32 v202, v202, v42
  v_add_f32 v234, v234, v218
  v_add_f32 v203, v203, v43
  v_add_f32 v235, v235, v219
  v_add_f32 v204, v204, v44
  s_waitcnt lgkmcnt(4)
  v_add_f32 v236, v236, v220
  s_add_u32 m0, s77, 32768
  s_add_u32 s72, s76, 512
  buffer_load_dwordx4 v10, s[4:7], s72 offen sc1 lds
  v_add_f32 v205, v205, v45
  v_add_f32 v237, v237, v221
  v_add_f32 v206, v206, v46
  v_add_f32 v238, v238, v222
  v_add_f32 v207, v207, v47
  v_add_f32 v239, v239, v223
  s_waitcnt lgkmcnt(2)
  v_add_f32 v58, v58, v59
  s_waitcnt lgkmcnt(0)
  s_add_u32 m0, s77, 33792
  s_add_u32 s72, s76, 512
  buffer_load_dwordx4 v11, s[4:7], s72 offen sc1 lds
  ds_read_b128 v[208:211], v60 offset:0
  ds_read_b128 v[212:215], v60 offset:32
  ds_read_b128 v[216:219], v60 offset:64
  ds_read_b128 v[220:223], v60 offset:96
  v_mul_f32 v192, -v26, v192
  v_mul_f32 v224, -v26, v224
  v_mul_f32 v193, -v26, v193
  v_mul_f32 v225, -v26, v225
  s_add_u32 m0, s77, 40960
  s_add_u32 s72, s76, 640
  buffer_load_dwordx4 v10, s[4:7], s72 offen sc1 lds
  v_mul_f32 v194, -v26, v194
  v_mul_f32 v226, -v26, v226
  v_mul_f32 v195, -v26, v195
  v_mul_f32 v227, -v26, v227
  v_mul_f32 v196, -v26, v196
  v_mul_f32 v228, -v26, v228
  v_mul_f32 v197, -v26, v197
  v_mul_f32 v229, -v26, v229
  s_add_u32 m0, s77, 41984
  s_add_u32 s72, s76, 640
  buffer_load_dwordx4 v11, s[4:7], s72 offen sc1 lds
  v_mul_f32 v198, -v26, v198
  v_mul_f32 v230, -v26, v230
  v_mul_f32 v199, -v26, v199
  v_mul_f32 v231, -v26, v231
  v_mul_f32 v200, -v26, v200
  v_mul_f32 v232, -v26, v232
  v_mul_f32 v201, -v26, v201
  v_mul_f32 v233, -v26, v233
  s_add_u32 m0, s77, 49152
  s_add_u32 s72, s76, 768
  buffer_load_dwordx4 v10, s[4:7], s72 offen sc1 lds
  v_mul_f32 v202, -v26, v202
  v_mul_f32 v234, -v26, v234
  v_mul_f32 v203, -v26, v203
  v_mul_f32 v235, -v26, v235
  v_mul_f32 v204, -v26, v204
  v_mul_f32 v236, -v26, v236
  v_mul_f32 v205, -v26, v205
  v_mul_f32 v237, -v26, v237
  s_add_u32 m0, s77, 50176
  s_add_u32 s72, s76, 768
  buffer_load_dwordx4 v11, s[4:7], s72 offen sc1 lds
  v_mul_f32 v206, -v26, v206
  v_mul_f32 v238, -v26, v238
  v_mul_f32 v207, -v26, v207
  v_mul_f32 v239, -v26, v239
  s_waitcnt lgkmcnt(3)
  v_mul_f32 v208, -v58, v208
  v_mul_f32 v209, -v58, v209
  v_mul_f32 v210, -v58, v210
  v_mul_f32 v211, -v58, v211
  s_add_u32 m0, s77, 57344
  s_add_u32 s72, s76, 896
  buffer_load_dwordx4 v10, s[4:7], s72 offen sc1 lds
  s_waitcnt lgkmcnt(2)
  v_mul_f32 v212, -v58, v212
  v_mul_f32 v213, -v58, v213
  v_mul_f32 v214, -v58, v214
  v_mul_f32 v215, -v58, v215
  s_waitcnt lgkmcnt(1)
  v_mul_f32 v216, -v58, v216
  v_mul_f32 v217, -v58, v217
  v_mul_f32 v218, -v58, v218
  v_mul_f32 v219, -v58, v219
  s_add_u32 m0, s77, 58368
  s_add_u32 s72, s76, 896
  buffer_load_dwordx4 v11, s[4:7], s72 offen sc1 lds
  s_waitcnt lgkmcnt(0)
  v_mul_f32 v220, -v58, v220
  v_mul_f32 v221, -v58, v221
  v_mul_f32 v222, -v58, v222
  v_mul_f32 v223, -v58, v223
  s_mul_i32 s70, s60, 24576
  s_lshl_b32 s72, s59, 7
  s_add_u32 s70, s70, s72
  s_lshl_b32 s71, s60, 10
  s_waitcnt vmcnt(14)
  s_barrier
  ds_read_b128 v[64:67], v13 offset:0
  ds_read_b64_tr_b16 v[32:33], v17 offset:0
  ds_read_b64_tr_b16 v[34:35], v17 offset:512
  ds_read_b64_tr_b16 v[36:37], v17 offset:8192
  ds_read_b64_tr_b16 v[38:39], v17 offset:8704
  ds_read_b128 v[68:71], v14 offset:0
  ds_read_b64_tr_b16 v[40:41], v18 offset:0
  ds_read_b64_tr_b16 v[42:43], v18 offset:512
  ds_read_b64_tr_b16 v[44:45], v18 offset:8192
  ds_read_b64_tr_b16 v[46:47], v18 offset:8704
  s_waitcnt lgkmcnt(7)
  v_mfma_f32_32x32x16_bf16 v[192:207], v[32:35], v[64:67], v[192:207]
  ds_read_b128 v[72:75], v15 offset:0
  ds_read_b64_tr_b16 v[48:49], v17 offset:4096
  ds_read_b64_tr_b16 v[50:51], v17 offset:4608
  s_waitcnt lgkmcnt(8)
  v_mfma_f32_32x32x16_bf16 v[208:223], v[64:67], v[36:39], v[208:223]
  ds_read_b64_tr_b16 v[52:53], v17 offset:12288
  ds_read_b64_tr_b16 v[54:55], v17 offset:12800
  s_waitcnt lgkmcnt(7)
  v_mfma_f32_32x32x16_bf16 v[192:207], v[40:43], v[68:71], v[192:207]
  ds_read_b128 v[76:79], v16 offset:0
  ds_read_b64_tr_b16 v[32:33], v18 offset:4096
  ds_read_b64_tr_b16 v[34:35], v18 offset:4608
  s_waitcnt lgkmcnt(8)
  v_mfma_f32_32x32x16_bf16 v[208:223], v[68:71], v[44:47], v[208:223]
  ds_read_b64_tr_b16 v[36:37], v18 offset:12288
  ds_read_b64_tr_b16 v[38:39], v18 offset:12800
  s_waitcnt lgkmcnt(7)
  v_mfma_f32_32x32x16_bf16 v[192:207], v[48:51], v[72:75], v[192:207]
  s_waitcnt vmcnt(12)
  s_barrier
  ds_read_b128 v[80:83], v13 offset:8192
  ds_read_b64_tr_b16 v[40:41], v17 offset:16384
  ds_read_b64_tr_b16 v[42:43], v17 offset:16896
  s_waitcnt lgkmcnt(8)
  v_mfma_f32_32x32x16_bf16 v[208:223], v[72:75], v[52:55], v[208:223]
  ds_read_b64_tr_b16 v[44:45], v17 offset:24576
  ds_read_b64_tr_b16 v[46:47], v17 offset:25088
  s_waitcnt lgkmcnt(7)
  v_mfma_f32_32x32x16_bf16 v[192:207], v[32:35], v[76:79], v[192:207]
  ds_read_b128 v[84:87], v14 offset:8192
  ds_read_b64_tr_b16 v[48:49], v18 offset:16384
  ds_read_b64_tr_b16 v[50:51], v18 offset:16896
  s_waitcnt lgkmcnt(8)
  v_mfma_f32_32x32x16_bf16 v[208:223], v[76:79], v[36:39], v[208:223]
  ds_read_b64_tr_b16 v[52:53], v18 offset:24576
  ds_read_b64_tr_b16 v[54:55], v18 offset:25088
  s_waitcnt lgkmcnt(7)
  v_mfma_f32_32x32x16_bf16 v[192:207], v[40:43], v[80:83], v[192:207]
  ds_read_b128 v[88:91], v15 offset:8192
  ds_read_b64_tr_b16 v[32:33], v17 offset:20480
  ds_read_b64_tr_b16 v[34:35], v17 offset:20992
  s_waitcnt lgkmcnt(8)
  v_mfma_f32_32x32x16_bf16 v[208:223], v[80:83], v[44:47], v[208:223]
  ds_read_b64_tr_b16 v[36:37], v17 offset:28672
  ds_read_b64_tr_b16 v[38:39], v17 offset:29184
  s_waitcnt lgkmcnt(7)
  v_mfma_f32_32x32x16_bf16 v[192:207], v[48:51], v[84:87], v[192:207]
  ds_read_b128 v[92:95], v16 offset:8192
  ds_read_b64_tr_b16 v[40:41], v18 offset:20480
  ds_read_b64_tr_b16 v[42:43], v18 offset:20992
  s_waitcnt lgkmcnt(8)
  v_mfma_f32_32x32x16_bf16 v[208:223], v[84:87], v[52:55], v[208:223]
  ds_read_b64_tr_b16 v[44:45], v18 offset:28672
  ds_read_b64_tr_b16 v[46:47], v18 offset:29184
  s_waitcnt lgkmcnt(7)
  v_mfma_f32_32x32x16_bf16 v[192:207], v[32:35], v[88:91], v[192:207]
  s_waitcnt vmcnt(10)
  s_barrier
  ds_read_b128 v[96:99], v13 offset:16384
  ds_read_b64_tr_b16 v[48:49], v17 offset:32768
  ds_read_b64_tr_b16 v[50:51], v17 offset:33280
  s_waitcnt lgkmcnt(8)
  v_mfma_f32_32x32x16_bf16 v[208:223], v[88:91], v[36:39], v[208:223]
  ds_read_b64_tr_b16 v[52:53], v17 offset:40960
  ds_read_b64_tr_b16 v[54:55], v17 offset:41472
  s_add_u32 m0, s71, 65536
  s_add_u32 s72, s70, 984064
  buffer_load_dwordx4 v12, s[8:11], s72 offen lds
  s_waitcnt lgkmcnt(7)
  v_mfma_f32_32x32x16_bf16 v[192:207], v[40:43], v[92:95], v[192:207]
  ds_read_b128 v[100:103], v14 offset:16384
  ds_read_b64_tr_b16 v[32:33], v18 offset:32768
  ds_read_b64_tr_b16 v[34:35], v18 offset:33280
  s_waitcnt lgkmcnt(8)
  v_mfma_f32_32x32x16_bf16 v[208:223], v[92:95], v[44:47], v[208:223]
  ds_read_b64_tr_b16 v[36:37], v18 offset:40960
  ds_read_b64_tr_b16 v[38:39], v18 offset:41472
  s_add_u32 m0, s71, 69632
  s_add_u32 s72, s70, 1082368
  buffer_load_dwordx4 v12, s[8:11], s72 offen lds
  s_waitcnt lgkmcnt(7)
  v_mfma_f32_32x32x16_bf16 v[192:207], v[48:51], v[96:99], v[192:207]
  ds_read_b128 v[104:107], v15 offset:16384
  ds_read_b64_tr_b16 v[40:41], v17 offset:36864
  ds_read_b64_tr_b16 v[42:43], v17 offset:37376
  s_waitcnt lgkmcnt(8)
  v_mfma_f32_32x32x16_bf16 v[208:223], v[96:99], v[52:55], v[208:223]
  ds_read_b64_tr_b16 v[44:45], v17 offset:45056
  ds_read_b64_tr_b16 v[46:47], v17 offset:45568
  s_add_u32 m0, s71, 73728
  s_add_u32 s72, s70, 985088
  buffer_load_dwordx4 v12, s[8:11], s72 offen lds
  s_waitcnt lgkmcnt(7)
  v_mfma_f32_32x32x16_bf16 v[192:207], v[32:35], v[100:103], v[192:207]
  ds_read_b128 v[108:111], v16 offset:16384
  ds_read_b64_tr_b16 v[48:49], v18 offset:36864
  ds_read_b64_tr_b16 v[50:51], v18 offset:37376
  s_waitcnt lgkmcnt(8)
  v_mfma_f32_32x32x16_bf16 v[208:223], v[100:103], v[36:39], v[208:223]
  ds_read_b64_tr_b16 v[52:53], v18 offset:45056
  ds_read_b64_tr_b16 v[54:55], v18 offset:45568
  s_add_u32 m0, s71, 77824
  s_add_u32 s72, s70, 1083392
  buffer_load_dwordx4 v12, s[8:11], s72 offen lds
  s_waitcnt lgkmcnt(7)
  v_mfma_f32_32x32x16_bf16 v[192:207], v[40:43], v[104:107], v[192:207]
  s_waitcnt vmcnt(12)
  s_barrier
  ds_read_b128 v[112:115], v13 offset:24576
  ds_read_b64_tr_b16 v[32:33], v19 offset:0
  ds_read_b64_tr_b16 v[34:35], v19 offset:512
  s_waitcnt lgkmcnt(8)
  v_mfma_f32_32x32x16_bf16 v[208:223], v[104:107], v[44:47], v[208:223]
  ds_read_b64_tr_b16 v[36:37], v19 offset:8192
  ds_read_b64_tr_b16 v[38:39], v19 offset:8704
  s_add_u32 m0, s71, 81920
  s_add_u32 s72, s70, 1180672
  buffer_load_dwordx4 v12, s[8:11], s72 offen lds
  s_waitcnt lgkmcnt(7)
  v_mfma_f32_32x32x16_bf16 v[192:207], v[48:51], v[108:111], v[192:207]
  ds_read_b128 v[116:119], v14 offset:24576
  ds_read_b64_tr_b16 v[40:41], v20 offset:0
  ds_read_b64_tr_b16 v[42:43], v20 offset:512
  s_waitcnt lgkmcnt(8)
  v_mfma_f32_32x32x16_bf16 v[208:223], v[108:111], v[52:55], v[208:223]
  ds_read_b64_tr_b16 v[44:45], v20 offset:8192
  ds_read_b64_tr_b16 v[46:47], v20 offset:8704
  s_add_u32 m0, s71, 86016
  s_add_u32 s72, s70, 1278976
  buffer_load_dwordx4 v12, s[8:11], s72 offen lds
  s_waitcnt lgkmcnt(7)
  v_mfma_f32_32x32x16_bf16 v[192:207], v[32:35], v[112:115], v[192:207]
  ds_read_b128 v[120:123], v15 offset:24576
  ds_read_b64_tr_b16 v[48:49], v19 offset:4096
  ds_read_b64_tr_b16 v[50:51], v19 offset:4608
  s_waitcnt lgkmcnt(8)
  v_mfma_f32_32x32x16_bf16 v[208:223], v[112:115], v[36:39], v[208:223]
  ds_read_b64_tr_b16 v[52:53], v19 offset:12288
  ds_read_b64_tr_b16 v[54:55], v19 offset:12800
  s_add_u32 m0, s71, 90112
  s_add_u32 s72, s70, 1181696
  buffer_load_dwordx4 v12, s[8:11], s72 offen lds
  s_waitcnt lgkmcnt(7)
  v_mfma_f32_32x32x16_bf16 v[192:207], v[40:43], v[116:119], v[192:207]
  ds_read_b128 v[124:127], v16 offset:24576
  ds_read_b64_tr_b16 v[32:33], v20 offset:4096
  ds_read_b64_tr_b16 v[34:35], v20 offset:4608
  s_waitcnt lgkmcnt(8)
  v_mfma_f32_32x32x16_bf16 v[208:223], v[116:119], v[44:47], v[208:223]
  ds_read_b64_tr_b16 v[36:37], v20 offset:12288
  ds_read_b64_tr_b16 v[38:39], v20 offset:12800
  s_add_u32 m0, s71, 94208
  s_add_u32 s72, s70, 1280000
  buffer_load_dwordx4 v12, s[8:11], s72 offen lds
  s_waitcnt lgkmcnt(7)
  v_mfma_f32_32x32x16_bf16 v[192:207], v[48:51], v[120:123], v[192:207]
  s_waitcnt vmcnt(14)
  s_barrier
  ds_read_b128 v[128:131], v13 offset:32768
  ds_read_b64_tr_b16 v[40:41], v19 offset:16384
  ds_read_b64_tr_b16 v[42:43], v19 offset:16896
  s_waitcnt lgkmcnt(8)
  v_mfma_f32_32x32x16_bf16 v[208:223], v[120:123], v[52:55], v[208:223]
  ds_read_b64_tr_b16 v[44:45], v19 offset:24576
  ds_read_b64_tr_b16 v[46:47], v19 offset:25088
  s_add_u32 m0, s71, 98304
  s_add_u32 s72, s70, 1377280
  buffer_load_dwordx4 v12, s[8:11], s72 offen lds
  s_waitcnt lgkmcnt(7)
  v_mfma_f32_32x32x16_bf16 v[192:207], v[32:35], v[124:127], v[192:207]
  ds_read_b128 v[132:135], v14 offset:32768
  ds_read_b64_tr_b16 v[48:49], v20 offset:16384
  ds_read_b64_tr_b16 v[50:51], v20 offset:16896
  s_waitcnt lgkmcnt(8)
  v_mfma_f32_32x32x16_bf16 v[208:223], v[124:127], v[36:39], v[208:223]
  ds_read_b64_tr_b16 v[52:53], v20 offset:24576
  ds_read_b64_tr_b16 v[54:55], v20 offset:25088
  s_add_u32 m0, s71, 102400
  s_add_u32 s72, s70, 1475584
  buffer_load_dwordx4 v12, s[8:11], s72 offen lds
  s_waitcnt lgkmcnt(7)
  v_mfma_f32_32x32x16_bf16 v[192:207], v[40:43], v[128:131], v[192:207]
  ds_read_b128 v[136:139], v15 offset:32768
  ds_read_b64_tr_b16 v[32:33], v19 offset:20480
  ds_read_b64_tr_b16 v[34:35], v19 offset:20992
  s_waitcnt lgkmcnt(8)
  v_mfma_f32_32x32x16_bf16 v[208:223], v[128:131], v[44:47], v[208:223]
  ds_read_b64_tr_b16 v[36:37], v19 offset:28672
  ds_read_b64_tr_b16 v[38:39], v19 offset:29184
  s_add_u32 m0, s71, 106496
  s_add_u32 s72, s70, 1378304
  buffer_load_dwordx4 v12, s[8:11], s72 offen lds
  s_waitcnt lgkmcnt(7)
  v_mfma_f32_32x32x16_bf16 v[192:207], v[48:51], v[132:135], v[192:207]
  ds_read_b128 v[140:143], v16 offset:32768
  ds_read_b64_tr_b16 v[40:41], v20 offset:20480
  ds_read_b64_tr_b16 v[42:43], v20 offset:20992
  s_waitcnt lgkmcnt(8)
  v_mfma_f32_32x32x16_bf16 v[208:223], v[132:135], v[52:55], v[208:223]
  ds_read_b64_tr_b16 v[44:45], v20 offset:28672
  ds_read_b64_tr_b16 v[46:47], v20 offset:29184
  s_add_u32 m0, s71, 110592
  s_add_u32 s72, s70, 1476608
  buffer_load_dwordx4 v12, s[8:11], s72 offen lds
  s_waitcnt lgkmcnt(7)
  v_mfma_f32_32x32x16_bf16 v[192:207], v[32:35], v[136:139], v[192:207]
  s_waitcnt vmcnt(8)
  s_barrier
  ds_read_b128 v[144:147], v13 offset:40960
  ds_read_b64_tr_b16 v[48:49], v17 offset:0
  ds_read_b64_tr_b16 v[50:51], v17 offset:512
  s_waitcnt lgkmcnt(8)
  v_mfma_f32_32x32x16_bf16 v[208:223], v[136:139], v[36:39], v[208:223]
  ds_read_b64_tr_b16 v[52:53], v17 offset:8192
  ds_read_b64_tr_b16 v[54:55], v17 offset:8704
  s_add_u32 m0, s71, 114688
  s_add_u32 s72, s70, 0
  buffer_load_dwordx4 v12, s[8:11], s72 offen lds
  s_waitcnt lgkmcnt(7)
  v_mfma_f32_32x32x16_bf16 v[192:207], v[40:43], v[140:143], v[192:207]
  ds_read_b128 v[148:151], v14 offset:40960
  ds_read_b64_tr_b16 v[32:33], v18 offset:0
  ds_read_b64_tr_b16 v[34:35], v18 offset:512
  s_waitcnt lgkmcnt(8)
  v_mfma_f32_32x32x16_bf16 v[208:223], v[140:143], v[44:47], v[208:223]
  ds_read_b64_tr_b16 v[36:37], v18 offset:8192
  ds_read_b64_tr_b16 v[38:39], v18 offset:8704
  s_add_u32 m0, s71, 118784
  s_add_u32 s72, s70, 98304
  buffer_load_dwordx4 v12, s[8:11], s72 offen lds
  s_waitcnt lgkmcnt(7)
  v_mfma_f32_32x32x16_bf16 v[192:207], v[48:51], v[144:147], v[192:207]
  ds_read_b128 v[152:155], v15 offset:40960
  ds_read_b64_tr_b16 v[40:41], v17 offset:4096
  ds_read_b64_tr_b16 v[42:43], v17 offset:4608
  s_waitcnt lgkmcnt(8)
  v_mfma_f32_32x32x16_bf16 v[208:223], v[144:147], v[52:55], v[208:223]
  ds_read_b64_tr_b16 v[44:45], v17 offset:12288
  ds_read_b64_tr_b16 v[46:47], v17 offset:12800
  s_add_u32 m0, s71, 122880
  s_add_u32 s72, s70, 196608
  buffer_load_dwordx4 v12, s[8:11], s72 offen lds
  s_waitcnt lgkmcnt(7)
  v_mfma_f32_32x32x16_bf16 v[192:207], v[32:35], v[148:151], v[192:207]
  ds_read_b128 v[156:159], v16 offset:40960
  ds_read_b64_tr_b16 v[48:49], v18 offset:4096
  ds_read_b64_tr_b16 v[50:51], v18 offset:4608
  s_waitcnt lgkmcnt(8)
  v_mfma_f32_32x32x16_bf16 v[208:223], v[148:151], v[36:39], v[208:223]
  ds_read_b64_tr_b16 v[52:53], v18 offset:12288
  ds_read_b64_tr_b16 v[54:55], v18 offset:12800
  s_add_u32 m0, s71, 126976
  s_add_u32 s72, s70, 294912
  buffer_load_dwordx4 v12, s[8:11], s72 offen lds
  s_waitcnt lgkmcnt(7)
  v_mfma_f32_32x32x16_bf16 v[192:207], v[40:43], v[152:155], v[192:207]
  s_waitcnt vmcnt(8)
  s_barrier
  ds_read_b128 v[160:163], v13 offset:49152
  ds_read_b64_tr_b16 v[32:33], v17 offset:16384
  ds_read_b64_tr_b16 v[34:35], v17 offset:16896
  s_waitcnt lgkmcnt(8)
  v_mfma_f32_32x32x16_bf16 v[208:223], v[152:155], v[44:47], v[208:223]
  ds_read_b64_tr_b16 v[36:37], v17 offset:24576
  ds_read_b64_tr_b16 v[38:39], v17 offset:25088
  s_add_u32 m0, s71, 131072
  s_add_u32 s72, s70, 393216
  buffer_load_dwordx4 v12, s[8:11], s72 offen lds
  s_waitcnt lgkmcnt(7)
  v_mfma_f32_32x32x16_bf16 v[192:207], v[48:51], v[156:159], v[192:207]
  ds_read_b128 v[164:167], v14 offset:49152
  ds_read_b64_tr_b16 v[40:41], v18 offset:16384
  ds_read_b64_tr_b16 v[42:43], v18 offset:16896
  s_waitcnt lgkmcnt(8)
  v_mfma_f32_32x32x16_bf16 v[208:223], v[156:159], v[52:55], v[208:223]
  ds_read_b64_tr_b16 v[44:45], v18 offset:24576
  ds_read_b64_tr_b16 v[46:47], v18 offset:25088
  s_add_u32 m0, s71, 135168
  s_add_u32 s72, s70, 491520
  buffer_load_dwordx4 v12, s[8:11], s72 offen lds
  s_waitcnt lgkmcnt(7)
  v_mfma_f32_32x32x16_bf16 v[192:207], v[32:35], v[160:163], v[192:207]
  ds_read_b128 v[168:171], v15 offset:49152
  ds_read_b64_tr_b16 v[48:49], v17 offset:20480
  ds_read_b64_tr_b16 v[50:51], v17 offset:20992
  s_waitcnt lgkmcnt(8)
  v_mfma_f32_32x32x16_bf16 v[208:223], v[160:163], v[36:39], v[208:223]
  ds_read_b64_tr_b16 v[52:53], v17 offset:28672
  ds_read_b64_tr_b16 v[54:55], v17 offset:29184
  s_add_u32 m0, s71, 139264
  s_add_u32 s72, s70, 589824
  buffer_load_dwordx4 v12, s[8:11], s72 offen lds
  s_waitcnt lgkmcnt(7)
  v_mfma_f32_32x32x16_bf16 v[192:207], v[40:43], v[164:167], v[192:207]
  ds_read_b128 v[172:175], v16 offset:49152
  ds_read_b64_tr_b16 v[32:33], v18 offset:20480
  ds_read_b64_tr_b16 v[34:35], v18 offset:20992
  s_waitcnt lgkmcnt(8)
  v_mfma_f32_32x32x16_bf16 v[208:223], v[164:167], v[44:47], v[208:223]
  ds_read_b64_tr_b16 v[36:37], v18 offset:28672
  ds_read_b64_tr_b16 v[38:39], v18 offset:29184
  s_add_u32 m0, s71, 143360
  s_add_u32 s72, s70, 688128
  buffer_load_dwordx4 v12, s[8:11], s72 offen lds
  s_waitcnt lgkmcnt(7)
  v_mfma_f32_32x32x16_bf16 v[192:207], v[48:51], v[168:171], v[192:207]
  s_waitcnt vmcnt(8)
  s_barrier
  ds_read_b128 v[176:179], v13 offset:57344
  ds_read_b64_tr_b16 v[40:41], v17 offset:32768
  ds_read_b64_tr_b16 v[42:43], v17 offset:33280
  s_waitcnt lgkmcnt(8)
  v_mfma_f32_32x32x16_bf16 v[208:223], v[168:171], v[52:55], v[208:223]
  ds_read_b64_tr_b16 v[44:45], v17 offset:40960
  ds_read_b64_tr_b16 v[46:47], v17 offset:41472
  s_add_u32 m0, s71, 65536
  s_add_u32 s72, s70, 786432
  buffer_load_dwordx4 v12, s[8:11], s72 offen lds
  s_waitcnt lgkmcnt(7)
  v_mfma_f32_32x32x16_bf16 v[192:207], v[32:35], v[172:175], v[192:207]
  ds_read_b128 v[180:183], v14 offset:57344
  ds_read_b64_tr_b16 v[48:49], v18 offset:32768
  ds_read_b64_tr_b16 v[50:51], v18 offset:33280
  s_waitcnt lgkmcnt(8)
  v_mfma_f32_32x32x16_bf16 v[208:223], v[172:175], v[36:39], v[208:223]
  ds_read_b64_tr_b16 v[52:53], v18 offset:40960
  ds_read_b64_tr_b16 v[54:55], v18 offset:41472
  s_add_u32 m0, s71, 69632
  s_add_u32 s72, s70, 884736
  buffer_load_dwordx4 v12, s[8:11], s72 offen lds
  s_waitcnt lgkmcnt(7)
  v_mfma_f32_32x32x16_bf16 v[192:207], v[40:43], v[176:179], v[192:207]
  ds_read_b128 v[184:187], v15 offset:57344
  ds_read_b64_tr_b16 v[32:33], v17 offset:36864
  ds_read_b64_tr_b16 v[34:35], v17 offset:37376
  s_waitcnt lgkmcnt(8)
  v_mfma_f32_32x32x16_bf16 v[208:223], v[176:179], v[44:47], v[208:223]
  ds_read_b64_tr_b16 v[36:37], v17 offset:45056
  ds_read_b64_tr_b16 v[38:39], v17 offset:45568
  s_add_u32 m0, s71, 73728
  s_add_u32 s72, s70, 983040
  buffer_load_dwordx4 v12, s[8:11], s72 offen lds
  ds_read_b128 v[240:243], v60 offset:128
  ds_read_b128 v[244:247], v60 offset:160
  ds_read_b128 v[248:251], v60 offset:192
  ds_read_b128 v[252:255], v60 offset:224
  s_waitcnt lgkmcnt(11)
  v_mfma_f32_32x32x16_bf16 v[192:207], v[48:51], v[180:183], v[192:207]
  ds_read_b128 v[188:191], v16 offset:57344
  ds_read_b64_tr_b16 v[40:41], v18 offset:36864
  ds_read_b64_tr_b16 v[42:43], v18 offset:37376
  s_waitcnt lgkmcnt(12)
  v_mfma_f32_32x32x16_bf16 v[208:223], v[180:183], v[52:55], v[208:223]
  ds_read_b64_tr_b16 v[44:45], v18 offset:45056
  ds_read_b64_tr_b16 v[46:47], v18 offset:45568
  s_add_u32 m0, s71, 77824
  s_add_u32 s72, s70, 1081344
  buffer_load_dwordx4 v12, s[8:11], s72 offen lds
  s_waitcnt lgkmcnt(11)
  v_mfma_f32_32x32x16_bf16 v[192:207], v[32:35], v[184:187], v[192:207]
  s_waitcnt lgkmcnt(9)
  v_mfma_f32_32x32x16_bf16 v[208:223], v[184:187], v[36:39], v[208:223]
  s_waitcnt lgkmcnt(2)
  v_mfma_f32_32x32x16_bf16 v[192:207], v[40:43], v[188:191], v[192:207]
  s_waitcnt lgkmcnt(0)
  v_mfma_f32_32x32x16_bf16 v[208:223], v[188:191], v[44:47], v[208:223]
  s_nop 9
  v_mul_f32 v192, v27, v192
  v_mul_f32 v193, v27, v193
  v_mul_f32 v194, v27, v194
  v_mul_f32 v195, v27, v195
  v_mul_f32 v196, v27, v196
  v_mul_f32 v197, v27, v197
  v_mul_f32 v198, v27, v198
  v_mul_f32 v199, v27, v199
  v_mul_f32 v200, v27, v200
  v_mul_f32 v201, v27, v201
  v_mul_f32 v202, v27, v202
  v_mul_f32 v203, v27, v203
  v_mul_f32 v204, v27, v204
  v_mul_f32 v205, v27, v205
  v_mul_f32 v206, v27, v206
  v_mul_f32 v207, v27, v207
  v_cvt_pk_bf16_f32 v192, v192, v193
  v_cvt_pk_bf16_f32 v193, v194, v195
  v_cvt_pk_bf16_f32 v194, v196, v197
  v_cvt_pk_bf16_f32 v195, v198, v199
  v_cvt_pk_bf16_f32 v196, v200, v201
  v_cvt_pk_bf16_f32 v197, v202, v203
  v_cvt_pk_bf16_f32 v198, v204, v205
  v_cvt_pk_bf16_f32 v199, v206, v207
  s_lshl_b32 s75, s59, 1
  s_add_u32 s75, s75, s67
  s_lshl_b32 s75, s75, 6
  s_lshl_b32 s76, s58, 1
  s_add_u32 s75, s75, s76
  s_add_u32 s75, s75, s68
  s_lshl_b32 s75, s75, 12
  s_lshl_b32 s76, s61, 22
  s_add_u32 s75, s75, s76
  s_add_u32 s75, s75, 1048576
  buffer_store_dwordx4 v[192:195], v2, s[16:19], s75 offen sc1
  buffer_store_dwordx4 v[196:199], v2, s[16:19], s75 offen offset:2048 sc1
  v_mul_f32 v208, v240, v208
  v_mul_f32 v209, v241, v209
  v_mul_f32 v210, v242, v210
  v_mul_f32 v211, v243, v211
  v_mul_f32 v212, v244, v212
  v_mul_f32 v213, v245, v213
  v_mul_f32 v214, v246, v214
  v_mul_f32 v215, v247, v215
  v_mul_f32 v216, v248, v216
  v_mul_f32 v217, v249, v217
  v_mul_f32 v218, v250, v218
  v_mul_f32 v219, v251, v219
  v_mul_f32 v220, v252, v220
  v_mul_f32 v221, v253, v221
  v_mul_f32 v222, v254, v222
  v_mul_f32 v223, v255, v223
  v_cvt_pk_bf16_f32 v208, v208, v209
  v_cvt_pk_bf16_f32 v209, v210, v211
  v_cvt_pk_bf16_f32 v210, v212, v213
  v_cvt_pk_bf16_f32 v211, v214, v215
  v_cvt_pk_bf16_f32 v212, v216, v217
  v_cvt_pk_bf16_f32 v213, v218, v219
  v_cvt_pk_bf16_f32 v214, v220, v221
  v_cvt_pk_bf16_f32 v215, v222, v223
  v_bfe_u32 v3, v1, 4, 1
  v_lshlrev_b32 v3, 11, v3
  v_lshrrev_b32 v5, 5, v1
  v_lshl_add_u32 v3, v5, 8, v3
  v_and_b32 v5, 15, v1
  v_lshl_add_u32 v3, v5, 4, v3
  buffer_store_dwordx4 v[208:211], v3, s[16:19], s75 offen offset:1024 sc1
  buffer_store_dwordx4 v[212:215], v3, s[16:19], s75 offen offset:1536 sc1
  s_mul_i32 s70, s60, 24576
  s_lshl_b32 s72, s59, 7
  s_add_u32 s70, s70, s72
  s_lshl_b32 s71, s60, 10
  s_waitcnt vmcnt(12)
  s_barrier
  ds_read_b64_tr_b16 v[32:33], v19 offset:0
  ds_read_b64_tr_b16 v[34:35], v19 offset:512
  ds_read_b64_tr_b16 v[40:41], v20 offset:0
  ds_read_b64_tr_b16 v[42:43], v20 offset:512
  s_waitcnt lgkmcnt(2)
  v_mfma_f32_32x32x16_bf16 v[224:239], v[32:35], v[64:67], v[224:239]
  ds_read_b64_tr_b16 v[48:49], v19 offset:4096
  ds_read_b64_tr_b16 v[50:51], v19 offset:4608
  s_add_u32 m0, s71, 81920
  s_add_u32 s72, s70, 1179648
  buffer_load_dwordx4 v12, s[8:11], s72 offen lds
  s_waitcnt lgkmcnt(2)
  v_mfma_f32_32x32x16_bf16 v[224:239], v[40:43], v[68:71], v[224:239]
  ds_read_b64_tr_b16 v[32:33], v20 offset:4096
  ds_read_b64_tr_b16 v[34:35], v20 offset:4608
  s_add_u32 m0, s71, 86016
  s_add_u32 s72, s70, 1277952
  buffer_load_dwordx4 v12, s[8:11], s72 offen lds
  s_waitcnt lgkmcnt(2)
  v_mfma_f32_32x32x16_bf16 v[224:239], v[48:51], v[72:75], v[224:239]
  ds_read_b64_tr_b16 v[40:41], v19 offset:8192
  ds_read_b64_tr_b16 v[42:43], v19 offset:8704
  s_add_u32 m0, s71, 90112
  s_add_u32 s72, s70, 1376256
  buffer_load_dwordx4 v12, s[8:11], s72 offen lds
  s_waitcnt lgkmcnt(2)
  v_mfma_f32_32x32x16_bf16 v[224:239], v[32:35], v[76:79], v[224:239]
  ds_read_b64_tr_b16 v[48:49], v20 offset:8192
  ds_read_b64_tr_b16 v[50:51], v20 offset:8704
  s_add_u32 m0, s71, 94208
  s_add_u32 s72, s70, 1474560
  buffer_load_dwordx4 v12, s[8:11], s72 offen lds
  s_waitcnt lgkmcnt(2)
  v_mfma_f32_32x32x16_bf16 v[224:239], v[40:43], v[80:83], v[224:239]
  ds_read_b64_tr_b16 v[32:33], v19 offset:12288
  ds_read_b64_tr_b16 v[34:35], v19 offset:12800
  s_waitcnt lgkmcnt(2)
  v_mfma_f32_32x32x16_bf16 v[224:239], v[48:51], v[84:87], v[224:239]
  ds_read_b64_tr_b16 v[40:41], v20 offset:12288
  ds_read_b64_tr_b16 v[42:43], v20 offset:12800
  s_waitcnt lgkmcnt(2)
  v_mfma_f32_32x32x16_bf16 v[224:239], v[32:35], v[88:91], v[224:239]
  s_waitcnt vmcnt(12)
  s_barrier
  ds_read_b64_tr_b16 v[48:49], v19 offset:16384
  ds_read_b64_tr_b16 v[50:51], v19 offset:16896
  s_waitcnt lgkmcnt(2)
  v_mfma_f32_32x32x16_bf16 v[224:239], v[40:43], v[92:95], v[224:239]
  ds_read_b64_tr_b16 v[32:33], v20 offset:16384
  ds_read_b64_tr_b16 v[34:35], v20 offset:16896
  s_waitcnt lgkmcnt(2)
  v_mfma_f32_32x32x16_bf16 v[224:239], v[48:51], v[96:99], v[224:239]
  ds_read_b64_tr_b16 v[40:41], v19 offset:20480
  ds_read_b64_tr_b16 v[42:43], v19 offset:20992
  s_waitcnt lgkmcnt(2)
  v_mfma_f32_32x32x16_bf16 v[224:239], v[32:35], v[100:103], v[224:239]
  ds_read_b64_tr_b16 v[48:49], v20 offset:20480
  ds_read_b64_tr_b16 v[50:51], v20 offset:20992
  s_waitcnt lgkmcnt(2)
  v_mfma_f32_32x32x16_bf16 v[224:239], v[40:43], v[104:107], v[224:239]
  ds_read_b64_tr_b16 v[32:33], v19 offset:24576
  ds_read_b64_tr_b16 v[34:35], v19 offset:25088
  s_waitcnt lgkmcnt(2)
  v_mfma_f32_32x32x16_bf16 v[224:239], v[48:51], v[108:111], v[224:239]
  ds_read_b64_tr_b16 v[40:41], v20 offset:24576
  ds_read_b64_tr_b16 v[42:43], v20 offset:25088
  s_waitcnt lgkmcnt(2)
  v_mfma_f32_32x32x16_bf16 v[224:239], v[32:35], v[112:115], v[224:239]
  ds_read_b64_tr_b16 v[48:49], v19 offset:28672
  ds_read_b64_tr_b16 v[50:51], v19 offset:29184
  s_waitcnt lgkmcnt(2)
  v_mfma_f32_32x32x16_bf16 v[224:239], v[40:43], v[116:119], v[224:239]
  ds_read_b64_tr_b16 v[32:33], v20 offset:28672
  ds_read_b64_tr_b16 v[34:35], v20 offset:29184
  s_waitcnt lgkmcnt(2)
  v_mfma_f32_32x32x16_bf16 v[224:239], v[48:51], v[120:123], v[224:239]
  s_waitcnt vmcnt(8)
  s_barrier
  ds_read_b64_tr_b16 v[40:41], v17 offset:0
  ds_read_b64_tr_b16 v[42:43], v17 offset:512
  s_waitcnt lgkmcnt(2)
  v_mfma_f32_32x32x16_bf16 v[224:239], v[32:35], v[124:127], v[224:239]
  ds_read_b64_tr_b16 v[48:49], v18 offset:0
  ds_read_b64_tr_b16 v[50:51], v18 offset:512
  s_waitcnt lgkmcnt(2)
  v_mfma_f32_32x32x16_bf16 v[224:239], v[40:43], v[128:131], v[224:239]
  ds_read_b64_tr_b16 v[32:33], v17 offset:4096
  ds_read_b64_tr_b16 v[34:35], v17 offset:4608
  s_waitcnt lgkmcnt(2)
  v_mfma_f32_32x32x16_bf16 v[224:239], v[48:51], v[132:135], v[224:239]
  ds_read_b64_tr_b16 v[40:41], v18 offset:4096
  ds_read_b64_tr_b16 v[42:43], v18 offset:4608
  s_waitcnt lgkmcnt(2)
  v_mfma_f32_32x32x16_bf16 v[224:239], v[32:35], v[136:139], v[224:239]
  ds_read_b64_tr_b16 v[48:49], v17 offset:8192
  ds_read_b64_tr_b16 v[50:51], v17 offset:8704
  s_waitcnt lgkmcnt(2)
  v_mfma_f32_32x32x16_bf16 v[224:239], v[40:43], v[140:143], v[224:239]
  ds_read_b64_tr_b16 v[32:33], v18 offset:8192
  ds_read_b64_tr_b16 v[34:35], v18 offset:8704
  s_waitcnt lgkmcnt(2)
  v_mfma_f32_32x32x16_bf16 v[224:239], v[48:51], v[144:147], v[224:239]
  ds_read_b64_tr_b16 v[40:41], v17 offset:12288
  ds_read_b64_tr_b16 v[42:43], v17 offset:12800
  s_waitcnt lgkmcnt(2)
  v_mfma_f32_32x32x16_bf16 v[224:239], v[32:35], v[148:151], v[224:239]
  ds_read_b64_tr_b16 v[48:49], v18 offset:12288
  ds_read_b64_tr_b16 v[50:51], v18 offset:12800
  s_waitcnt lgkmcnt(2)
  v_mfma_f32_32x32x16_bf16 v[224:239], v[40:43], v[152:155], v[224:239]
  s_waitcnt vmcnt(4)
  s_waitcnt vmcnt(0)
  s_barrier
  s_cmp_eq_u32 s60, 0
  s_cbranch_scc0 L_fs_79
  s_lshl_b32 s78, s61, 8
  s_add_u32 s78, s78, s2
  s_lshl_b32 s78, s78, 7
  s_add_u32 s78, s78, 4096
  v_mov_b32 v4, s62
  v_mov_b32 v5, s63
  v_mov_b32 v6, s78
  s_mov_b64 exec, 1
  buffer_store_dwordx2 v[4:5], v6, s[16:19], 0 offen sc1
  s_mov_b64 exec, -1
L_fs_79:
  ds_read_b64_tr_b16 v[32:33], v17 offset:16384
  ds_read_b64_tr_b16 v[34:35], v17 offset:16896
  s_waitcnt lgkmcnt(2)
  v_mfma_f32_32x32x16_bf16 v[224:239], v[48:51], v[156:159], v[224:239]
  ds_read_b64_tr_b16 v[40:41], v18 offset:16384
  ds_read_b64_tr_b16 v[42:43], v18 offset:16896
  s_waitcnt lgkmcnt(2)
  v_mfma_f32_32x32x16_bf16 v[224:239], v[32:35], v[160:163], v[224:239]
  ds_read_b64_tr_b16 v[48:49], v17 offset:20480
  ds_read_b64_tr_b16 v[50:51], v17 offset:20992
  s_waitcnt lgkmcnt(2)
  v_mfma_f32_32x32x16_bf16 v[224:239], v[40:43], v[164:167], v[224:239]
  ds_read_b64_tr_b16 v[32:33], v18 offset:20480
  ds_read_b64_tr_b16 v[34:35], v18 offset:20992
  s_waitcnt lgkmcnt(2)
  v_mfma_f32_32x32x16_bf16 v[224:239], v[48:51], v[168:171], v[224:239]
  ds_read_b64_tr_b16 v[40:41], v17 offset:24576
  ds_read_b64_tr_b16 v[42:43], v17 offset:25088
  s_waitcnt lgkmcnt(2)
  v_mfma_f32_32x32x16_bf16 v[224:239], v[32:35], v[172:175], v[224:239]
  ds_read_b64_tr_b16 v[48:49], v18 offset:24576
  ds_read_b64_tr_b16 v[50:51], v18 offset:25088
  s_waitcnt lgkmcnt(2)
  v_mfma_f32_32x32x16_bf16 v[224:239], v[40:43], v[176:179], v[224:239]
  ds_read_b64_tr_b16 v[32:33], v17 offset:28672
  ds_read_b64_tr_b16 v[34:35], v17 offset:29184
  s_waitcnt lgkmcnt(2)
  v_mfma_f32_32x32x16_bf16 v[224:239], v[48:51], v[180:183], v[224:239]
  ds_read_b64_tr_b16 v[40:41], v18 offset:28672
  ds_read_b64_tr_b16 v[42:43], v18 offset:29184
  s_waitcnt lgkmcnt(2)
  v_mfma_f32_32x32x16_bf16 v[224:239], v[32:35], v[184:187], v[224:239]
  s_waitcnt lgkmcnt(0)
  v_mfma_f32_32x32x16_bf16 v[224:239], v[40:43], v[188:191], v[224:239]
  s_waitcnt lgkmcnt(0)
  s_barrier
  s_lshl_b32 s92, s59, 1
  s_add_u32 s92, s92, s67
  s_lshl_b32 s92, s92, 6
  s_lshl_b32 s93, s58, 1
  s_add_u32 s92, s92, s93
  s_add_u32 s92, s92, s68
  s_lshl_b32 s92, s92, 12
  s_add_u32 s92, s92, 5242880
  s_mul_i32 s93, s67, 40960
  s_lshl_b32 s94, s68, 12
  s_add_u32 s93, s93, s94
  s_add_u32 s93, s93, 98304
  s_add_u32 m0, s93, 0
  s_add_u32 s94, s92, 0
  buffer_load_dwordx4 v2, s[16:19], s94 offen sc1 lds
  s_add_u32 m0, s93, 1024
  s_add_u32 s94, s92, 1024
  buffer_load_dwordx4 v2, s[16:19], s94 offen sc1 lds
  s_add_u32 m0, s93, 2048
  s_add_u32 s94, s92, 2048
  buffer_load_dwordx4 v2, s[16:19], s94 offen sc1 lds
  s_add_u32 m0, s93, 3072
  s_add_u32 s94, s92, 3072
  buffer_load_dwordx4 v2, s[16:19], s94 offen sc1 lds
  v_mul_f32 v27, 0x3eb8aa3b, v27
  v_mul_f32 v224, v27, v224
  v_mul_f32 v225, v27, v225
  v_mul_f32 v226, v27, v226
  v_mul_f32 v227, v27, v227
  v_mul_f32 v228, v27, v228
  v_mul_f32 v229, v27, v229
  v_mul_f32 v230, v27, v230
  v_mul_f32 v231, v27, v231
  v_mul_f32 v232, v27, v232
  v_mul_f32 v233, v27, v233
  v_mul_f32 v234, v27, v234
  v_mul_f32 v235, v27, v235
  v_mul_f32 v236, v27, v236
  v_mul_f32 v237, v27, v237
  v_mul_f32 v238, v27, v238
  v_mul_f32 v239, v27, v239
  v_cvt_pk_bf16_f32 v224, v224, v225
  v_cvt_pk_bf16_f32 v225, v226, v227
  v_cvt_pk_bf16_f32 v226, v228, v229
  v_cvt_pk_bf16_f32 v227, v230, v231
  v_cvt_pk_bf16_f32 v228, v232, v233
  v_cvt_pk_bf16_f32 v229, v234, v235
  v_cvt_pk_bf16_f32 v230, v236, v237
  v_cvt_pk_bf16_f32 v231, v238, v239
  v_and_b32 v3, 31, v1
  v_lshrrev_b32 v4, 5, v1
  v_lshlrev_b32 v4, 2, v4
  v_sub_u32 v3, v3, v4
  v_mov_b32 v48, 0
  v_mov_b32 v49, 0xf149f2ca
  v_mov_b32 v50, 0xffff
  v_mov_b32 v51, 0xffff0000
  v_cmp_le_i32 s[72:73], 0, v3
  v_mov_b32 v160, 0
  v_mov_b32 v176, 0
  v_cndmask_b32 v208, v49, v48, s[72:73]
  v_cndmask_b32 v232, v48, v49, s[72:73]
  v_cndmask_b32 v52, v48, v50, s[72:73]
  v_cmp_le_i32 s[74:75], 1, v3
  v_mov_b32 v161, 0
  v_mov_b32 v177, 0
  v_cndmask_b32 v209, v49, v48, s[74:75]
  v_cndmask_b32 v233, v48, v49, s[74:75]
  v_cndmask_b32 v53, v48, v51, s[74:75]
  v_or_b32 v32, v52, v53
  v_not_b32 v40, v32
  v_cmp_le_i32 s[76:77], 2, v3
  v_mov_b32 v162, 0
  v_mov_b32 v178, 0
  v_cndmask_b32 v210, v49, v48, s[76:77]
  v_cndmask_b32 v234, v48, v49, s[76:77]
  v_cndmask_b32 v52, v48, v50, s[76:77]
  v_cmp_le_i32 s[78:79], 3, v3
  v_mov_b32 v163, 0
  v_mov_b32 v179, 0
  v_cndmask_b32 v211, v49, v48, s[78:79]
  v_cndmask_b32 v235, v48, v49, s[78:79]
  v_cndmask_b32 v53, v48, v51, s[78:79]
  v_or_b32 v33, v52, v53
  v_not_b32 v41, v33
  v_cmp_le_i32 s[72:73], 8, v3
  v_mov_b32 v164, 0
  v_mov_b32 v180, 0
  v_cndmask_b32 v212, v49, v48, s[72:73]
  v_cndmask_b32 v236, v48, v49, s[72:73]
  v_cndmask_b32 v52, v48, v50, s[72:73]
  v_cmp_le_i32 s[74:75], 9, v3
  v_mov_b32 v165, 0
  v_mov_b32 v181, 0
  v_cndmask_b32 v213, v49, v48, s[74:75]
  v_cndmask_b32 v237, v48, v49, s[74:75]
  v_cndmask_b32 v53, v48, v51, s[74:75]
  v_or_b32 v34, v52, v53
  v_not_b32 v42, v34
  v_cmp_le_i32 s[76:77], 10, v3
  v_mov_b32 v166, 0
  v_mov_b32 v182, 0
  v_cndmask_b32 v214, v49, v48, s[76:77]
  v_cndmask_b32 v238, v48, v49, s[76:77]
  v_cndmask_b32 v52, v48, v50, s[76:77]
  v_cmp_le_i32 s[78:79], 11, v3
  v_mov_b32 v167, 0
  v_mov_b32 v183, 0
  v_cndmask_b32 v215, v49, v48, s[78:79]
  v_cndmask_b32 v239, v48, v49, s[78:79]
  v_cndmask_b32 v53, v48, v51, s[78:79]
  v_or_b32 v35, v52, v53
  v_not_b32 v43, v35
  v_cmp_le_i32 s[72:73], 16, v3
  v_mov_b32 v168, 0
  v_mov_b32 v184, 0
  v_cndmask_b32 v216, v49, v48, s[72:73]
  v_cndmask_b32 v240, v48, v49, s[72:73]
  v_cndmask_b32 v52, v48, v50, s[72:73]
  v_cmp_le_i32 s[74:75], 17, v3
  v_mov_b32 v169, 0
  v_mov_b32 v185, 0
  v_cndmask_b32 v217, v49, v48, s[74:75]
  v_cndmask_b32 v241, v48, v49, s[74:75]
  v_cndmask_b32 v53, v48, v51, s[74:75]
  v_or_b32 v36, v52, v53
  v_not_b32 v44, v36
  v_cmp_le_i32 s[76:77], 18, v3
  v_mov_b32 v170, 0
  v_mov_b32 v186, 0
  v_cndmask_b32 v218, v49, v48, s[76:77]
  v_cndmask_b32 v242, v48, v49, s[76:77]
  v_cndmask_b32 v52, v48, v50, s[76:77]
  v_cmp_le_i32 s[78:79], 19, v3
  v_mov_b32 v171, 0
  v_mov_b32 v187, 0
  v_cndmask_b32 v219, v49, v48, s[78:79]
  v_cndmask_b32 v243, v48, v49, s[78:79]
  v_cndmask_b32 v53, v48, v51, s[78:79]
  v_or_b32 v37, v52, v53
  v_not_b32 v45, v37
  v_cmp_le_i32 s[72:73], 24, v3
  v_mov_b32 v172, 0
  v_mov_b32 v188, 0
  v_cndmask_b32 v220, v49, v48, s[72:73]
  v_cndmask_b32 v244, v48, v49, s[72:73]
  v_cndmask_b32 v52, v48, v50, s[72:73]
  v_cmp_le_i32 s[74:75], 25, v3
  v_mov_b32 v173, 0
  v_mov_b32 v189, 0
  v_cndmask_b32 v221, v49, v48, s[74:75]
  v_cndmask_b32 v245, v48, v49, s[74:75]
  v_cndmask_b32 v53, v48, v51, s[74:75]
  v_or_b32 v38, v52, v53
  v_not_b32 v46, v38
  v_cmp_le_i32 s[76:77], 26, v3
  v_mov_b32 v174, 0
  v_mov_b32 v190, 0
  v_cndmask_b32 v222, v49, v48, s[76:77]
  v_cndmask_b32 v246, v48, v49, s[76:77]
  v_cndmask_b32 v52, v48, v50, s[76:77]
  v_cmp_le_i32 s[78:79], 27, v3
  v_mov_b32 v175, 0
  v_mov_b32 v191, 0
  v_cndmask_b32 v223, v49, v48, s[78:79]
  v_cndmask_b32 v247, v48, v49, s[78:79]
  v_cndmask_b32 v53, v48, v51, s[78:79]
  v_or_b32 v39, v52, v53
  v_not_b32 v47, v39
  v_mov_b32 v192, 0
  v_mov_b32 v200, 0
  v_mov_b32 v193, 0
  v_mov_b32 v201, 0
  v_mov_b32 v194, 0
  v_mov_b32 v202, 0
  v_mov_b32 v195, 0
  v_mov_b32 v203, 0
  v_mov_b32 v196, 0
  v_mov_b32 v204, 0
  v_mov_b32 v197, 0
  v_mov_b32 v205, 0
  v_mov_b32 v198, 0
  v_mov_b32 v206, 0
  v_mov_b32 v199, 0
  v_mov_b32 v207, 0
  v_accvgpr_write_b32 a72, v48
  v_accvgpr_write_b32 a73, v48
  v_accvgpr_write_b32 a74, v48
  v_accvgpr_write_b32 a75, v48
  v_accvgpr_write_b32 a76, v48
  v_accvgpr_write_b32 a77, v48
  v_accvgpr_write_b32 a78, v48
  v_accvgpr_write_b32 a79, v48
  v_accvgpr_write_b32 a80, v48
  v_accvgpr_write_b32 a81, v48
  v_accvgpr_write_b32 a82, v48
  v_accvgpr_write_b32 a83, v48
  v_accvgpr_write_b32 a84, v48
  v_accvgpr_write_b32 a85, v48
  v_accvgpr_write_b32 a86, v48
  v_accvgpr_write_b32 a87, v48
  v_mov_b32 v54, 0x3f803f80
  s_mov_b32 exec_lo, 0x00110000
  s_mov_b32 exec_hi, 0x00110000
  v_accvgpr_write_b32 a72, v54
  v_accvgpr_write_b32 a73, v54
  v_accvgpr_write_b32 a74, v54
  v_accvgpr_write_b32 a75, v54
  v_accvgpr_write_b32 a76, v54
  v_accvgpr_write_b32 a77, v54
  v_accvgpr_write_b32 a78, v54
  v_accvgpr_write_b32 a79, v54
  v_accvgpr_write_b32 a80, v54
  v_accvgpr_write_b32 a81, v54
  v_accvgpr_write_b32 a82, v54
  v_accvgpr_write_b32 a83, v54
  v_accvgpr_write_b32 a84, v54
  v_accvgpr_write_b32 a85, v54
  v_accvgpr_write_b32 a86, v54
  v_accvgpr_write_b32 a87, v54
  s_mov_b64 exec, -1
  s_sub_u32 s72, s58, 4
  v_add_u32 v8, s72, v1
  v_cmp_le_i32 s[74:75], 0, v8
  v_and_b32 v9, 3, v8
  v_lshlrev_b32 v9, 3, v9
  v_add_u32 v9, s59, v9
  v_lshlrev_b32 v9, 3, v9
  v_lshrrev_b32 v7, 2, v8
  v_add_u32 v9, v9, v7
  s_lshl_b32 s70, s61, 15
  s_add_u32 s70, s70, 4096
  v_lshlrev_b32 v9, 7, v9
  v_add_u32 v9, s70, v9
  s_and_b64 s[74:75], s[74:75], 0xf
  s_lshl_b32 s76, s58, 1
  s_add_u32 s76, s76, s68
  s_sub_u32 s77, 8, s76
  s_max_i32 s77, s77, 0
  s_lshl_b32 s78, s59, 1
  s_add_u32 s78, s78, s67
  s_lshl_b32 s78, s78, 18
  s_lshl_b32 s79, s61, 22
  s_add_u32 s78, s78, s79
  s_add_u32 s78, s78, 1048576
  s_lshl_b32 s79, s68, 2
  s_lshl_b32 s80, s58, 1
  s_add_u32 s80, s80, s79
  s_sub_u32 s80, s80, 8
  s_add_i32 s81, s80, 0
  s_max_i32 s81, s81, 0
  s_lshl_b32 s81, s81, 12
  s_add_u32 s81, s81, s78
  s_add_i32 s82, s80, 1
  s_max_i32 s82, s82, 0
  s_lshl_b32 s82, s82, 12
  s_add_u32 s82, s82, s78
  s_add_i32 s83, s80, 2
  s_max_i32 s83, s83, 0
  s_lshl_b32 s83, s83, 12
  s_add_u32 s83, s83, s78
  s_add_i32 s84, s80, 3
  s_max_i32 s84, s84, 0
  s_lshl_b32 s84, s84, 12
  s_add_u32 s84, s84, s78
  s_mul_i32 s86, s67, 40960
  s_lshl_b32 s87, s68, 14
  s_add_u32 s87, s87, s86
  s_add_u32 s87, s87, 65536
  s_lshl_b32 s88, s68, 12
  s_add_u32 s88, s88, s86
  s_add_u32 s88, s88, 65536
  v_add_u32 v10, s88, v2
  v_and_b32 v8, 15, v1
  v_lshlrev_b32 v8, 4, v8
  v_lshrrev_b32 v7, 5, v1
  v_lshl_add_u32 v8, v7, 8, v8
  v_add_u32 v11, s88, v8
  s_mov_b32 s90, 0xffff
  s_mov_b32 s91, 0xffff
  v_bfe_u32 v20, v1, 4, 1
  v_lshlrev_b32 v20, 14, v20
  v_and_b32 v7, 15, v1
  v_lshl_add_u32 v20, v7, 4, v20
  v_lshrrev_b32 v7, 5, v1
  v_lshl_add_u32 v20, v7, 8, v20
  s_lshl_b32 s72, s58, 2
  s_lshl_b32 s73, s68, 1
  s_add_u32 s72, s72, s73
  s_lshl_b32 s72, s72, 4
  s_lshl_b32 s73, s59, 1
  s_add_u32 s72, s72, s73
  s_add_u32 s72, s72, s67
  s_lshl_b32 s72, s72, 10
  s_lshl_b32 s73, s61, 21
  s_add_u32 s72, s72, s73
  s_add_u32 s89, s72, 9437184
  s_mov_b64 s[76:77], s[74:75]
  v_lshrrev_b32 v3, 3, v1
  v_lshlrev_b32 v3, 10, v3
  v_bfe_u32 v4, v1, 1, 2
  v_bfe_u32 v5, v1, 4, 2
  v_xor_b32 v4, v4, v5
  v_lshlrev_b32 v4, 1, v4
  v_and_b32 v5, 1, v1
  v_add_u32 v4, v4, v5
  v_lshl_add_u32 v19, v4, 4, v3
  s_lshl_b32 s78, s60, 17
  s_lshl_b32 s73, s59, 7
  s_add_u32 s78, s78, s73
  s_lshl_b32 s79, s60, 14
  s_mov_b64 exec, s[76:77]
  s_mov_b32 s100, 0
  s_cbranch_execz L_pok_81
L_poll_80:
  buffer_load_dwordx2 v[4:5], v9, s[16:19], 0 offen sc1
  s_waitcnt vmcnt(0)
  v_cmp_ne_u64 vcc, s[62:63], v[4:5]
  s_nop 0
  s_cbranch_vccz L_pok_81
  s_add_u32 s100, s100, 1
  s_cmp_lt_u32 s100, 400000
  s_cbranch_scc1 L_poll_80
  s_branch L_fail
L_pok_81:
  s_mov_b64 exec, -1
  s_lshl_b32 s76, s58, 1
  s_add_u32 s76, s76, s68
  s_sub_u32 s77, 8, s76
  s_max_i32 s77, s77, 0
  s_add_u32 m0, s87, 0
  s_add_u32 s72, s81, 0
  buffer_load_dwordx4 v2, s[16:19], s72 offen sc1 lds
  s_add_u32 m0, s87, 2048
  s_add_u32 s72, s81, 2048
  buffer_load_dwordx4 v2, s[16:19], s72 offen sc1 lds
  s_add_u32 m0, s87, 4096
  s_add_u32 s72, s82, 0
  buffer_load_dwordx4 v2, s[16:19], s72 offen sc1 lds
  s_add_u32 m0, s87, 6144
  s_add_u32 s72, s82, 2048
  buffer_load_dwordx4 v2, s[16:19], s72 offen sc1 lds
  s_add_u32 m0, s87, 8192
  s_add_u32 s72, s83, 0
  buffer_load_dwordx4 v2, s[16:19], s72 offen sc1 lds
  s_add_u32 m0, s87, 10240
  s_add_u32 s72, s83, 2048
  buffer_load_dwordx4 v2, s[16:19], s72 offen sc1 lds
  s_add_u32 m0, s87, 12288
  s_add_u32 s72, s84, 0
  buffer_load_dwordx4 v2, s[16:19], s72 offen sc1 lds
  s_add_u32 m0, s87, 14336
  s_add_u32 s72, s84, 2048
  buffer_load_dwordx4 v2, s[16:19], s72 offen sc1 lds
  s_add_u32 m0, s87, 1024
  s_add_u32 s72, s81, 1024
  buffer_load_dwordx4 v2, s[16:19], s72 offen sc1 lds
  s_add_u32 m0, s87, 3072
  s_add_u32 s72, s81, 3072
  buffer_load_dwordx4 v2, s[16:19], s72 offen sc1 lds
  s_add_u32 m0, s87, 5120
  s_add_u32 s72, s82, 1024
  buffer_load_dwordx4 v2, s[16:19], s72 offen sc1 lds
  s_add_u32 m0, s87, 7168
  s_add_u32 s72, s82, 3072
  buffer_load_dwordx4 v2, s[16:19], s72 offen sc1 lds
  s_add_u32 m0, s87, 9216
  s_add_u32 s72, s83, 1024
  buffer_load_dwordx4 v2, s[16:19], s72 offen sc1 lds
  s_add_u32 m0, s87, 11264
  s_add_u32 s72, s83, 3072
  buffer_load_dwordx4 v2, s[16:19], s72 offen sc1 lds
  s_add_u32 m0, s87, 13312
  s_add_u32 s72, s84, 1024
  buffer_load_dwordx4 v2, s[16:19], s72 offen sc1 lds
  s_add_u32 m0, s87, 15360
  s_add_u32 s72, s84, 3072
  buffer_load_dwordx4 v2, s[16:19], s72 offen sc1 lds
  v_mov_b32 v48, 0xf149f2ca
  v_mov_b32 v49, 0xf149f2ca
  v_mov_b32 v50, 0xf149f2ca
  v_mov_b32 v51, 0xf149f2ca
  s_waitcnt vmcnt(8)
  s_barrier
  ds_read_b128 a[0:3], v10 offset:0
  ds_read_b128 a[4:7], v10 offset:2048
  ds_read_b128 a[8:11], v10 offset:4096
  ds_read_b128 a[12:15], v10 offset:6144
  s_waitcnt lgkmcnt(3)
  v_mfma_f32_32x32x16_bf16 v[64:79], a[0:3], v[224:227], v[232:247]
  ds_read_b128 a[16:19], v10 offset:8192
  s_waitcnt lgkmcnt(3)
  v_mfma_f32_32x32x16_bf16 v[80:95], a[4:7], v[228:231], v[232:247]
  s_cmp_gt_u32 s77, 0
  s_cbranch_scc1 L_p1s_82
  ds_read_b128 a[20:23], v10 offset:10240
  s_waitcnt lgkmcnt(3)
  v_mfma_f32_32x32x16_bf16 v[96:111], a[8:11], v[224:227], 0
  s_nop 3
  v_max3_f32 v48, v48, v64, v65
  v_max3_f32 v49, v49, v66, v67
  v_max3_f32 v48, v48, v68, v69
  v_max3_f32 v49, v49, v70, v71
  v_max3_f32 v48, v48, v72, v73
  v_max3_f32 v49, v49, v74, v75
  v_max3_f32 v48, v48, v76, v77
  v_max3_f32 v49, v49, v78, v79
  ds_read_b128 a[24:27], v10 offset:12288
  s_waitcnt lgkmcnt(3)
  v_mfma_f32_32x32x16_bf16 v[112:127], a[12:15], v[228:231], 0
  v_max3_f32 v50, v50, v80, v81
  v_max3_f32 v51, v51, v82, v83
  v_max3_f32 v50, v50, v84, v85
  v_max3_f32 v51, v51, v86, v87
  v_max3_f32 v50, v50, v88, v89
  v_max3_f32 v51, v51, v90, v91
  v_max3_f32 v50, v50, v92, v93
  v_max3_f32 v51, v51, v94, v95
L_p1b_83:
  s_cmp_gt_u32 s77, 1
  s_cbranch_scc1 L_p1s_84
  ds_read_b128 a[28:31], v10 offset:14336
  s_waitcnt lgkmcnt(3)
  v_mfma_f32_32x32x16_bf16 v[64:79], a[16:19], v[224:227], 0
  v_max3_f32 v48, v48, v96, v97
  v_max3_f32 v49, v49, v98, v99
  v_max3_f32 v48, v48, v100, v101
  v_max3_f32 v49, v49, v102, v103
  s_add_u32 m0, s79, 0
  s_add_u32 s72, s78, 0
  buffer_load_dwordx4 v19, s[12:15], s72 offen lds
  v_max3_f32 v48, v48, v104, v105
  v_max3_f32 v49, v49, v106, v107
  v_max3_f32 v48, v48, v108, v109
  v_max3_f32 v49, v49, v110, v111
  ds_read_b128 a[32:35], v10 offset:16384
  s_waitcnt lgkmcnt(3)
  v_mfma_f32_32x32x16_bf16 v[80:95], a[20:23], v[228:231], 0
  v_max3_f32 v50, v50, v112, v113
  v_max3_f32 v51, v51, v114, v115
  v_max3_f32 v50, v50, v116, v117
  v_max3_f32 v51, v51, v118, v119
  s_add_u32 m0, s79, 1024
  s_add_u32 s72, s78, 8192
  buffer_load_dwordx4 v19, s[12:15], s72 offen lds
  v_max3_f32 v50, v50, v120, v121
  v_max3_f32 v51, v51, v122, v123
  v_max3_f32 v50, v50, v124, v125
  v_max3_f32 v51, v51, v126, v127
L_p1b_85:
  s_cmp_gt_u32 s77, 2
  s_cbranch_scc1 L_p1s_86
  ds_read_b128 a[36:39], v10 offset:18432
  s_waitcnt lgkmcnt(3)
  v_mfma_f32_32x32x16_bf16 v[96:111], a[24:27], v[224:227], 0
  v_max3_f32 v48, v48, v64, v65
  v_max3_f32 v49, v49, v66, v67
  v_max3_f32 v48, v48, v68, v69
  v_max3_f32 v49, v49, v70, v71
  s_add_u32 m0, s79, 2048
  s_add_u32 s72, s78, 16384
  buffer_load_dwordx4 v19, s[12:15], s72 offen lds
  v_max3_f32 v48, v48, v72, v73
  v_max3_f32 v49, v49, v74, v75
  v_max3_f32 v48, v48, v76, v77
  v_max3_f32 v49, v49, v78, v79
  ds_read_b128 a[40:43], v10 offset:20480
  s_waitcnt lgkmcnt(3)
  v_mfma_f32_32x32x16_bf16 v[112:127], a[28:31], v[228:231], 0
  v_max3_f32 v50, v50, v80, v81
  v_max3_f32 v51, v51, v82, v83
  v_max3_f32 v50, v50, v84, v85
  v_max3_f32 v51, v51, v86, v87
  s_add_u32 m0, s79, 3072
  s_add_u32 s72, s78, 24576
  buffer_load_dwordx4 v19, s[12:15], s72 offen lds
  v_max3_f32 v50, v50, v88, v89
  v_max3_f32 v51, v51, v90, v91
  v_max3_f32 v50, v50, v92, v93
  v_max3_f32 v51, v51, v94, v95
L_p1b_87:
  s_cmp_gt_u32 s77, 3
  s_cbranch_scc1 L_p1s_88
  ds_read_b128 a[44:47], v10 offset:22528
  s_waitcnt lgkmcnt(3)
  v_mfma_f32_32x32x16_bf16 v[64:79], a[32:35], v[224:227], 0
  v_max3_f32 v48, v48, v96, v97
  v_max3_f32 v49, v49, v98, v99
  v_max3_f32 v48, v48, v100, v101
  v_max3_f32 v49, v49, v102, v103
  s_add_u32 m0, s79, 4096
  s_add_u32 s72, s78, 32768
  buffer_load_dwordx4 v19, s[12:15], s72 offen lds
  v_max3_f32 v48, v48, v104, v105
  v_max3_f32 v49, v49, v106, v107
  v_max3_f32 v48, v48, v108, v109
  v_max3_f32 v49, v49, v110, v111
  ds_read_b128 a[48:51], v10 offset:24576
  s_waitcnt lgkmcnt(3)
  v_mfma_f32_32x32x16_bf16 v[80:95], a[36:39], v[228:231], 0
  v_max3_f32 v50, v50, v112, v113
  v_max3_f32 v51, v51, v114, v115
  v_max3_f32 v50, v50, v116, v117
  v_max3_f32 v51, v51, v118, v119
  s_add_u32 m0, s79, 5120
  s_add_u32 s72, s78, 40960
  buffer_load_dwordx4 v19, s[12:15], s72 offen lds
  v_max3_f32 v50, v50, v120, v121
  v_max3_f32 v51, v51, v122, v123
  v_max3_f32 v50, v50, v124, v125
  v_max3_f32 v51, v51, v126, v127
L_p1b_89:
  s_cmp_gt_u32 s77, 4
  s_cbranch_scc1 L_p1s_90
  ds_read_b128 a[52:55], v10 offset:26624
  s_waitcnt lgkmcnt(3)
  v_mfma_f32_32x32x16_bf16 v[96:111], a[40:43], v[224:227], 0
  v_max3_f32 v48, v48, v64, v65
  v_max3_f32 v49, v49, v66, v67
  v_max3_f32 v48, v48, v68, v69
  v_max3_f32 v49, v49, v70, v71
  s_add_u32 m0, s79, 6144
  s_add_u32 s72, s78, 49152
  buffer_load_dwordx4 v19, s[12:15], s72 offen lds
  v_max3_f32 v48, v48, v72, v73
  v_max3_f32 v49, v49, v74, v75
  v_max3_f32 v48, v48, v76, v77
  v_max3_f32 v49, v49, v78, v79
  ds_read_b128 a[56:59], v10 offset:28672
  s_waitcnt lgkmcnt(3)
  v_mfma_f32_32x32x16_bf16 v[112:127], a[44:47], v[228:231], 0
  v_max3_f32 v50, v50, v80, v81
  v_max3_f32 v51, v51, v82, v83
  v_max3_f32 v50, v50, v84, v85
  v_max3_f32 v51, v51, v86, v87
  s_add_u32 m0, s79, 7168
  s_add_u32 s72, s78, 57344
  buffer_load_dwordx4 v19, s[12:15], s72 offen lds
  v_max3_f32 v50, v50, v88, v89
  v_max3_f32 v51, v51, v90, v91
  v_max3_f32 v50, v50, v92, v93
  v_max3_f32 v51, v51, v94, v95
L_p1b_91:
  s_cmp_gt_u32 s77, 5
  s_cbranch_scc1 L_p1s_92
  ds_read_b128 a[60:63], v10 offset:30720
  s_waitcnt lgkmcnt(3)
  v_mfma_f32_32x32x16_bf16 v[64:79], a[48:51], v[224:227], 0
  v_max3_f32 v48, v48, v96, v97
  v_max3_f32 v49, v49, v98, v99
  v_max3_f32 v48, v48, v100, v101
  v_max3_f32 v49, v49, v102, v103
  s_add_u32 m0, s79, 8192
  s_add_u32 s72, s78, 65536
  buffer_load_dwordx4 v19, s[12:15], s72 offen lds
  v_max3_f32 v48, v48, v104, v105
  v_max3_f32 v49, v49, v106, v107
  v_max3_f32 v48, v48, v108, v109
  v_max3_f32 v49, v49, v110, v111
  ds_read_b128 a[64:67], v10 offset:32768
  s_waitcnt lgkmcnt(3)
  v_mfma_f32_32x32x16_bf16 v[80:95], a[52:55], v[228:231], 0
  v_max3_f32 v50, v50, v112, v113
  v_max3_f32 v51, v51, v114, v115
  v_max3_f32 v50, v50, v116, v117
  v_max3_f32 v51, v51, v118, v119
  s_add_u32 m0, s79, 9216
  s_add_u32 s72, s78, 73728
  buffer_load_dwordx4 v19, s[12:15], s72 offen lds
  v_max3_f32 v50, v50, v120, v121
  v_max3_f32 v51, v51, v122, v123
  v_max3_f32 v50, v50, v124, v125
  v_max3_f32 v51, v51, v126, v127
L_p1b_93:
  s_cmp_gt_u32 s77, 6
  s_cbranch_scc1 L_p1s_94
  ds_read_b128 a[68:71], v10 offset:34816
  s_waitcnt lgkmcnt(3)
  v_mfma_f32_32x32x16_bf16 v[96:111], a[56:59], v[224:227], 0
  v_max3_f32 v48, v48, v64, v65
  v_max3_f32 v49, v49, v66, v67
  v_max3_f32 v48, v48, v68, v69
  v_max3_f32 v49, v49, v70, v71
  s_add_u32 m0, s79, 10240
  s_add_u32 s72, s78, 81920
  buffer_load_dwordx4 v19, s[12:15], s72 offen lds
  v_max3_f32 v48, v48, v72, v73
  v_max3_f32 v49, v49, v74, v75
  v_max3_f32 v48, v48, v76, v77
  v_max3_f32 v49, v49, v78, v79
  s_waitcnt lgkmcnt(2)
  v_mfma_f32_32x32x16_bf16 v[112:127], a[60:63], v[228:231], 0
  v_max3_f32 v50, v50, v80, v81
  v_max3_f32 v51, v51, v82, v83
  v_max3_f32 v50, v50, v84, v85
  v_max3_f32 v51, v51, v86, v87
  s_add_u32 m0, s79, 11264
  s_add_u32 s72, s78, 90112
  buffer_load_dwordx4 v19, s[12:15], s72 offen lds
  v_max3_f32 v50, v50, v88, v89
  v_max3_f32 v51, v51, v90, v91
  v_max3_f32 v50, v50, v92, v93
  v_max3_f32 v51, v51, v94, v95
L_p1b_95:
  s_cmp_gt_u32 s77, 7
  s_cbranch_scc1 L_p1s_96
  s_waitcnt lgkmcnt(1)
  v_mfma_f32_32x32x16_bf16 v[64:79], a[64:67], v[224:227], v[208:223]
  v_max3_f32 v48, v48, v96, v97
  v_max3_f32 v49, v49, v98, v99
  v_max3_f32 v48, v48, v100, v101
  v_max3_f32 v49, v49, v102, v103
  s_add_u32 m0, s79, 12288
  s_add_u32 s72, s78, 98304
  buffer_load_dwordx4 v19, s[12:15], s72 offen lds
  v_max3_f32 v48, v48, v104, v105
  v_max3_f32 v49, v49, v106, v107
  v_max3_f32 v48, v48, v108, v109
  v_max3_f32 v49, v49, v110, v111
  s_waitcnt lgkmcnt(0)
  v_mfma_f32_32x32x16_bf16 v[80:95], a[68:71], v[228:231], v[208:223]
  v_max3_f32 v50, v50, v112, v113
  v_max3_f32 v51, v51, v114, v115
  v_max3_f32 v50, v50, v116, v117
  v_max3_f32 v51, v51, v118, v119
  s_add_u32 m0, s79, 13312
  s_add_u32 s72, s78, 106496
  buffer_load_dwordx4 v19, s[12:15], s72 offen lds
  v_max3_f32 v50, v50, v120, v121
  v_max3_f32 v51, v51, v122, v123
  v_max3_f32 v50, v50, v124, v125
  v_max3_f32 v51, v51, v126, v127
L_p1b_97:
  v_max3_f32 v48, v48, v64, v65
  v_max3_f32 v49, v49, v66, v67
  v_max3_f32 v48, v48, v68, v69
  v_max3_f32 v49, v49, v70, v71
  s_add_u32 m0, s79, 14336
  s_add_u32 s72, s78, 114688
  buffer_load_dwordx4 v19, s[12:15], s72 offen lds
  v_max3_f32 v48, v48, v72, v73
  v_max3_f32 v49, v49, v74, v75
  v_max3_f32 v48, v48, v76, v77
  v_max3_f32 v49, v49, v78, v79
  v_max3_f32 v50, v50, v80, v81
  v_max3_f32 v51, v51, v82, v83
  v_max3_f32 v50, v50, v84, v85
  v_max3_f32 v51, v51, v86, v87
  s_add_u32 m0, s79, 15360
  s_add_u32 s72, s78, 122880
  buffer_load_dwordx4 v19, s[12:15], s72 offen lds
  v_max3_f32 v50, v50, v88, v89
  v_max3_f32 v51, v51, v90, v91
  v_max3_f32 v50, v50, v92, v93
  v_max3_f32 v51, v51, v94, v95
  v_max_f32 v48, v48, v49
  v_mov_b32 v49, v48
  v_max_f32 v50, v50, v51
  v_mov_b32 v51, v50
  v_permlane32_swap_b32 v48, v49
  s_nop 0
  v_permlane32_swap_b32 v50, v51
  v_max_f32 v48, v48, v49
  v_xor_b32 v48, 0x80000000, v48
  v_max_f32 v50, v50, v51
  v_xor_b32 v50, 0x80000000, v50
  v_mov_b32 v128, v48
  v_mov_b32 v129, v48
  v_mov_b32 v130, v48
  v_mov_b32 v131, v48
  v_mov_b32 v132, v48
  v_mov_b32 v133, v48
  v_mov_b32 v134, v48
  v_mov_b32 v135, v48
  v_mov_b32 v136, v48
  v_mov_b32 v137, v48
  v_mov_b32 v138, v48
  v_mov_b32 v139, v48
  v_mov_b32 v140, v48
  v_mov_b32 v141, v48
  v_mov_b32 v142, v48
  v_mov_b32 v143, v48
  s_nop 1
  v_mfma_f32_32x32x16_bf16 v[64:79], a[0:3], v[224:227], v[128:143]
  v_mov_b32 v144, v50
  v_mov_b32 v145, v50
  v_mov_b32 v146, v50
  v_mov_b32 v147, v50
  v_mov_b32 v148, v50
  v_mov_b32 v149, v50
  v_mov_b32 v150, v50
  v_mov_b32 v151, v50
  v_mov_b32 v152, v50
  v_mov_b32 v153, v50
  v_mov_b32 v154, v50
  v_mov_b32 v155, v50
  v_mov_b32 v156, v50
  v_mov_b32 v157, v50
  v_mov_b32 v158, v50
  v_mov_b32 v159, v50
  s_waitcnt vmcnt(16)
  s_barrier
  buffer_load_dword v21, v20, s[16:19], s89 offen sc1
  buffer_load_dword v23, v20, s[16:19], s89 offen offset:512 sc1
  s_lshl_b32 s72, s61, 5
  s_add_u32 s72, s72, s58
  s_lshl_b32 s72, s72, 3
  s_add_u32 s72, s72, s59
  s_lshl_b32 s72, s72, 10
  s_lshl_b32 s73, s60, 8
  s_add_u32 s72, s72, s73
  s_add_u32 s72, s72, 524288
  s_mov_b64 exec, 0xffff
  buffer_load_dword v22, v2, s[16:19], s72 offen sc1
  s_mov_b64 exec, -1
  s_cmp_gt_u32 s77, 0
  s_cbranch_scc1 L_sk_98
  v_exp_f32 v64, v64
  v_exp_f32 v65, v65
  v_mfma_f32_32x32x16_bf16 v[80:95], a[4:7], v[228:231], v[144:159]
  v_exp_f32 v66, v66
  v_cvt_pk_bf16_f32 v192, v64, v65
  v_exp_f32 v67, v67
  v_exp_f32 v68, v68
  v_cvt_pk_bf16_f32 v193, v66, v67
  v_exp_f32 v69, v69
  v_exp_f32 v70, v70
  v_cvt_pk_bf16_f32 v194, v68, v69
  v_exp_f32 v71, v71
  v_exp_f32 v72, v72
  v_cvt_pk_bf16_f32 v195, v70, v71
  v_exp_f32 v73, v73
  v_exp_f32 v74, v74
  v_cvt_pk_bf16_f32 v196, v72, v73
  v_exp_f32 v75, v75
  s_mov_b64 exec, s[90:91]
  ds_read_b128 a[72:75], v11 offset:1024
  ds_read_b128 a[76:79], v11 offset:1536
  s_mov_b64 exec, -1
  v_exp_f32 v76, v76
  v_cvt_pk_bf16_f32 v197, v74, v75
  v_exp_f32 v77, v77
  v_exp_f32 v78, v78
  v_cvt_pk_bf16_f32 v198, v76, v77
  v_exp_f32 v79, v79
  s_nop 0
  v_cvt_pk_bf16_f32 v199, v78, v79
  v_and_b32 v192, v40, v192
  v_and_b32 v193, v41, v193
  v_and_b32 v194, v42, v194
  v_and_b32 v195, v43, v195
  v_and_b32 v196, v44, v196
  v_and_b32 v197, v45, v197
  v_and_b32 v198, v46, v198
  v_and_b32 v199, v47, v199
  v_exp_f32 v80, v80
  v_exp_f32 v81, v81
  v_mfma_f32_32x32x16_bf16 v[64:79], a[8:11], v[224:227], v[128:143]
  v_exp_f32 v82, v82
  v_cvt_pk_bf16_f32 v200, v80, v81
  v_exp_f32 v83, v83
  v_exp_f32 v84, v84
  v_cvt_pk_bf16_f32 v201, v82, v83
  s_waitcnt lgkmcnt(1)
  v_mfma_f32_32x32x16_bf16 v[160:175], a[72:75], v[192:195], v[160:175]
  v_exp_f32 v85, v85
  v_exp_f32 v86, v86
  v_cvt_pk_bf16_f32 v202, v84, v85
  v_exp_f32 v87, v87
  v_exp_f32 v88, v88
  v_cvt_pk_bf16_f32 v203, v86, v87
  v_exp_f32 v89, v89
  s_waitcnt lgkmcnt(0)
  v_mfma_f32_32x32x16_bf16 v[160:175], a[76:79], v[196:199], v[160:175]
  v_exp_f32 v90, v90
  v_cvt_pk_bf16_f32 v204, v88, v89
  v_exp_f32 v91, v91
  s_mov_b64 exec, s[90:91]
  ds_read_b128 a[80:83], v11 offset:3072
  ds_read_b128 a[84:87], v11 offset:3584
  s_mov_b64 exec, -1
  v_exp_f32 v92, v92
  v_cvt_pk_bf16_f32 v205, v90, v91
  v_exp_f32 v93, v93
  v_exp_f32 v94, v94
  v_cvt_pk_bf16_f32 v206, v92, v93
  v_exp_f32 v95, v95
  s_nop 0
  v_cvt_pk_bf16_f32 v207, v94, v95
  v_and_b32 v200, v40, v200
  v_and_b32 v201, v41, v201
  v_and_b32 v202, v42, v202
  v_and_b32 v203, v43, v203
  v_and_b32 v204, v44, v204
  v_and_b32 v205, v45, v205
  v_and_b32 v206, v46, v206
  v_and_b32 v207, v47, v207
L_bk_99:
  s_cmp_gt_u32 s77, 1
  s_cbranch_scc1 L_sk_100
  v_exp_f32 v64, v64
  v_exp_f32 v65, v65
  v_mfma_f32_32x32x16_bf16 v[80:95], a[12:15], v[228:231], v[144:159]
  v_exp_f32 v66, v66
  v_cvt_pk_bf16_f32 v192, v64, v65
  v_exp_f32 v67, v67
  v_exp_f32 v68, v68
  v_cvt_pk_bf16_f32 v193, v66, v67
  s_waitcnt lgkmcnt(1)
  v_mfma_f32_32x32x16_bf16 v[176:191], a[80:83], v[200:203], v[176:191]
  v_exp_f32 v69, v69
  v_exp_f32 v70, v70
  v_cvt_pk_bf16_f32 v194, v68, v69
  v_exp_f32 v71, v71
  v_exp_f32 v72, v72
  v_cvt_pk_bf16_f32 v195, v70, v71
  v_exp_f32 v73, v73
  s_waitcnt lgkmcnt(0)
  v_mfma_f32_32x32x16_bf16 v[176:191], a[84:87], v[204:207], v[176:191]
  v_exp_f32 v74, v74
  v_cvt_pk_bf16_f32 v196, v72, v73
  v_exp_f32 v75, v75
  s_mov_b64 exec, s[90:91]
  ds_read_b128 a[72:75], v11 offset:5120
  ds_read_b128 a[76:79], v11 offset:5632
  s_mov_b64 exec, -1
  v_exp_f32 v76, v76
  v_cvt_pk_bf16_f32 v197, v74, v75
  v_exp_f32 v77, v77
  v_exp_f32 v78, v78
  v_cvt_pk_bf16_f32 v198, v76, v77
  v_exp_f32 v79, v79
  s_nop 0
  v_cvt_pk_bf16_f32 v199, v78, v79
  v_exp_f32 v80, v80
  v_exp_f32 v81, v81
  v_mfma_f32_32x32x16_bf16 v[64:79], a[16:19], v[224:227], v[128:143]
  v_exp_f32 v82, v82
  v_cvt_pk_bf16_f32 v200, v80, v81
  v_exp_f32 v83, v83
  v_exp_f32 v84, v84
  v_cvt_pk_bf16_f32 v201, v82, v83
  s_waitcnt lgkmcnt(1)
  v_mfma_f32_32x32x16_bf16 v[160:175], a[72:75], v[192:195], v[160:175]
  v_exp_f32 v85, v85
  v_exp_f32 v86, v86
  v_cvt_pk_bf16_f32 v202, v84, v85
  v_exp_f32 v87, v87
  v_exp_f32 v88, v88
  v_cvt_pk_bf16_f32 v203, v86, v87
  v_exp_f32 v89, v89
  s_waitcnt lgkmcnt(0)
  v_mfma_f32_32x32x16_bf16 v[160:175], a[76:79], v[196:199], v[160:175]
  v_exp_f32 v90, v90
  v_cvt_pk_bf16_f32 v204, v88, v89
  v_exp_f32 v91, v91
  s_mov_b64 exec, s[90:91]
  ds_read_b128 a[80:83], v11 offset:7168
  ds_read_b128 a[84:87], v11 offset:7680
  s_mov_b64 exec, -1
  v_exp_f32 v92, v92
  v_cvt_pk_bf16_f32 v205, v90, v91
  v_exp_f32 v93, v93
  v_exp_f32 v94, v94
  v_cvt_pk_bf16_f32 v206, v92, v93
  v_exp_f32 v95, v95
  s_nop 0
  v_cvt_pk_bf16_f32 v207, v94, v95
L_bk_101:
  s_cmp_gt_u32 s77, 2
  s_cbranch_scc1 L_sk_102
  v_exp_f32 v64, v64
  v_exp_f32 v65, v65
  v_mfma_f32_32x32x16_bf16 v[80:95], a[20:23], v[228:231], v[144:159]
  v_exp_f32 v66, v66
  v_cvt_pk_bf16_f32 v192, v64, v65
  v_exp_f32 v67, v67
  v_exp_f32 v68, v68
  v_cvt_pk_bf16_f32 v193, v66, v67
  s_waitcnt lgkmcnt(1)
  v_mfma_f32_32x32x16_bf16 v[176:191], a[80:83], v[200:203], v[176:191]
  v_exp_f32 v69, v69
  v_exp_f32 v70, v70
  v_cvt_pk_bf16_f32 v194, v68, v69
  v_exp_f32 v71, v71
  v_exp_f32 v72, v72
  v_cvt_pk_bf16_f32 v195, v70, v71
  v_exp_f32 v73, v73
  s_waitcnt lgkmcnt(0)
  v_mfma_f32_32x32x16_bf16 v[176:191], a[84:87], v[204:207], v[176:191]
  v_exp_f32 v74, v74
  v_cvt_pk_bf16_f32 v196, v72, v73
  v_exp_f32 v75, v75
  s_mov_b64 exec, s[90:91]
  ds_read_b128 a[72:75], v11 offset:9216
  ds_read_b128 a[76:79], v11 offset:9728
  s_mov_b64 exec, -1
  v_exp_f32 v76, v76
  v_cvt_pk_bf16_f32 v197, v74, v75
  v_exp_f32 v77, v77
  v_exp_f32 v78, v78
  v_cvt_pk_bf16_f32 v198, v76, v77
  v_exp_f32 v79, v79
  s_nop 0
  v_cvt_pk_bf16_f32 v199, v78, v79
  v_exp_f32 v80, v80
  v_exp_f32 v81, v81
  v_mfma_f32_32x32x16_bf16 v[64:79], a[24:27], v[224:227], v[128:143]
  v_exp_f32 v82, v82
  v_cvt_pk_bf16_f32 v200, v80, v81
  v_exp_f32 v83, v83
  v_exp_f32 v84, v84
  v_cvt_pk_bf16_f32 v201, v82, v83
  s_waitcnt lgkmcnt(1)
  v_mfma_f32_32x32x16_bf16 v[160:175], a[72:75], v[192:195], v[160:175]
  v_exp_f32 v85, v85
  v_exp_f32 v86, v86
  v_cvt_pk_bf16_f32 v202, v84, v85
  v_exp_f32 v87, v87
  v_exp_f32 v88, v88
  v_cvt_pk_bf16_f32 v203, v86, v87
  v_exp_f32 v89, v89
  s_waitcnt lgkmcnt(0)
  v_mfma_f32_32x32x16_bf16 v[160:175], a[76:79], v[196:199], v[160:175]
  v_exp_f32 v90, v90
  v_cvt_pk_bf16_f32 v204, v88, v89
  v_exp_f32 v91, v91
  s_mov_b64 exec, s[90:91]
  ds_read_b128 a[80:83], v11 offset:11264
  ds_read_b128 a[84:87], v11 offset:11776
  s_mov_b64 exec, -1
  v_exp_f32 v92, v92
  v_cvt_pk_bf16_f32 v205, v90, v91
  v_exp_f32 v93, v93
  v_exp_f32 v94, v94
  v_cvt_pk_bf16_f32 v206, v92, v93
  v_exp_f32 v95, v95
  s_nop 0
  v_cvt_pk_bf16_f32 v207, v94, v95
L_bk_103:
  s_cmp_gt_u32 s77, 3
  s_cbranch_scc1 L_sk_104
  v_exp_f32 v64, v64
  v_exp_f32 v65, v65
  v_mfma_f32_32x32x16_bf16 v[80:95], a[28:31], v[228:231], v[144:159]
  v_exp_f32 v66, v66
  v_cvt_pk_bf16_f32 v192, v64, v65
  v_exp_f32 v67, v67
  v_exp_f32 v68, v68
  v_cvt_pk_bf16_f32 v193, v66, v67
  s_waitcnt lgkmcnt(1)
  v_mfma_f32_32x32x16_bf16 v[176:191], a[80:83], v[200:203], v[176:191]
  v_exp_f32 v69, v69
  v_exp_f32 v70, v70
  v_cvt_pk_bf16_f32 v194, v68, v69
  v_exp_f32 v71, v71
  v_exp_f32 v72, v72
  v_cvt_pk_bf16_f32 v195, v70, v71
  v_exp_f32 v73, v73
  s_waitcnt lgkmcnt(0)
  v_mfma_f32_32x32x16_bf16 v[176:191], a[84:87], v[204:207], v[176:191]
  v_exp_f32 v74, v74
  v_cvt_pk_bf16_f32 v196, v72, v73
  v_exp_f32 v75, v75
  s_mov_b64 exec, s[90:91]
  ds_read_b128 a[72:75], v11 offset:13312
  ds_read_b128 a[76:79], v11 offset:13824
  s_mov_b64 exec, -1
  v_exp_f32 v76, v76
  v_cvt_pk_bf16_f32 v197, v74, v75
  v_exp_f32 v77, v77
  v_exp_f32 v78, v78
  v_cvt_pk_bf16_f32 v198, v76, v77
  v_exp_f32 v79, v79
  s_nop 0
  v_cvt_pk_bf16_f32 v199, v78, v79
  v_exp_f32 v80, v80
  v_exp_f32 v81, v81
  v_mfma_f32_32x32x16_bf16 v[64:79], a[32:35], v[224:227], v[128:143]
  v_exp_f32 v82, v82
  v_cvt_pk_bf16_f32 v200, v80, v81
  v_exp_f32 v83, v83
  v_exp_f32 v84, v84
  v_cvt_pk_bf16_f32 v201, v82, v83
  s_waitcnt lgkmcnt(1)
  v_mfma_f32_32x32x16_bf16 v[160:175], a[72:75], v[192:195], v[160:175]
  v_exp_f32 v85, v85
  v_exp_f32 v86, v86
  v_cvt_pk_bf16_f32 v202, v84, v85
  v_exp_f32 v87, v87
  v_exp_f32 v88, v88
  v_cvt_pk_bf16_f32 v203, v86, v87
  v_exp_f32 v89, v89
  s_waitcnt lgkmcnt(0)
  v_mfma_f32_32x32x16_bf16 v[160:175], a[76:79], v[196:199], v[160:175]
  v_exp_f32 v90, v90
  v_cvt_pk_bf16_f32 v204, v88, v89
  v_exp_f32 v91, v91
  s_mov_b64 exec, s[90:91]
  ds_read_b128 a[80:83], v11 offset:15360
  ds_read_b128 a[84:87], v11 offset:15872
  s_mov_b64 exec, -1
  v_exp_f32 v92, v92
  v_cvt_pk_bf16_f32 v205, v90, v91
  v_exp_f32 v93, v93
  v_exp_f32 v94, v94
  v_cvt_pk_bf16_f32 v206, v92, v93
  v_exp_f32 v95, v95
  s_nop 0
  v_cvt_pk_bf16_f32 v207, v94, v95
L_bk_105:
  s_cmp_gt_u32 s77, 4
  s_cbranch_scc1 L_sk_106
  v_exp_f32 v64, v64
  v_exp_f32 v65, v65
  v_mfma_f32_32x32x16_bf16 v[80:95], a[36:39], v[228:231], v[144:159]
  v_exp_f32 v66, v66
  v_cvt_pk_bf16_f32 v192, v64, v65
  v_exp_f32 v67, v67
  v_exp_f32 v68, v68
  v_cvt_pk_bf16_f32 v193, v66, v67
  s_waitcnt lgkmcnt(1)
  v_mfma_f32_32x32x16_bf16 v[176:191], a[80:83], v[200:203], v[176:191]
  v_exp_f32 v69, v69
  v_exp_f32 v70, v70
  v_cvt_pk_bf16_f32 v194, v68, v69
  v_exp_f32 v71, v71
  v_exp_f32 v72, v72
  v_cvt_pk_bf16_f32 v195, v70, v71
  v_exp_f32 v73, v73
  s_waitcnt lgkmcnt(0)
  v_mfma_f32_32x32x16_bf16 v[176:191], a[84:87], v[204:207], v[176:191]
  v_exp_f32 v74, v74
  v_cvt_pk_bf16_f32 v196, v72, v73
  v_exp_f32 v75, v75
  s_mov_b64 exec, s[90:91]
  ds_read_b128 a[72:75], v11 offset:17408
  ds_read_b128 a[76:79], v11 offset:17920
  s_mov_b64 exec, -1
  v_exp_f32 v76, v76
  v_cvt_pk_bf16_f32 v197, v74, v75
  v_exp_f32 v77, v77
  v_exp_f32 v78, v78
  v_cvt_pk_bf16_f32 v198, v76, v77
  v_exp_f32 v79, v79
  s_nop 0
  v_cvt_pk_bf16_f32 v199, v78, v79
  v_exp_f32 v80, v80
  v_exp_f32 v81, v81
  v_mfma_f32_32x32x16_bf16 v[64:79], a[40:43], v[224:227], v[128:143]
  v_exp_f32 v82, v82
  v_cvt_pk_bf16_f32 v200, v80, v81
  v_exp_f32 v83, v83
  v_exp_f32 v84, v84
  v_cvt_pk_bf16_f32 v201, v82, v83
  s_waitcnt lgkmcnt(1)
  v_mfma_f32_32x32x16_bf16 v[160:175], a[72:75], v[192:195], v[160:175]
  v_exp_f32 v85, v85
  v_exp_f32 v86, v86
  v_cvt_pk_bf16_f32 v202, v84, v85
  v_exp_f32 v87, v87
  v_exp_f32 v88, v88
  v_cvt_pk_bf16_f32 v203, v86, v87
  v_exp_f32 v89, v89
  s_waitcnt lgkmcnt(0)
  v_mfma_f32_32x32x16_bf16 v[160:175], a[76:79], v[196:199], v[160:175]
  v_exp_f32 v90, v90
  v_cvt_pk_bf16_f32 v204, v88, v89
  v_exp_f32 v91, v91
  s_mov_b64 exec, s[90:91]
  ds_read_b128 a[80:83], v11 offset:19456
  ds_read_b128 a[84:87], v11 offset:19968
  s_mov_b64 exec, -1
  v_exp_f32 v92, v92
  v_cvt_pk_bf16_f32 v205, v90, v91
  v_exp_f32 v93, v93
  v_exp_f32 v94, v94
  v_cvt_pk_bf16_f32 v206, v92, v93
  v_exp_f32 v95, v95
  s_nop 0
  v_cvt_pk_bf16_f32 v207, v94, v95
L_bk_107:
  s_cmp_gt_u32 s77, 5
  s_cbranch_scc1 L_sk_108
  v_exp_f32 v64, v64
  v_exp_f32 v65, v65
  v_mfma_f32_32x32x16_bf16 v[80:95], a[44:47], v[228:231], v[144:159]
  v_exp_f32 v66, v66
  v_cvt_pk_bf16_f32 v192, v64, v65
  v_exp_f32 v67, v67
  v_exp_f32 v68, v68
  v_cvt_pk_bf16_f32 v193, v66, v67
  s_waitcnt lgkmcnt(1)
  v_mfma_f32_32x32x16_bf16 v[176:191], a[80:83], v[200:203], v[176:191]
  v_exp_f32 v69, v69
  v_exp_f32 v70, v70
  v_cvt_pk_bf16_f32 v194, v68, v69
  v_exp_f32 v71, v71
  v_exp_f32 v72, v72
  v_cvt_pk_bf16_f32 v195, v70, v71
  v_exp_f32 v73, v73
  s_waitcnt lgkmcnt(0)
  v_mfma_f32_32x32x16_bf16 v[176:191], a[84:87], v[204:207], v[176:191]
  v_exp_f32 v74, v74
  v_cvt_pk_bf16_f32 v196, v72, v73
  v_exp_f32 v75, v75
  s_mov_b64 exec, s[90:91]
  ds_read_b128 a[72:75], v11 offset:21504
  ds_read_b128 a[76:79], v11 offset:22016
  s_mov_b64 exec, -1
  v_exp_f32 v76, v76
  v_cvt_pk_bf16_f32 v197, v74, v75
  v_exp_f32 v77, v77
  v_exp_f32 v78, v78
  v_cvt_pk_bf16_f32 v198, v76, v77
  v_exp_f32 v79, v79
  s_nop 0
  v_cvt_pk_bf16_f32 v199, v78, v79
  v_exp_f32 v80, v80
  v_exp_f32 v81, v81
  v_mfma_f32_32x32x16_bf16 v[64:79], a[48:51], v[224:227], v[128:143]
  v_exp_f32 v82, v82
  v_cvt_pk_bf16_f32 v200, v80, v81
  v_exp_f32 v83, v83
  v_exp_f32 v84, v84
  v_cvt_pk_bf16_f32 v201, v82, v83
  s_waitcnt lgkmcnt(1)
  v_mfma_f32_32x32x16_bf16 v[160:175], a[72:75], v[192:195], v[160:175]
  v_exp_f32 v85, v85
  v_exp_f32 v86, v86
  v_cvt_pk_bf16_f32 v202, v84, v85
  v_exp_f32 v87, v87
  v_exp_f32 v88, v88
  v_cvt_pk_bf16_f32 v203, v86, v87
  v_exp_f32 v89, v89
  s_waitcnt lgkmcnt(0)
  v_mfma_f32_32x32x16_bf16 v[160:175], a[76:79], v[196:199], v[160:175]
  v_exp_f32 v90, v90
  v_cvt_pk_bf16_f32 v204, v88, v89
  v_exp_f32 v91, v91
  s_mov_b64 exec, s[90:91]
  ds_read_b128 a[80:83], v11 offset:23552
  ds_read_b128 a[84:87], v11 offset:24064
  s_mov_b64 exec, -1
  v_exp_f32 v92, v92
  v_cvt_pk_bf16_f32 v205, v90, v91
  v_exp_f32 v93, v93
  v_exp_f32 v94, v94
  v_cvt_pk_bf16_f32 v206, v92, v93
  v_exp_f32 v95, v95
  s_nop 0
  v_cvt_pk_bf16_f32 v207, v94, v95
L_bk_109:
  s_cmp_gt_u32 s77, 6
  s_cbranch_scc1 L_sk_110
  v_exp_f32 v64, v64
  v_exp_f32 v65, v65
  v_mfma_f32_32x32x16_bf16 v[80:95], a[52:55], v[228:231], v[144:159]
  v_exp_f32 v66, v66
  v_cvt_pk_bf16_f32 v192, v64, v65
  v_exp_f32 v67, v67
  v_exp_f32 v68, v68
  v_cvt_pk_bf16_f32 v193, v66, v67
  s_waitcnt lgkmcnt(1)
  v_mfma_f32_32x32x16_bf16 v[176:191], a[80:83], v[200:203], v[176:191]
  v_exp_f32 v69, v69
  v_exp_f32 v70, v70
  v_cvt_pk_bf16_f32 v194, v68, v69
  v_exp_f32 v71, v71
  v_exp_f32 v72, v72
  v_cvt_pk_bf16_f32 v195, v70, v71
  v_exp_f32 v73, v73
  s_waitcnt lgkmcnt(0)
  v_mfma_f32_32x32x16_bf16 v[176:191], a[84:87], v[204:207], v[176:191]
  v_exp_f32 v74, v74
  v_cvt_pk_bf16_f32 v196, v72, v73
  v_exp_f32 v75, v75
  s_mov_b64 exec, s[90:91]
  ds_read_b128 a[72:75], v11 offset:25600
  ds_read_b128 a[76:79], v11 offset:26112
  s_mov_b64 exec, -1
  v_exp_f32 v76, v76
  v_cvt_pk_bf16_f32 v197, v74, v75
  v_exp_f32 v77, v77
  v_exp_f32 v78, v78
  v_cvt_pk_bf16_f32 v198, v76, v77
  v_exp_f32 v79, v79
  s_nop 0
  v_cvt_pk_bf16_f32 v199, v78, v79
  v_exp_f32 v80, v80
  v_exp_f32 v81, v81
  v_mfma_f32_32x32x16_bf16 v[64:79], a[56:59], v[224:227], v[128:143]
  v_exp_f32 v82, v82
  v_cvt_pk_bf16_f32 v200, v80, v81
  v_exp_f32 v83, v83
  v_exp_f32 v84, v84
  v_cvt_pk_bf16_f32 v201, v82, v83
  s_waitcnt lgkmcnt(1)
  v_mfma_f32_32x32x16_bf16 v[160:175], a[72:75], v[192:195], v[160:175]
  v_exp_f32 v85, v85
  v_exp_f32 v86, v86
  v_cvt_pk_bf16_f32 v202, v84, v85
  v_exp_f32 v87, v87
  v_exp_f32 v88, v88
  v_cvt_pk_bf16_f32 v203, v86, v87
  v_exp_f32 v89, v89
  s_waitcnt lgkmcnt(0)
  v_mfma_f32_32x32x16_bf16 v[160:175], a[76:79], v[196:199], v[160:175]
  v_exp_f32 v90, v90
  v_cvt_pk_bf16_f32 v204, v88, v89
  v_exp_f32 v91, v91
  s_mov_b64 exec, s[90:91]
  ds_read_b128 a[80:83], v11 offset:27648
  ds_read_b128 a[84:87], v11 offset:28160
  s_mov_b64 exec, -1
  v_exp_f32 v92, v92
  v_cvt_pk_bf16_f32 v205, v90, v91
  v_exp_f32 v93, v93
  v_exp_f32 v94, v94
  v_cvt_pk_bf16_f32 v206, v92, v93
  v_exp_f32 v95, v95
  s_nop 0
  v_cvt_pk_bf16_f32 v207, v94, v95
L_bk_111:
  s_cmp_gt_u32 s77, 7
  s_cbranch_scc1 L_sk_112
  v_exp_f32 v64, v64
  v_exp_f32 v65, v65
  v_mfma_f32_32x32x16_bf16 v[80:95], a[60:63], v[228:231], v[144:159]
  v_exp_f32 v66, v66
  v_cvt_pk_bf16_f32 v192, v64, v65
  v_exp_f32 v67, v67
  v_exp_f32 v68, v68
  v_cvt_pk_bf16_f32 v193, v66, v67
  s_waitcnt lgkmcnt(1)
  v_mfma_f32_32x32x16_bf16 v[176:191], a[80:83], v[200:203], v[176:191]
  v_exp_f32 v69, v69
  v_exp_f32 v70, v70
  v_cvt_pk_bf16_f32 v194, v68, v69
  v_exp_f32 v71, v71
  v_exp_f32 v72, v72
  v_cvt_pk_bf16_f32 v195, v70, v71
  v_exp_f32 v73, v73
  s_waitcnt lgkmcnt(0)
  v_mfma_f32_32x32x16_bf16 v[176:191], a[84:87], v[204:207], v[176:191]
  v_exp_f32 v74, v74
  v_cvt_pk_bf16_f32 v196, v72, v73
  v_exp_f32 v75, v75
  s_mov_b64 exec, s[90:91]
  ds_read_b128 a[72:75], v11 offset:29696
  ds_read_b128 a[76:79], v11 offset:30208
  s_mov_b64 exec, -1
  v_exp_f32 v76, v76
  v_cvt_pk_bf16_f32 v197, v74, v75
  v_exp_f32 v77, v77
  v_exp_f32 v78, v78
  v_cvt_pk_bf16_f32 v198, v76, v77
  v_exp_f32 v79, v79
  s_nop 0
  v_cvt_pk_bf16_f32 v199, v78, v79
  v_exp_f32 v80, v80
  v_exp_f32 v81, v81
  v_mfma_f32_32x32x16_bf16 v[64:79], a[64:67], v[224:227], v[128:143]
  v_exp_f32 v82, v82
  v_cvt_pk_bf16_f32 v200, v80, v81
  v_exp_f32 v83, v83
  v_exp_f32 v84, v84
  v_cvt_pk_bf16_f32 v201, v82, v83
  s_waitcnt lgkmcnt(1)
  v_mfma_f32_32x32x16_bf16 v[160:175], a[72:75], v[192:195], v[160:175]
  v_exp_f32 v85, v85
  v_exp_f32 v86, v86
  v_cvt_pk_bf16_f32 v202, v84, v85
  v_exp_f32 v87, v87
  v_exp_f32 v88, v88
  v_cvt_pk_bf16_f32 v203, v86, v87
  v_exp_f32 v89, v89
  s_waitcnt lgkmcnt(0)
  v_mfma_f32_32x32x16_bf16 v[160:175], a[76:79], v[196:199], v[160:175]
  v_exp_f32 v90, v90
  v_cvt_pk_bf16_f32 v204, v88, v89
  v_exp_f32 v91, v91
  s_mov_b64 exec, s[90:91]
  ds_read_b128 a[80:83], v11 offset:31744
  ds_read_b128 a[84:87], v11 offset:32256
  s_mov_b64 exec, -1
  v_exp_f32 v92, v92
  v_cvt_pk_bf16_f32 v205, v90, v91
  v_exp_f32 v93, v93
  v_exp_f32 v94, v94
  v_cvt_pk_bf16_f32 v206, v92, v93
  v_exp_f32 v95, v95
  s_nop 0
  v_cvt_pk_bf16_f32 v207, v94, v95
L_bk_113:
  v_exp_f32 v64, v64
  v_exp_f32 v65, v65
  v_mfma_f32_32x32x16_bf16 v[80:95], a[68:71], v[228:231], v[144:159]
  v_exp_f32 v66, v66
  v_cvt_pk_bf16_f32 v192, v64, v65
  v_exp_f32 v67, v67
  v_exp_f32 v68, v68
  v_cvt_pk_bf16_f32 v193, v66, v67
  s_waitcnt lgkmcnt(1)
  v_mfma_f32_32x32x16_bf16 v[176:191], a[80:83], v[200:203], v[176:191]
  v_exp_f32 v69, v69
  v_exp_f32 v70, v70
  v_cvt_pk_bf16_f32 v194, v68, v69
  v_exp_f32 v71, v71
  v_exp_f32 v72, v72
  v_cvt_pk_bf16_f32 v195, v70, v71
  v_exp_f32 v73, v73
  s_waitcnt lgkmcnt(0)
  v_mfma_f32_32x32x16_bf16 v[176:191], a[84:87], v[204:207], v[176:191]
  v_exp_f32 v74, v74
  v_cvt_pk_bf16_f32 v196, v72, v73
  v_exp_f32 v75, v75
  s_mov_b64 exec, s[90:91]
  ds_read_b128 a[72:75], v11 offset:33792
  ds_read_b128 a[76:79], v11 offset:34304
  s_mov_b64 exec, -1
  v_exp_f32 v76, v76
  v_cvt_pk_bf16_f32 v197, v74, v75
  v_exp_f32 v77, v77
  v_exp_f32 v78, v78
  v_cvt_pk_bf16_f32 v198, v76, v77
  v_exp_f32 v79, v79
  s_nop 0
  v_cvt_pk_bf16_f32 v199, v78, v79
  v_and_b32 v192, v32, v192
  v_and_b32 v193, v33, v193
  v_and_b32 v194, v34, v194
  v_and_b32 v195, v35, v195
  v_and_b32 v196, v36, v196
  v_and_b32 v197, v37, v197
  v_and_b32 v198, v38, v198
  v_and_b32 v199, v39, v199
  v_exp_f32 v80, v80
  v_exp_f32 v81, v81
  v_exp_f32 v82, v82
  v_cvt_pk_bf16_f32 v200, v80, v81
  v_exp_f32 v83, v83
  v_exp_f32 v84, v84
  v_cvt_pk_bf16_f32 v201, v82, v83
  s_waitcnt lgkmcnt(1)
  v_mfma_f32_32x32x16_bf16 v[160:175], a[72:75], v[192:195], v[160:175]
  v_exp_f32 v85, v85
  v_exp_f32 v86, v86
  v_cvt_pk_bf16_f32 v202, v84, v85
  v_exp_f32 v87, v87
  v_exp_f32 v88, v88
  v_cvt_pk_bf16_f32 v203, v86, v87
  v_exp_f32 v89, v89
  s_waitcnt lgkmcnt(0)
  v_mfma_f32_32x32x16_bf16 v[160:175], a[76:79], v[196:199], v[160:175]
  v_exp_f32 v90, v90
  v_cvt_pk_bf16_f32 v204, v88, v89
  v_exp_f32 v91, v91
  s_mov_b64 exec, s[90:91]
  ds_read_b128 a[80:83], v11 offset:35840
  ds_read_b128 a[84:87], v11 offset:36352
  s_mov_b64 exec, -1
  v_exp_f32 v92, v92
  v_cvt_pk_bf16_f32 v205, v90, v91
  v_exp_f32 v93, v93
  v_exp_f32 v94, v94
  v_cvt_pk_bf16_f32 v206, v92, v93
  v_exp_f32 v95, v95
  s_nop 0
  v_cvt_pk_bf16_f32 v207, v94, v95
  v_and_b32 v200, v32, v200
  v_and_b32 v201, v33, v201
  v_and_b32 v202, v34, v202
  v_and_b32 v203, v35, v203
  v_and_b32 v204, v36, v204
  v_and_b32 v205, v37, v205
  v_and_b32 v206, v38, v206
  v_and_b32 v207, v39, v207
  s_waitcnt lgkmcnt(1)
  v_mfma_f32_32x32x16_bf16 v[176:191], a[80:83], v[200:203], v[176:191]
  s_waitcnt lgkmcnt(0)
  v_mfma_f32_32x32x16_bf16 v[176:191], a[84:87], v[204:207], v[176:191]
  v_rcp_f32 v52, v168
  s_nop 0
  v_mul_f32 v160, v52, v160
  v_mul_f32 v161, v52, v161
  v_mul_f32 v162, v52, v162
  v_mul_f32 v163, v52, v163
  v_mul_f32 v164, v52, v164
  v_mul_f32 v165, v52, v165
  v_mul_f32 v166, v52, v166
  v_mul_f32 v167, v52, v167
  v_cvt_pk_bf16_f32 v160, v160, v161
  v_cvt_pk_bf16_f32 v161, v162, v163
  v_cvt_pk_bf16_f32 v162, v164, v165
  v_cvt_pk_bf16_f32 v163, v166, v167
  v_rcp_f32 v52, v184
  s_nop 0
  v_mul_f32 v176, v52, v176
  v_mul_f32 v177, v52, v177
  v_mul_f32 v178, v52, v178
  v_mul_f32 v179, v52, v179
  v_mul_f32 v180, v52, v180
  v_mul_f32 v181, v52, v181
  v_mul_f32 v182, v52, v182
  v_mul_f32 v183, v52, v183
  v_cvt_pk_bf16_f32 v176, v176, v177
  v_cvt_pk_bf16_f32 v177, v178, v179
  v_cvt_pk_bf16_f32 v178, v180, v181
  v_cvt_pk_bf16_f32 v179, v182, v183
  s_cmp_eq_u32 s0, 0
  s_cbranch_scc1 L_slow_114
  buffer_store_dwordx4 v[160:163], v20, s[16:19], s89 offen offset:0
  buffer_store_dwordx4 v[176:179], v20, s[16:19], s89 offen offset:512
  s_branch L_dj_115
L_slow_114:
  buffer_store_dwordx4 v[160:163], v20, s[16:19], s89 offen offset:0 sc1
  buffer_store_dwordx4 v[176:179], v20, s[16:19], s89 offen offset:512 sc1
L_dj_115:
  s_barrier
  s_waitcnt vmcnt(0)
  s_barrier
  s_cmp_eq_u32 s60, 0
  s_cbranch_scc0 L_pub_116
  s_lshl_b32 s70, s61, 8
  s_add_u32 s70, s70, s2
  s_lshl_b32 s70, s70, 7
  s_add_u32 s70, s70, 69632
  v_mov_b32 v4, s62
  v_mov_b32 v5, s63
  v_mov_b32 v6, s70
  s_mov_b64 exec, 1
  s_cmp_eq_u32 s0, 0
  s_cbranch_scc1 L_slow_117
  buffer_store_dwordx2 v[4:5], v6, s[16:19], 0 offen
  s_branch L_dj_118
L_slow_117:
  buffer_store_dwordx2 v[4:5], v6, s[16:19], 0 offen sc1
L_dj_118:
  s_mov_b64 exec, -1
L_pub_116:
  v_mov_b32 v8, s58
  v_and_b32 v9, 3, v8
  v_lshlrev_b32 v9, 3, v9
  v_add_u32 v9, v1, v9
  v_lshlrev_b32 v9, 3, v9
  v_lshrrev_b32 v7, 2, v8
  v_add_u32 v9, v9, v7
  s_lshl_b32 s70, s61, 15
  s_add_u32 s70, s70, 69632
  v_lshlrev_b32 v9, 7, v9
  v_add_u32 v9, s70, v9
  s_mov_b32 s76, 0xff
  s_mov_b32 s77, 0
  v_lshrrev_b32 v3, 5, v1
  v_lshlrev_b32 v3, 4, v3
  v_bfe_u32 v4, v1, 4, 1
  v_lshl_add_u32 v3, v4, 2, v3
  v_bfe_u32 v5, v1, 2, 2
  v_add_u32 v3, v3, v5
  v_bfe_u32 v5, v3, 1, 2
  v_and_b32 v6, 3, v1
  v_lshlrev_b32 v6, 3, v6
  v_lshl_add_u32 v6, v3, 7, v6
  v_xor_b32 v7, 0, v5
  v_lshl_add_u32 v10, v7, 5, v6
  v_xor_b32 v7, 1, v5
  v_lshl_add_u32 v11, v7, 5, v6
  v_xor_b32 v7, 2, v5
  v_lshl_add_u32 v12, v7, 5, v6
  v_xor_b32 v7, 3, v5
  v_lshl_add_u32 v13, v7, 5, v6
  ds_read_b64_tr_b16 v[128:129], v10 offset:0
  ds_read_b64_tr_b16 v[130:131], v10 offset:1024
  ds_read_b64_tr_b16 v[132:133], v11 offset:0
  ds_read_b64_tr_b16 v[134:135], v11 offset:1024
  ds_read_b64_tr_b16 v[136:137], v12 offset:0
  ds_read_b64_tr_b16 v[138:139], v12 offset:1024
  ds_read_b64_tr_b16 v[140:141], v13 offset:0
  ds_read_b64_tr_b16 v[142:143], v13 offset:1024
  ds_read_b64_tr_b16 v[144:145], v10 offset:4096
  ds_read_b64_tr_b16 v[146:147], v10 offset:5120
  ds_read_b64_tr_b16 v[148:149], v11 offset:4096
  ds_read_b64_tr_b16 v[150:151], v11 offset:5120
  ds_read_b64_tr_b16 v[152:153], v12 offset:4096
  ds_read_b64_tr_b16 v[154:155], v12 offset:5120
  ds_read_b64_tr_b16 v[156:157], v13 offset:4096
  ds_read_b64_tr_b16 v[158:159], v13 offset:5120
  ds_read_b64_tr_b16 v[160:161], v10 offset:8192
  ds_read_b64_tr_b16 v[162:163], v10 offset:9216
  ds_read_b64_tr_b16 v[164:165], v11 offset:8192
  ds_read_b64_tr_b16 v[166:167], v11 offset:9216
  ds_read_b64_tr_b16 v[168:169], v12 offset:8192
  ds_read_b64_tr_b16 v[170:171], v12 offset:9216
  ds_read_b64_tr_b16 v[172:173], v13 offset:8192
  ds_read_b64_tr_b16 v[174:175], v13 offset:9216
  ds_read_b64_tr_b16 v[176:177], v10 offset:12288
  ds_read_b64_tr_b16 v[178:179], v10 offset:13312
  ds_read_b64_tr_b16 v[180:181], v11 offset:12288
  ds_read_b64_tr_b16 v[182:183], v11 offset:13312
  ds_read_b64_tr_b16 v[184:185], v12 offset:12288
  ds_read_b64_tr_b16 v[186:187], v12 offset:13312
  ds_read_b64_tr_b16 v[188:189], v13 offset:12288
  ds_read_b64_tr_b16 v[190:191], v13 offset:13312
  ds_read_b64_tr_b16 v[192:193], v10 offset:16384
  ds_read_b64_tr_b16 v[194:195], v10 offset:17408
  ds_read_b64_tr_b16 v[196:197], v11 offset:16384
  ds_read_b64_tr_b16 v[198:199], v11 offset:17408
  ds_read_b64_tr_b16 v[200:201], v12 offset:16384
  ds_read_b64_tr_b16 v[202:203], v12 offset:17408
  ds_read_b64_tr_b16 v[204:205], v13 offset:16384
  ds_read_b64_tr_b16 v[206:207], v13 offset:17408
  ds_read_b64_tr_b16 v[208:209], v10 offset:20480
  ds_read_b64_tr_b16 v[210:211], v10 offset:21504
  ds_read_b64_tr_b16 v[212:213], v11 offset:20480
  ds_read_b64_tr_b16 v[214:215], v11 offset:21504
  ds_read_b64_tr_b16 v[216:217], v12 offset:20480
  ds_read_b64_tr_b16 v[218:219], v12 offset:21504
  ds_read_b64_tr_b16 v[220:221], v13 offset:20480
  ds_read_b64_tr_b16 v[222:223], v13 offset:21504
  ds_read_b64_tr_b16 v[224:225], v10 offset:24576
  ds_read_b64_tr_b16 v[226:227], v10 offset:25600
  ds_read_b64_tr_b16 v[228:229], v11 offset:24576
  ds_read_b64_tr_b16 v[230:231], v11 offset:25600
  ds_read_b64_tr_b16 v[232:233], v12 offset:24576
  ds_read_b64_tr_b16 v[234:235], v12 offset:25600
  ds_read_b64_tr_b16 v[236:237], v13 offset:24576
  ds_read_b64_tr_b16 v[238:239], v13 offset:25600
  ds_read_b64_tr_b16 v[240:241], v10 offset:28672
  ds_read_b64_tr_b16 v[242:243], v10 offset:29696
  ds_read_b64_tr_b16 v[244:245], v11 offset:28672
  ds_read_b64_tr_b16 v[246:247], v11 offset:29696
  ds_read_b64_tr_b16 v[248:249], v12 offset:28672
  ds_read_b64_tr_b16 v[250:251], v12 offset:29696
  ds_read_b64_tr_b16 v[252:253], v13 offset:28672
  ds_read_b64_tr_b16 v[254:255], v13 offset:29696
  s_mov_b64 exec, s[76:77]
  s_mov_b32 s100, 0
  s_cbranch_execz L_pok_120
L_poll_119:
  buffer_load_dwordx2 v[4:5], v9, s[16:19], 0 offen sc1
  s_waitcnt vmcnt(0)
  v_cmp_ne_u64 vcc, s[62:63], v[4:5]
  s_nop 0
  s_cbranch_vccz L_pok_120
  s_add_u32 s100, s100, 1
  s_cmp_lt_u32 s100, 400000
  s_cbranch_scc1 L_poll_119
  s_branch L_fail
L_pok_120:
  s_mov_b64 exec, -1
  s_waitcnt vmcnt(0) lgkmcnt(0)
  s_lshl_b32 s72, s58, 2
  s_add_u32 s72, s72, s60
  s_lshl_b32 s72, s72, 14
  s_lshl_b32 s73, s61, 21
  s_add_u32 s72, s72, s73
  s_add_u32 s74, s72, 9437184
  s_add_u32 s73, s74, 0
  buffer_load_dwordx4 v[64:67], v2, s[16:19], s73 offen offset:0 sc1
  buffer_load_dwordx4 v[68:71], v2, s[16:19], s73 offen offset:1024 sc1
  buffer_load_dwordx4 v[72:75], v2, s[16:19], s73 offen offset:2048 sc1
  buffer_load_dwordx4 v[76:79], v2, s[16:19], s73 offen offset:3072 sc1
  s_add_u32 s73, s74, 4096
  buffer_load_dwordx4 v[80:83], v2, s[16:19], s73 offen offset:0 sc1
  buffer_load_dwordx4 v[84:87], v2, s[16:19], s73 offen offset:1024 sc1
  buffer_load_dwordx4 v[88:91], v2, s[16:19], s73 offen offset:2048 sc1
  buffer_load_dwordx4 v[92:95], v2, s[16:19], s73 offen offset:3072 sc1
  s_add_u32 s73, s74, 8192
  buffer_load_dwordx4 v[96:99], v2, s[16:19], s73 offen offset:0 sc1
  buffer_load_dwordx4 v[100:103], v2, s[16:19], s73 offen offset:1024 sc1
  buffer_load_dwordx4 v[104:107], v2, s[16:19], s73 offen offset:2048 sc1
  s_cmp_eq_u32 s66, 0
  s_cbranch_scc1 L_oa_121
  s_lshl_b32 s76, s65, 6
  s_lshl_b32 s77, s60, 4
  s_add_u32 s76, s76, s77
  s_mul_i32 s76, s76, 3072
  s_add_u32 s76, s76, 24117248
  s_add_u32 s73, s74, 8192
  buffer_load_dwordx4 v[108:111], v2, s[16:19], s73 offen offset:3072 sc1
  s_waitcnt vmcnt(11)
  v_mfma_f32_16x16x32_bf16 v[46:49], v[128:131], v[64:67], 0
  v_mfma_f32_16x16x32_bf16 v[50:53], v[132:135], v[64:67], 0
  v_mfma_f32_16x16x32_bf16 v[54:57], v[136:139], v[64:67], 0
  v_mfma_f32_16x16x32_bf16 v[58:61], v[140:143], v[64:67], 0
  s_add_u32 s73, s74, 12288
  buffer_load_dwordx4 v[112:115], v2, s[16:19], s73 offen offset:0 sc1
  s_waitcnt vmcnt(11)
  v_mfma_f32_16x16x32_bf16 v[46:49], v[144:147], v[68:71], v[46:49]
  v_mfma_f32_16x16x32_bf16 v[50:53], v[148:151], v[68:71], v[50:53]
  v_mfma_f32_16x16x32_bf16 v[54:57], v[152:155], v[68:71], v[54:57]
  v_mfma_f32_16x16x32_bf16 v[58:61], v[156:159], v[68:71], v[58:61]
  buffer_load_dwordx4 v[116:119], v2, s[16:19], s73 offen offset:1024 sc1
  s_waitcnt vmcnt(11)
  v_mfma_f32_16x16x32_bf16 v[46:49], v[160:163], v[72:75], v[46:49]
  v_mfma_f32_16x16x32_bf16 v[50:53], v[164:167], v[72:75], v[50:53]
  v_mfma_f32_16x16x32_bf16 v[54:57], v[168:171], v[72:75], v[54:57]
  v_mfma_f32_16x16x32_bf16 v[58:61], v[172:175], v[72:75], v[58:61]
  buffer_load_dwordx4 v[120:123], v2, s[16:19], s73 offen offset:2048 sc1
  s_waitcnt vmcnt(11)
  v_mfma_f32_16x16x32_bf16 v[46:49], v[176:179], v[76:79], v[46:49]
  v_mfma_f32_16x16x32_bf16 v[50:53], v[180:183], v[76:79], v[50:53]
  v_mfma_f32_16x16x32_bf16 v[54:57], v[184:187], v[76:79], v[54:57]
  v_mfma_f32_16x16x32_bf16 v[58:61], v[188:191], v[76:79], v[58:61]
  buffer_load_dwordx4 v[124:127], v2, s[16:19], s73 offen offset:3072 sc1
  s_waitcnt vmcnt(11)
  v_mfma_f32_16x16x32_bf16 v[46:49], v[192:195], v[80:83], v[46:49]
  v_mfma_f32_16x16x32_bf16 v[50:53], v[196:199], v[80:83], v[50:53]
  s_add_u32 s77, s76, 0
  buffer_load_dwordx4 a[0:3], v2, s[16:19], s77 offen offset:0 sc1
  s_add_u32 s77, s76, 0
  buffer_load_dwordx4 a[4:7], v2, s[16:19], s77 offen offset:1024 sc1
  v_mfma_f32_16x16x32_bf16 v[54:57], v[200:203], v[80:83], v[54:57]
  v_mfma_f32_16x16x32_bf16 v[58:61], v[204:207], v[80:83], v[58:61]
  s_waitcnt vmcnt(12)
  v_mfma_f32_16x16x32_bf16 v[46:49], v[208:211], v[84:87], v[46:49]
  v_mfma_f32_16x16x32_bf16 v[50:53], v[212:215], v[84:87], v[50:53]
  s_add_u32 s77, s76, 0
  buffer_load_dwordx4 a[8:11], v2, s[16:19], s77 offen offset:2048 sc1
  s_add_u32 s77, s76, 3072
  buffer_load_dwordx4 a[12:15], v2, s[16:19], s77 offen offset:0 sc1
  v_mfma_f32_16x16x32_bf16 v[54:57], v[216:219], v[84:87], v[54:57]
  v_mfma_f32_16x16x32_bf16 v[58:61], v[220:223], v[84:87], v[58:61]
  s_waitcnt vmcnt(13)
  v_mfma_f32_16x16x32_bf16 v[46:49], v[224:227], v[88:91], v[46:49]
  ds_read_b64_tr_b16 v[14:15], v10 offset:32768
  ds_read_b64_tr_b16 v[16:17], v10 offset:33792
  v_mfma_f32_16x16x32_bf16 v[50:53], v[228:231], v[88:91], v[50:53]
  ds_read_b64_tr_b16 v[18:19], v11 offset:32768
  ds_read_b64_tr_b16 v[20:21], v11 offset:33792
  s_add_u32 s77, s76, 3072
  buffer_load_dwordx4 a[16:19], v2, s[16:19], s77 offen offset:1024 sc1
  s_add_u32 s77, s76, 3072
  buffer_load_dwordx4 a[20:23], v2, s[16:19], s77 offen offset:2048 sc1
  v_mfma_f32_16x16x32_bf16 v[54:57], v[232:235], v[88:91], v[54:57]
  ds_read_b64_tr_b16 v[22:23], v12 offset:32768
  ds_read_b64_tr_b16 v[24:25], v12 offset:33792
  v_mfma_f32_16x16x32_bf16 v[58:61], v[236:239], v[88:91], v[58:61]
  ds_read_b64_tr_b16 v[26:27], v13 offset:32768
  ds_read_b64_tr_b16 v[28:29], v13 offset:33792
  s_waitcnt vmcnt(14)
  v_mfma_f32_16x16x32_bf16 v[46:49], v[240:243], v[92:95], v[46:49]
  ds_read_b64_tr_b16 v[30:31], v10 offset:36864
  ds_read_b64_tr_b16 v[32:33], v10 offset:37888
  v_mfma_f32_16x16x32_bf16 v[50:53], v[244:247], v[92:95], v[50:53]
  ds_read_b64_tr_b16 v[34:35], v11 offset:36864
  ds_read_b64_tr_b16 v[36:37], v11 offset:37888
  s_add_u32 s77, s76, 6144
  buffer_load_dwordx4 a[24:27], v2, s[16:19], s77 offen offset:0 sc1
  s_add_u32 s77, s76, 6144
  buffer_load_dwordx4 a[28:31], v2, s[16:19], s77 offen offset:1024 sc1
  v_mfma_f32_16x16x32_bf16 v[54:57], v[248:251], v[92:95], v[54:57]
  ds_read_b64_tr_b16 v[38:39], v12 offset:36864
  ds_read_b64_tr_b16 v[40:41], v12 offset:37888
  v_mfma_f32_16x16x32_bf16 v[58:61], v[252:255], v[92:95], v[58:61]
  ds_read_b64_tr_b16 v[42:43], v13 offset:36864
  ds_read_b64_tr_b16 v[44:45], v13 offset:37888
  s_waitcnt vmcnt(15) lgkmcnt(14)
  v_mfma_f32_16x16x32_bf16 v[46:49], v[14:17], v[96:99], v[46:49]
  ds_read_b64_tr_b16 v[14:15], v10 offset:40960
  ds_read_b64_tr_b16 v[16:17], v10 offset:41984
  s_waitcnt lgkmcnt(14)
  v_mfma_f32_16x16x32_bf16 v[50:53], v[18:21], v[96:99], v[50:53]
  ds_read_b64_tr_b16 v[18:19], v11 offset:40960
  ds_read_b64_tr_b16 v[20:21], v11 offset:41984
  s_add_u32 s77, s76, 6144
  buffer_load_dwordx4 a[32:35], v2, s[16:19], s77 offen offset:2048 sc1
  s_add_u32 s77, s76, 9216
  buffer_load_dwordx4 a[36:39], v2, s[16:19], s77 offen offset:0 sc1
  s_waitcnt lgkmcnt(14)
  v_mfma_f32_16x16x32_bf16 v[54:57], v[22:25], v[96:99], v[54:57]
  ds_read_b64_tr_b16 v[22:23], v12 offset:40960
  ds_read_b64_tr_b16 v[24:25], v12 offset:41984
  s_waitcnt lgkmcnt(14)
  v_mfma_f32_16x16x32_bf16 v[58:61], v[26:29], v[96:99], v[58:61]
  ds_read_b64_tr_b16 v[26:27], v13 offset:40960
  ds_read_b64_tr_b16 v[28:29], v13 offset:41984
  s_waitcnt vmcnt(16) lgkmcnt(14)
  v_mfma_f32_16x16x32_bf16 v[46:49], v[30:33], v[100:103], v[46:49]
  ds_read_b64_tr_b16 v[30:31], v10 offset:45056
  ds_read_b64_tr_b16 v[32:33], v10 offset:46080
  s_waitcnt lgkmcnt(14)
  v_mfma_f32_16x16x32_bf16 v[50:53], v[34:37], v[100:103], v[50:53]
  ds_read_b64_tr_b16 v[34:35], v11 offset:45056
  ds_read_b64_tr_b16 v[36:37], v11 offset:46080
  s_add_u32 s77, s76, 9216
  buffer_load_dwordx4 a[40:43], v2, s[16:19], s77 offen offset:1024 sc1
  s_add_u32 s77, s76, 9216
  buffer_load_dwordx4 a[44:47], v2, s[16:19], s77 offen offset:2048 sc1
  s_waitcnt lgkmcnt(14)
  v_mfma_f32_16x16x32_bf16 v[54:57], v[38:41], v[100:103], v[54:57]
  ds_read_b64_tr_b16 v[38:39], v12 offset:45056
  ds_read_b64_tr_b16 v[40:41], v12 offset:46080
  s_waitcnt lgkmcnt(14)
  v_mfma_f32_16x16x32_bf16 v[58:61], v[42:45], v[100:103], v[58:61]
  ds_read_b64_tr_b16 v[42:43], v13 offset:45056
  ds_read_b64_tr_b16 v[44:45], v13 offset:46080
  s_waitcnt vmcnt(17) lgkmcnt(14)
  v_mfma_f32_16x16x32_bf16 v[46:49], v[14:17], v[104:107], v[46:49]
  ds_read_b64_tr_b16 v[14:15], v10 offset:49152
  ds_read_b64_tr_b16 v[16:17], v10 offset:50176
  s_waitcnt lgkmcnt(14)
  v_mfma_f32_16x16x32_bf16 v[50:53], v[18:21], v[104:107], v[50:53]
  ds_read_b64_tr_b16 v[18:19], v11 offset:49152
  ds_read_b64_tr_b16 v[20:21], v11 offset:50176
  s_add_u32 s77, s76, 12288
  buffer_load_dwordx4 a[48:51], v2, s[16:19], s77 offen offset:0 sc1
  s_add_u32 s77, s76, 12288
  buffer_load_dwordx4 a[52:55], v2, s[16:19], s77 offen offset:1024 sc1
  s_waitcnt lgkmcnt(14)
  v_mfma_f32_16x16x32_bf16 v[54:57], v[22:25], v[104:107], v[54:57]
  ds_read_b64_tr_b16 v[22:23], v12 offset:49152
  ds_read_b64_tr_b16 v[24:25], v12 offset:50176
  s_waitcnt lgkmcnt(14)
  v_mfma_f32_16x16x32_bf16 v[58:61], v[26:29], v[104:107], v[58:61]
  ds_read_b64_tr_b16 v[26:27], v13 offset:49152
  ds_read_b64_tr_b16 v[28:29], v13 offset:50176
  s_waitcnt vmcnt(18) lgkmcnt(14)
  v_mfma_f32_16x16x32_bf16 v[46:49], v[30:33], v[108:111], v[46:49]
  ds_read_b64_tr_b16 v[30:31], v10 offset:53248
  ds_read_b64_tr_b16 v[32:33], v10 offset:54272
  s_waitcnt lgkmcnt(14)
  v_mfma_f32_16x16x32_bf16 v[50:53], v[34:37], v[108:111], v[50:53]
  ds_read_b64_tr_b16 v[34:35], v11 offset:53248
  ds_read_b64_tr_b16 v[36:37], v11 offset:54272
  s_add_u32 s77, s76, 12288
  buffer_load_dwordx4 a[56:59], v2, s[16:19], s77 offen offset:2048 sc1
  s_add_u32 s77, s76, 15360
  buffer_load_dwordx4 a[60:63], v2, s[16:19], s77 offen offset:0 sc1
  s_waitcnt lgkmcnt(14)
  v_mfma_f32_16x16x32_bf16 v[54:57], v[38:41], v[108:111], v[54:57]
  ds_read_b64_tr_b16 v[38:39], v12 offset:53248
  ds_read_b64_tr_b16 v[40:41], v12 offset:54272
  s_waitcnt lgkmcnt(14)
  v_mfma_f32_16x16x32_bf16 v[58:61], v[42:45], v[108:111], v[58:61]
  ds_read_b64_tr_b16 v[42:43], v13 offset:53248
  ds_read_b64_tr_b16 v[44:45], v13 offset:54272
  s_waitcnt vmcnt(19) lgkmcnt(14)
  v_mfma_f32_16x16x32_bf16 v[46:49], v[14:17], v[112:115], v[46:49]
  ds_read_b64_tr_b16 v[14:15], v10 offset:57344
  ds_read_b64_tr_b16 v[16:17], v10 offset:58368
  s_waitcnt lgkmcnt(14)
  v_mfma_f32_16x16x32_bf16 v[50:53], v[18:21], v[112:115], v[50:53]
  ds_read_b64_tr_b16 v[18:19], v11 offset:57344
  ds_read_b64_tr_b16 v[20:21], v11 offset:58368
  s_waitcnt lgkmcnt(14)
  v_mfma_f32_16x16x32_bf16 v[54:57], v[22:25], v[112:115], v[54:57]
  ds_read_b64_tr_b16 v[22:23], v12 offset:57344
  ds_read_b64_tr_b16 v[24:25], v12 offset:58368
  s_waitcnt lgkmcnt(14)
  v_mfma_f32_16x16x32_bf16 v[58:61], v[26:29], v[112:115], v[58:61]
  ds_read_b64_tr_b16 v[26:27], v13 offset:57344
  ds_read_b64_tr_b16 v[28:29], v13 offset:58368
  s_waitcnt vmcnt(18) lgkmcnt(14)
  v_mfma_f32_16x16x32_bf16 v[46:49], v[30:33], v[116:119], v[46:49]
  ds_read_b64_tr_b16 v[30:31], v10 offset:61440
  ds_read_b64_tr_b16 v[32:33], v10 offset:62464
  s_waitcnt lgkmcnt(14)
  v_mfma_f32_16x16x32_bf16 v[50:53], v[34:37], v[116:119], v[50:53]
  ds_read_b64_tr_b16 v[34:35], v11 offset:61440
  ds_read_b64_tr_b16 v[36:37], v11 offset:62464
  s_waitcnt lgkmcnt(14)
  v_mfma_f32_16x16x32_bf16 v[54:57], v[38:41], v[116:119], v[54:57]
  ds_read_b64_tr_b16 v[38:39], v12 offset:61440
  ds_read_b64_tr_b16 v[40:41], v12 offset:62464
  s_waitcnt lgkmcnt(14)
  v_mfma_f32_16x16x32_bf16 v[58:61], v[42:45], v[116:119], v[58:61]
  ds_read_b64_tr_b16 v[42:43], v13 offset:61440
  ds_read_b64_tr_b16 v[44:45], v13 offset:62464
  s_waitcnt vmcnt(17) lgkmcnt(14)
  v_mfma_f32_16x16x32_bf16 v[46:49], v[14:17], v[120:123], v[46:49]
  s_waitcnt lgkmcnt(12)
  v_mfma_f32_16x16x32_bf16 v[50:53], v[18:21], v[120:123], v[50:53]
  s_waitcnt lgkmcnt(10)
  v_mfma_f32_16x16x32_bf16 v[54:57], v[22:25], v[120:123], v[54:57]
  s_waitcnt lgkmcnt(8)
  v_mfma_f32_16x16x32_bf16 v[58:61], v[26:29], v[120:123], v[58:61]
  s_waitcnt vmcnt(16) lgkmcnt(6)
  v_mfma_f32_16x16x32_bf16 v[46:49], v[30:33], v[124:127], v[46:49]
  s_waitcnt lgkmcnt(4)
  v_mfma_f32_16x16x32_bf16 v[50:53], v[34:37], v[124:127], v[50:53]
  s_waitcnt lgkmcnt(2)
  v_mfma_f32_16x16x32_bf16 v[54:57], v[38:41], v[124:127], v[54:57]
  s_waitcnt lgkmcnt(0)
  v_mfma_f32_16x16x32_bf16 v[58:61], v[42:45], v[124:127], v[58:61]
L_ob_122:
  v_and_b32 v3, 15, v1
  s_lshl_b32 s72, s60, 4
  v_add_u32 v14, s72, v3
  v_lshrrev_b32 v4, 4, v1
  v_mul_u32_u24 v5, 144, v14
  v_lshl_add_u32 v5, v4, 3, v5
  v_add_u32 v15, 147456, v5
  ds_read_b64 v[176:177], v15 offset:0
  ds_read_b64 v[178:179], v15 offset:32
  ds_read_b64 v[180:181], v15 offset:64
  ds_read_b64 v[182:183], v15 offset:96
  s_waitcnt lgkmcnt(3)
  v_lshlrev_b32 v192, 16, v176
  v_and_b32 v193, 0xffff0000, v176
  v_lshlrev_b32 v194, 16, v177
  v_and_b32 v195, 0xffff0000, v177
  s_waitcnt lgkmcnt(2)
  v_lshlrev_b32 v196, 16, v178
  v_and_b32 v197, 0xffff0000, v178
  v_lshlrev_b32 v198, 16, v179
  v_and_b32 v199, 0xffff0000, v179
  s_waitcnt lgkmcnt(1)
  v_lshlrev_b32 v200, 16, v180
  v_and_b32 v201, 0xffff0000, v180
  v_lshlrev_b32 v202, 16, v181
  v_and_b32 v203, 0xffff0000, v181
  s_waitcnt lgkmcnt(0)
  v_lshlrev_b32 v204, 16, v182
  v_and_b32 v205, 0xffff0000, v182
  v_lshlrev_b32 v206, 16, v183
  v_and_b32 v207, 0xffff0000, v183
  v_add_f32 v192, v192, v46
  v_add_f32 v193, v193, v47
  v_add_f32 v194, v194, v48
  v_add_f32 v195, v195, v49
  v_add_f32 v196, v196, v50
  v_add_f32 v197, v197, v51
  v_add_f32 v198, v198, v52
  v_add_f32 v199, v199, v53
  v_add_f32 v200, v200, v54
  v_add_f32 v201, v201, v55
  v_add_f32 v202, v202, v56
  v_add_f32 v203, v203, v57
  v_add_f32 v204, v204, v58
  v_add_f32 v205, v205, v59
  v_add_f32 v206, v206, v60
  v_add_f32 v207, v207, v61
  v_cvt_pk_bf16_f32 v176, v192, v193
  v_cvt_pk_bf16_f32 v177, v194, v195
  v_cvt_pk_bf16_f32 v178, v196, v197
  v_cvt_pk_bf16_f32 v179, v198, v199
  v_cvt_pk_bf16_f32 v180, v200, v201
  v_cvt_pk_bf16_f32 v181, v202, v203
  v_cvt_pk_bf16_f32 v182, v204, v205
  v_cvt_pk_bf16_f32 v183, v206, v207
  ds_write_b64 v15, v[176:177] offset:0
  ds_write_b64 v15, v[178:179] offset:32
  ds_write_b64 v15, v[180:181] offset:64
  ds_write_b64 v15, v[182:183] offset:96
  v_add_f32 v16, v192, v193
  v_mul_f32 v17, v192, v192
  v_fmac_f32 v17, v193, v193
  v_add_f32 v16, v16, v194
  v_fmac_f32 v17, v194, v194
  v_add_f32 v16, v16, v195
  v_fmac_f32 v17, v195, v195
  v_add_f32 v16, v16, v196
  v_fmac_f32 v17, v196, v196
  v_add_f32 v16, v16, v197
  v_fmac_f32 v17, v197, v197
  v_add_f32 v16, v16, v198
  v_fmac_f32 v17, v198, v198
  v_add_f32 v16, v16, v199
  v_fmac_f32 v17, v199, v199
  v_add_f32 v16, v16, v200
  v_fmac_f32 v17, v200, v200
  v_add_f32 v16, v16, v201
  v_fmac_f32 v17, v201, v201
  v_add_f32 v16, v16, v202
  v_fmac_f32 v17, v202, v202
  v_add_f32 v16, v16, v203
  v_fmac_f32 v17, v203, v203
  v_add_f32 v16, v16, v204
  v_fmac_f32 v17, v204, v204
  v_add_f32 v16, v16, v205
  v_fmac_f32 v17, v205, v205
  v_add_f32 v16, v16, v206
  v_fmac_f32 v17, v206, v206
  v_add_f32 v16, v16, v207
  v_fmac_f32 v17, v207, v207
  v_mov_b32 v20, v16
  v_mov_b32 v21, v17
  s_nop 0
  v_permlane16_swap_b32 v16, v20
  v_permlane16_swap_b32 v17, v21
  v_add_f32 v16, v16, v20
  v_add_f32 v17, v17, v21
  v_mov_b32 v20, v16
  v_mov_b32 v21, v17
  s_nop 0
  v_permlane32_swap_b32 v16, v20
  v_permlane32_swap_b32 v17, v21
  v_add_f32 v16, v16, v20
  v_add_f32 v17, v17, v21
  v_mov_b32 v18, s62
  v_mov_b32 v19, s63
  s_lshl_b32 s72, s61, 5
  s_add_u32 s72, s72, s58
  s_lshl_b32 s72, s72, 13
  s_add_u32 s72, s72, 524288
  s_lshl_b32 s73, s59, 10
  s_add_u32 s73, s73, s72
  v_lshlrev_b32 v22, 4, v14
  s_mov_b64 exec, 0xffff
  s_cmp_eq_u32 s0, 0
  s_cbranch_scc1 L_slow_123
  buffer_store_dwordx4 v[16:19], v22, s[16:19], s73 offen
  s_branch L_dj_124
L_slow_123:
  buffer_store_dwordx4 v[16:19], v22, s[16:19], s73 offen sc1
L_dj_124:
  s_mov_b64 exec, -1
  v_lshrrev_b32 v4, 4, v1
  s_lshl_b32 s72, s61, 5
  s_add_u32 s72, s72, s58
  s_lshl_b32 s72, s72, 13
  s_add_u32 s72, s72, 524288
  v_lshl_add_u32 v23, v4, 11, v22
  s_mov_b32 s100, 0
L_stp_125:
  buffer_load_dwordx4 v[24:27], v23, s[16:19], s72 offen sc1
  buffer_load_dwordx4 v[28:31], v23, s[16:19], s72 offen offset:1024 sc1
  s_waitcnt vmcnt(0)
  v_cmp_ne_u64 vcc, s[62:63], v[26:27]
  v_cmp_ne_u64 s[74:75], s[62:63], v[30:31]
  s_or_b64 vcc, vcc, s[74:75]
  s_cbranch_vccz L_sto_126
  s_add_u32 s100, s100, 1
  s_cmp_lt_u32 s100, 400000
  s_cbranch_scc1 L_stp_125
  s_branch L_fail
L_sto_126:
  s_lshl_b32 s90, s65, 6
  s_lshl_b32 s91, s60, 4
  s_add_u32 s90, s90, s91
  s_mul_i32 s90, s90, 3072
  s_add_u32 s90, s90, 24117248
  s_cmp_eq_u32 s66, 0
  s_cselect_b32 s90, 0x70000000, s90
  s_add_u32 s91, s90, 15360
  buffer_load_dwordx4 a[64:67], v2, s[16:19], s91 offen offset:1024 sc1
  v_add_f32 v16, v24, v28
  v_add_f32 v17, v25, v29
  v_mov_b32 v20, v16
  v_mov_b32 v21, v17
  s_nop 0
  v_permlane16_swap_b32 v16, v20
  v_permlane16_swap_b32 v17, v21
  v_add_f32 v16, v16, v20
  buffer_load_dwordx4 a[68:71], v2, s[16:19], s91 offen offset:2048 sc1
  v_add_f32 v17, v17, v21
  v_mov_b32 v20, v16
  v_mov_b32 v21, v17
  s_nop 0
  v_permlane32_swap_b32 v16, v20
  v_permlane32_swap_b32 v17, v21
  v_add_f32 v16, v16, v20
  v_add_f32 v17, v17, v21
  s_add_u32 s91, s90, 18432
  buffer_load_dwordx4 a[72:75], v2, s[16:19], s91 offen offset:0 sc1
  v_mul_f32 v16, 0x3b000000, v16
  v_mul_f32 v17, 0x3b000000, v17
  v_fma_f32 v17, -v16, v16, v17
  v_max_f32 v17, 0, v17
  v_add_f32 v18, 0x3727c5ac, v17
  v_rsq_f32 v18, v18
  s_nop 0
  v_mul_f32 v19, v18, v18
  buffer_load_dwordx4 a[76:79], v2, s[16:19], s91 offen offset:1024 sc1
  v_mul_f32 v19, v19, v17
  v_add_f32 v19, 0x3727c5ac, v19
  v_rsq_f32 v19, v19
  s_nop 0
  v_mul_f32 v18, v18, v19
  v_sub_f32 v192, v192, v16
  v_sub_f32 v193, v193, v16
  v_sub_f32 v194, v194, v16
  buffer_load_dwordx4 a[80:83], v2, s[16:19], s91 offen offset:2048 sc1
  v_sub_f32 v195, v195, v16
  v_sub_f32 v196, v196, v16
  v_sub_f32 v197, v197, v16
  v_sub_f32 v198, v198, v16
  v_sub_f32 v199, v199, v16
  v_sub_f32 v200, v200, v16
  v_sub_f32 v201, v201, v16
  s_add_u32 s91, s90, 21504
  buffer_load_dwordx4 a[84:87], v2, s[16:19], s91 offen offset:0 sc1
  v_sub_f32 v202, v202, v16
  v_sub_f32 v203, v203, v16
  v_sub_f32 v204, v204, v16
  v_sub_f32 v205, v205, v16
  v_sub_f32 v206, v206, v16
  v_sub_f32 v207, v207, v16
  v_mul_f32 v192, v18, v192
  buffer_load_dwordx4 a[88:91], v2, s[16:19], s91 offen offset:1024 sc1
  v_mul_f32 v193, v18, v193
  v_mul_f32 v194, v18, v194
  v_mul_f32 v195, v18, v195
  v_mul_f32 v196, v18, v196
  v_mul_f32 v197, v18, v197
  v_mul_f32 v198, v18, v198
  v_mul_f32 v199, v18, v199
  buffer_load_dwordx4 a[92:95], v2, s[16:19], s91 offen offset:2048 sc1
  v_mul_f32 v200, v18, v200
  v_mul_f32 v201, v18, v201
  v_mul_f32 v202, v18, v202
  v_mul_f32 v203, v18, v203
  v_mul_f32 v204, v18, v204
  v_mul_f32 v205, v18, v205
  v_mul_f32 v206, v18, v206
  s_add_u32 s91, s90, 24576
  buffer_load_dwordx4 a[96:99], v2, s[16:19], s91 offen offset:0 sc1
  v_mul_f32 v207, v18, v207
  v_cvt_pk_bf16_f32 v176, v192, v193
  v_cvt_pk_bf16_f32 v177, v194, v195
  v_cvt_pk_bf16_f32 v178, v196, v197
  v_cvt_pk_bf16_f32 v179, v198, v199
  v_cvt_pk_bf16_f32 v180, v200, v201
  v_cvt_pk_bf16_f32 v181, v202, v203
  buffer_load_dwordx4 a[100:103], v2, s[16:19], s91 offen offset:1024 sc1
  v_cvt_pk_bf16_f32 v182, v204, v205
  v_cvt_pk_bf16_f32 v183, v206, v207
  v_mul_u32_u24 v5, 160, v14
  v_lshl_add_u32 v5, v4, 3, v5
  v_add_u32 v5, 65536, v5
  ds_write_b64 v5, v[176:177] offset:0
  ds_write_b64 v5, v[178:179] offset:32
  buffer_load_dwordx4 a[104:107], v2, s[16:19], s91 offen offset:2048 sc1
  ds_write_b64 v5, v[180:181] offset:64
  ds_write_b64 v5, v[182:183] offset:96
  v_lshrrev_b32 v3, 4, v1
  v_lshlrev_b32 v3, 3, v3
  v_bfe_u32 v6, v1, 2, 2
  v_add_u32 v3, v3, v6
  s_lshl_b32 s72, s68, 5
  s_add_u32 s91, s90, 27648
  buffer_load_dwordx4 a[108:111], v2, s[16:19], s91 offen offset:0 sc1
  v_add_u32 v3, s72, v3
  v_mul_u32_u24 v3, 160, v3
  v_and_b32 v6, 3, v1
  v_lshl_add_u32 v3, v6, 3, v3
  s_lshl_b32 s72, s67, 6
  s_add_u32 s72, s72, 65536
  v_add_u32 v3, s72, v3
  s_waitcnt lgkmcnt(0)
  s_barrier
  ds_read_b64_tr_b16 v[184:185], v3 offset:0
  ds_read_b64_tr_b16 v[186:187], v3 offset:640
  ds_read_b64_tr_b16 v[188:189], v3 offset:32
  ds_read_b64_tr_b16 v[190:191], v3 offset:672
  s_lshl_b32 s72, s59, 6
  s_lshl_b32 s73, s58, 1
  s_add_u32 s72, s72, s73
  s_add_u32 s72, s72, s68
  s_lshl_b32 s72, s72, 2
  s_lshl_b32 s73, s67, 1
  s_add_u32 s72, s72, s73
  s_lshl_b32 s72, s72, 10
  s_lshl_b32 s73, s61, 21
  s_add_u32 s72, s72, s73
  s_add_u32 s72, s72, 13631488
  s_waitcnt lgkmcnt(2)
  buffer_store_dwordx4 v[184:187], v2, s[16:19], s72 offen offset:0 sc1
  s_waitcnt lgkmcnt(0)
  buffer_store_dwordx4 v[188:191], v2, s[16:19], s72 offen offset:1024 sc1
  s_cmp_eq_u32 s66, 0
  s_cbranch_scc1 L_e1_127
  s_lshl_b32 s72, s65, 6
  s_lshl_b32 s73, s60, 4
  s_add_u32 s72, s72, s73
  s_mul_i32 s72, s72, 3072
  s_add_u32 s72, s72, 24117248
  s_add_u32 s73, s72, 27648
  buffer_load_dwordx4 a[112:115], v2, s[16:19], s73 offen offset:1024 sc1
  buffer_load_dwordx4 a[116:119], v2, s[16:19], s73 offen offset:2048 sc1
  s_add_u32 s73, s72, 30720
  buffer_load_dwordx4 a[120:123], v2, s[16:19], s73 offen offset:0 sc1
  buffer_load_dwordx4 a[124:127], v2, s[16:19], s73 offen offset:1024 sc1
  buffer_load_dwordx4 a[128:131], v2, s[16:19], s73 offen offset:2048 sc1
  s_add_u32 s73, s72, 33792
  buffer_load_dwordx4 a[132:135], v2, s[16:19], s73 offen offset:0 sc1
  buffer_load_dwordx4 a[136:139], v2, s[16:19], s73 offen offset:1024 sc1
  buffer_load_dwordx4 a[140:143], v2, s[16:19], s73 offen offset:2048 sc1
  s_add_u32 s73, s72, 36864
  buffer_load_dwordx4 a[144:147], v2, s[16:19], s73 offen offset:0 sc1
  buffer_load_dwordx4 a[148:151], v2, s[16:19], s73 offen offset:1024 sc1
  buffer_load_dwordx4 a[152:155], v2, s[16:19], s73 offen offset:2048 sc1
  s_add_u32 s73, s72, 39936
  buffer_load_dwordx4 a[156:159], v2, s[16:19], s73 offen offset:0 sc1
L_e1_127:
  s_cmp_eq_u32 s66, 1
  s_cbranch_scc1 L_dr_128
  s_waitcnt vmcnt(0)
L_dr_128:
  s_waitcnt vmcnt(12)
  s_barrier
  s_cmp_eq_u32 s60, 0
  s_cbranch_scc0 L_pub_129
  s_lshl_b32 s70, s61, 8
  s_add_u32 s70, s70, s2
  s_lshl_b32 s70, s70, 7
  s_add_u32 s70, s70, 135168
  v_mov_b32 v4, s62
  v_mov_b32 v5, s63
  v_mov_b32 v6, s70
  s_mov_b64 exec, 1
  buffer_store_dwordx2 v[4:5], v6, s[16:19], 0 offen sc1
  s_mov_b64 exec, -1
L_pub_129:
  v_lshrrev_b32 v3, 3, v1
  v_lshlrev_b32 v3, 12, v3
  v_bfe_u32 v4, v1, 1, 2
  v_bfe_u32 v5, v1, 4, 1
  v_and_b32 v6, 1, v1
  v_or_b32 v7, 0, v5
  v_xor_b32 v7, v4, v7
  v_lshl_add_u32 v7, v7, 1, v6
  v_lshl_add_u32 v40, v7, 4, v3
  v_or_b32 v7, 2, v5
  v_xor_b32 v7, v4, v7
  v_lshl_add_u32 v7, v7, 1, v6
  v_lshl_add_u32 v41, v7, 4, v3
  v_lshrrev_b32 v3, 4, v1
  v_lshlrev_b32 v4, 3, v3
  v_bfe_u32 v5, v1, 2, 2
  v_add_u32 v4, v4, v5
  v_lshlrev_b32 v4, 7, v4
  v_and_b32 v5, 3, v1
  v_lshl_add_u32 v4, v5, 3, v4
  v_and_b32 v3, 1, v3
  v_lshlrev_b32 v3, 1, v3
  v_bfe_u32 v5, v1, 3, 1
  v_or_b32 v3, v3, v5
  v_xor_b32 v5, 0, v3
  v_lshl_add_u32 v42, v5, 5, v4
  v_xor_b32 v5, 1, v3
  v_lshl_add_u32 v43, v5, 5, v4
  v_xor_b32 v5, 2, v3
  v_lshl_add_u32 v44, v5, 5, v4
  v_xor_b32 v5, 3, v3
  v_lshl_add_u32 v45, v5, 5, v4
  s_mul_i32 s89, s60, 1441792
  s_lshl_b32 s88, s58, 7
  s_add_u32 s89, s89, s88
  s_mul_i32 s86, s60, 20480
  s_add_u32 s86, s86, 65536
  s_lshl_b32 s87, s60, 14
  s_add_u32 s87, s87, 0
  s_cmp_eq_u32 s66, 0
  s_cbranch_scc1 L_m1o_131
  s_lshl_b32 s90, s65, 6
  s_lshl_b32 s91, s60, 4
  s_add_u32 s90, s90, s91
  s_mul_i32 s90, s90, 3072
  s_add_u32 s90, s90, 24117248
  s_add_u32 s91, s90, 39936
  buffer_load_dwordx4 a[160:163], v2, s[16:19], s91 offen offset:1024 sc1
  s_mov_b32 s32, s46
  s_mov_b32 s33, s47
  s_mov_b32 s34, 2752
  s_mov_b32 s35, 0x20000
  s_mul_i32 s72, s65, 96
  v_and_b32 v3, 1, v1
  v_lshlrev_b32 v3, 3, v3
  s_mul_i32 s73, s60, 3
  s_add_u32 s74, s73, 0
  s_lshr_b32 s74, s74, 1
  s_lshl_b32 s74, s74, 4
  s_add_u32 s74, s74, s72
  buffer_load_dwordx2 v[14:15], v3, s[32:35], s74 offen
  s_add_u32 s74, s73, 1
  s_lshr_b32 s74, s74, 1
  s_lshl_b32 s74, s74, 4
  s_add_u32 s74, s74, s72
  buffer_load_dwordx4 a[164:167], v2, s[16:19], s91 offen offset:2048 sc1
  buffer_load_dwordx2 v[16:17], v3, s[32:35], s74 offen
  s_add_u32 s74, s73, 2
  s_lshr_b32 s74, s74, 1
  s_lshl_b32 s74, s74, 4
  s_add_u32 s74, s74, s72
  buffer_load_dwordx2 v[18:19], v3, s[32:35], s74 offen
  s_lshl_b32 s73, s60, 3
  v_add_u32 v8, s73, v1
  v_and_b32 v9, 3, v8
  v_lshlrev_b32 v9, 3, v9
  v_add_u32 v9, s64, v9
  v_lshlrev_b32 v9, 3, v9
  v_lshrrev_b32 v7, 2, v8
  v_add_u32 v9, v9, v7
  s_lshl_b32 s70, s61, 15
  s_add_u32 s70, s70, 135168
  v_lshlrev_b32 v9, 7, v9
  s_add_u32 s91, s90, 43008
  buffer_load_dwordx4 a[168:171], v2, s[16:19], s91 offen offset:0 sc1
  v_add_u32 v9, s70, v9
  v_and_b32 v3, 15, v1
  v_mul_u32_u24 v3, 208, v3
  v_lshrrev_b32 v4, 4, v1
  v_lshl_add_u32 v3, v4, 4, v3
  s_mul_i32 s72, s60, 13312
  v_add_u32 v13, s72, v3
  v_lshrrev_b32 v3, 1, v1
  v_mul_u32_u24 v10, 208, v3
  v_and_b32 v4, 1, v1
  v_lshl_add_u32 v10, v4, 4, v10
  v_lshrrev_b32 v5, 5, v1
  v_lshlrev_b32 v11, 10, v5
  v_and_b32 v3, 15, v3
  v_lshl_add_u32 v11, v3, 4, v11
  v_lshl_add_u32 v11, v4, 3, v11
  s_mul_i32 s76, s60, 3
  buffer_load_dwordx4 a[172:175], v2, s[16:19], s91 offen offset:1024 sc1
  s_mov_b32 s84, 0xbdd2d3e8
  s_mov_b32 s85, 0xc0135761
  s_add_u32 s72, s76, 0
  s_lshr_b32 s73, s72, 1
  s_and_b32 s72, s72, 1
  s_mul_i32 s74, s72, 6656
  s_lshl_b32 s75, s73, 5
  s_add_u32 s74, s74, s75
  v_add_u32 v20, s74, v10
  s_add_u32 s72, s76, 1
  s_lshr_b32 s73, s72, 1
  s_and_b32 s72, s72, 1
  s_mul_i32 s74, s72, 6656
  s_lshl_b32 s75, s73, 5
  s_add_u32 s74, s74, s75
  v_add_u32 v21, s74, v10
  s_add_u32 s72, s76, 2
  buffer_load_dwordx4 a[176:179], v2, s[16:19], s91 offen offset:2048 sc1
  s_lshr_b32 s73, s72, 1
  s_and_b32 s72, s72, 1
  s_mul_i32 s74, s72, 6656
  s_lshl_b32 s75, s73, 5
  s_add_u32 s74, s74, s75
  v_add_u32 v22, s74, v10
  s_mul_i32 s76, s60, 3
  s_mul_i32 s77, s64, 176128
  s_lshl_b32 s73, s61, 21
  s_add_u32 s77, s77, s73
  s_add_u32 s77, s77, 17825792
  s_add_u32 s72, s76, 0
  s_lshr_b32 s73, s72, 1
  s_and_b32 s72, s72, 1
  s_mul_i32 s74, s65, 6
  s_add_u32 s74, s74, s73
  s_lshr_b32 s75, s74, 2
  s_add_u32 s91, s90, 46080
  buffer_load_dwordx4 a[180:183], v2, s[16:19], s91 offen offset:0 sc1
  s_and_b32 s79, s74, 3
  s_lshl_b32 s75, s75, 12
  s_lshl_b32 s79, s79, 8
  s_add_u32 s75, s75, s79
  s_lshl_b32 s72, s72, 11
  s_add_u32 s75, s75, s72
  s_add_u32 s75, s75, s77
  s_cmp_ge_u32 s74, 172
  s_cselect_b32 s79, 0x70000000, 0
  s_or_b32 s75, s75, s79
  s_cmp_eq_u32 s66, 0
  s_cselect_b32 s80, 0x70000000, s75
  s_add_u32 s72, s76, 1
  s_lshr_b32 s73, s72, 1
  s_and_b32 s72, s72, 1
  s_mul_i32 s74, s65, 6
  s_add_u32 s74, s74, s73
  buffer_load_dwordx4 a[184:187], v2, s[16:19], s91 offen offset:1024 sc1
  s_lshr_b32 s75, s74, 2
  s_and_b32 s79, s74, 3
  s_lshl_b32 s75, s75, 12
  s_lshl_b32 s79, s79, 8
  s_add_u32 s75, s75, s79
  s_lshl_b32 s72, s72, 11
  s_add_u32 s75, s75, s72
  s_add_u32 s75, s75, s77
  s_cmp_ge_u32 s74, 172
  s_cselect_b32 s79, 0x70000000, 0
  s_or_b32 s75, s75, s79
  s_cmp_eq_u32 s66, 0
  s_cselect_b32 s81, 0x70000000, s75
  s_add_u32 s72, s76, 2
  s_lshr_b32 s73, s72, 1
  s_and_b32 s72, s72, 1
  s_mul_i32 s74, s65, 6
  buffer_load_dwordx4 a[188:191], v2, s[16:19], s91 offen offset:2048 sc1
  s_add_u32 s74, s74, s73
  s_lshr_b32 s75, s74, 2
  s_and_b32 s79, s74, 3
  s_lshl_b32 s75, s75, 12
  s_lshl_b32 s79, s79, 8
  s_add_u32 s75, s75, s79
  s_lshl_b32 s72, s72, 11
  s_add_u32 s75, s75, s72
  s_add_u32 s75, s75, s77
  s_cmp_ge_u32 s74, 172
  s_cselect_b32 s79, 0x70000000, 0
  s_or_b32 s75, s75, s79
  s_cmp_eq_u32 s66, 0
  s_cselect_b32 s82, 0x70000000, s75
  s_lshl_b32 s72, s64, 6
  s_lshl_b32 s73, s60, 4
  s_add_u32 s72, s72, s73
  s_lshl_b32 s72, s72, 12
  s_lshl_b32 s73, s61, 21
  s_add_u32 s72, s72, s73
  s_add_u32 s43, s72, 13631488
  s_mov_b64 exec, 0xff
  s_mov_b32 s100, 0
  s_cbranch_execz L_pok_133
L_poll_132:
  buffer_load_dwordx2 v[4:5], v9, s[16:19], 0 offen sc1
  s_waitcnt vmcnt(0)
  v_cmp_ne_u64 vcc, s[62:63], v[4:5]
  s_nop 0
  s_cbranch_vccz L_pok_133
  s_add_u32 s100, s100, 1
  s_cmp_lt_u32 s100, 400000
  s_cbranch_scc1 L_poll_132
  s_branch L_fail
L_pok_133:
  s_mov_b64 exec, -1
  s_mov_b32 s72, s43
  buffer_load_dwordx4 v[64:67], v2, s[16:19], s72 offen offset:0 sc1
  buffer_load_dwordx4 v[68:71], v2, s[16:19], s72 offen offset:1024 sc1
  buffer_load_dwordx4 v[72:75], v2, s[16:19], s72 offen offset:2048 sc1
  buffer_load_dwordx4 v[76:79], v2, s[16:19], s72 offen offset:3072 sc1
  s_add_u32 s72, s72, 4096
  buffer_load_dwordx4 v[80:83], v2, s[16:19], s72 offen offset:0 sc1
  buffer_load_dwordx4 v[84:87], v2, s[16:19], s72 offen offset:1024 sc1
  buffer_load_dwordx4 v[88:91], v2, s[16:19], s72 offen offset:2048 sc1
  buffer_load_dwordx4 v[92:95], v2, s[16:19], s72 offen offset:3072 sc1
  s_add_u32 s72, s72, 4096
  buffer_load_dwordx4 v[96:99], v2, s[16:19], s72 offen offset:0 sc1
  buffer_load_dwordx4 v[100:103], v2, s[16:19], s72 offen offset:1024 sc1
  buffer_load_dwordx4 v[104:107], v2, s[16:19], s72 offen offset:2048 sc1
  buffer_load_dwordx4 v[108:111], v2, s[16:19], s72 offen offset:3072 sc1
  s_add_u32 s72, s72, 4096
  buffer_load_dwordx4 v[112:115], v2, s[16:19], s72 offen offset:0 sc1
  buffer_load_dwordx4 v[116:119], v2, s[16:19], s72 offen offset:1024 sc1
  buffer_load_dwordx4 v[120:123], v2, s[16:19], s72 offen offset:2048 sc1
  s_waitcnt vmcnt(14)
  v_mfma_f32_16x16x32_bf16 a[192:195], a[0:3], v[64:67], 0
  v_mfma_f32_16x16x32_bf16 a[208:211], a[4:7], v[64:67], 0
  v_mfma_f32_16x16x32_bf16 a[224:227], a[8:11], v[64:67], 0
  buffer_load_dwordx4 v[124:127], v2, s[16:19], s72 offen offset:3072 sc1
  s_add_u32 s72, s72, 4096
  s_waitcnt vmcnt(14)
  v_mfma_f32_16x16x32_bf16 a[196:199], a[0:3], v[68:71], 0
  v_mfma_f32_16x16x32_bf16 a[212:215], a[4:7], v[68:71], 0
  v_mfma_f32_16x16x32_bf16 a[228:231], a[8:11], v[68:71], 0
  buffer_load_dwordx4 v[128:131], v2, s[16:19], s72 offen offset:0 sc1
  s_waitcnt vmcnt(14)
  v_mfma_f32_16x16x32_bf16 a[200:203], a[0:3], v[72:75], 0
  v_mfma_f32_16x16x32_bf16 a[216:219], a[4:7], v[72:75], 0
  v_mfma_f32_16x16x32_bf16 a[232:235], a[8:11], v[72:75], 0
  buffer_load_dwordx4 v[132:135], v2, s[16:19], s72 offen offset:1024 sc1
  s_waitcnt vmcnt(14)
  v_mfma_f32_16x16x32_bf16 a[204:207], a[0:3], v[76:79], 0
  v_mfma_f32_16x16x32_bf16 a[220:223], a[4:7], v[76:79], 0
  v_mfma_f32_16x16x32_bf16 a[236:239], a[8:11], v[76:79], 0
  buffer_load_dwordx4 v[136:139], v2, s[16:19], s72 offen offset:2048 sc1
  s_waitcnt vmcnt(14)
  v_mfma_f32_16x16x32_bf16 a[192:195], a[12:15], v[80:83], a[192:195]
  v_mfma_f32_16x16x32_bf16 a[208:211], a[16:19], v[80:83], a[208:211]
  v_mfma_f32_16x16x32_bf16 a[224:227], a[20:23], v[80:83], a[224:227]
  buffer_load_dwordx4 v[140:143], v2, s[16:19], s72 offen offset:3072 sc1
  s_add_u32 s72, s72, 4096
  s_waitcnt vmcnt(14)
  v_mfma_f32_16x16x32_bf16 a[196:199], a[12:15], v[84:87], a[196:199]
  v_mfma_f32_16x16x32_bf16 a[212:215], a[16:19], v[84:87], a[212:215]
  v_mfma_f32_16x16x32_bf16 a[228:231], a[20:23], v[84:87], a[228:231]
  buffer_load_dwordx4 v[144:147], v2, s[16:19], s72 offen offset:0 sc1
  s_waitcnt vmcnt(14)
  v_mfma_f32_16x16x32_bf16 a[200:203], a[12:15], v[88:91], a[200:203]
  v_mfma_f32_16x16x32_bf16 a[216:219], a[16:19], v[88:91], a[216:219]
  v_mfma_f32_16x16x32_bf16 a[232:235], a[20:23], v[88:91], a[232:235]
  buffer_load_dwordx4 v[148:151], v2, s[16:19], s72 offen offset:1024 sc1
  s_waitcnt vmcnt(14)
  v_mfma_f32_16x16x32_bf16 a[204:207], a[12:15], v[92:95], a[204:207]
  v_mfma_f32_16x16x32_bf16 a[220:223], a[16:19], v[92:95], a[220:223]
  v_mfma_f32_16x16x32_bf16 a[236:239], a[20:23], v[92:95], a[236:239]
  buffer_load_dwordx4 v[152:155], v2, s[16:19], s72 offen offset:2048 sc1
  s_waitcnt vmcnt(14)
  v_mfma_f32_16x16x32_bf16 a[192:195], a[24:27], v[96:99], a[192:195]
  v_mfma_f32_16x16x32_bf16 a[208:211], a[28:31], v[96:99], a[208:211]
  v_mfma_f32_16x16x32_bf16 a[224:227], a[32:35], v[96:99], a[224:227]
  buffer_load_dwordx4 v[156:159], v2, s[16:19], s72 offen offset:3072 sc1
  s_add_u32 s72, s72, 4096
  s_waitcnt vmcnt(14)
  v_mfma_f32_16x16x32_bf16 a[196:199], a[24:27], v[100:103], a[196:199]
  v_mfma_f32_16x16x32_bf16 a[212:215], a[28:31], v[100:103], a[212:215]
  v_mfma_f32_16x16x32_bf16 a[228:231], a[32:35], v[100:103], a[228:231]
  buffer_load_dwordx4 v[64:67], v2, s[16:19], s72 offen offset:0 sc1
  s_waitcnt vmcnt(14)
  v_mfma_f32_16x16x32_bf16 a[200:203], a[24:27], v[104:107], a[200:203]
  v_mfma_f32_16x16x32_bf16 a[216:219], a[28:31], v[104:107], a[216:219]
  v_mfma_f32_16x16x32_bf16 a[232:235], a[32:35], v[104:107], a[232:235]
  buffer_load_dwordx4 v[68:71], v2, s[16:19], s72 offen offset:1024 sc1
  s_waitcnt vmcnt(14)
  v_mfma_f32_16x16x32_bf16 a[204:207], a[24:27], v[108:111], a[204:207]
  v_mfma_f32_16x16x32_bf16 a[220:223], a[28:31], v[108:111], a[220:223]
  v_mfma_f32_16x16x32_bf16 a[236:239], a[32:35], v[108:111], a[236:239]
  buffer_load_dwordx4 v[72:75], v2, s[16:19], s72 offen offset:2048 sc1
  s_waitcnt vmcnt(14)
  v_mfma_f32_16x16x32_bf16 a[192:195], a[36:39], v[112:115], a[192:195]
  v_mfma_f32_16x16x32_bf16 a[208:211], a[40:43], v[112:115], a[208:211]
  v_mfma_f32_16x16x32_bf16 a[224:227], a[44:47], v[112:115], a[224:227]
  buffer_load_dwordx4 v[76:79], v2, s[16:19], s72 offen offset:3072 sc1
  s_add_u32 s72, s72, 4096
  s_waitcnt vmcnt(14)
  v_mfma_f32_16x16x32_bf16 a[196:199], a[36:39], v[116:119], a[196:199]
  v_mfma_f32_16x16x32_bf16 a[212:215], a[40:43], v[116:119], a[212:215]
  v_mfma_f32_16x16x32_bf16 a[228:231], a[44:47], v[116:119], a[228:231]
  buffer_load_dwordx4 v[80:83], v2, s[16:19], s72 offen offset:0 sc1
  s_waitcnt vmcnt(14)
  v_mfma_f32_16x16x32_bf16 a[200:203], a[36:39], v[120:123], a[200:203]
  v_mfma_f32_16x16x32_bf16 a[216:219], a[40:43], v[120:123], a[216:219]
  v_mfma_f32_16x16x32_bf16 a[232:235], a[44:47], v[120:123], a[232:235]
  buffer_load_dwordx4 v[84:87], v2, s[16:19], s72 offen offset:1024 sc1
  s_waitcnt vmcnt(14)
  v_mfma_f32_16x16x32_bf16 a[204:207], a[36:39], v[124:127], a[204:207]
  v_mfma_f32_16x16x32_bf16 a[220:223], a[40:43], v[124:127], a[220:223]
  v_mfma_f32_16x16x32_bf16 a[236:239], a[44:47], v[124:127], a[236:239]
  buffer_load_dwordx4 v[88:91], v2, s[16:19], s72 offen offset:2048 sc1
  s_waitcnt vmcnt(14)
  v_mfma_f32_16x16x32_bf16 a[192:195], a[48:51], v[128:131], a[192:195]
  v_mfma_f32_16x16x32_bf16 a[208:211], a[52:55], v[128:131], a[208:211]
  v_mfma_f32_16x16x32_bf16 a[224:227], a[56:59], v[128:131], a[224:227]
  buffer_load_dwordx4 v[92:95], v2, s[16:19], s72 offen offset:3072 sc1
  s_add_u32 s72, s72, 4096
  s_waitcnt vmcnt(14)
  v_mfma_f32_16x16x32_bf16 a[196:199], a[48:51], v[132:135], a[196:199]
  v_mfma_f32_16x16x32_bf16 a[212:215], a[52:55], v[132:135], a[212:215]
  v_mfma_f32_16x16x32_bf16 a[228:231], a[56:59], v[132:135], a[228:231]
  buffer_load_dwordx4 v[96:99], v2, s[16:19], s72 offen offset:0 sc1
  s_waitcnt vmcnt(14)
  v_mfma_f32_16x16x32_bf16 a[200:203], a[48:51], v[136:139], a[200:203]
  v_mfma_f32_16x16x32_bf16 a[216:219], a[52:55], v[136:139], a[216:219]
  v_mfma_f32_16x16x32_bf16 a[232:235], a[56:59], v[136:139], a[232:235]
  buffer_load_dwordx4 v[100:103], v2, s[16:19], s72 offen offset:1024 sc1
  s_waitcnt vmcnt(14)
  v_mfma_f32_16x16x32_bf16 a[204:207], a[48:51], v[140:143], a[204:207]
  v_mfma_f32_16x16x32_bf16 a[220:223], a[52:55], v[140:143], a[220:223]
  v_mfma_f32_16x16x32_bf16 a[236:239], a[56:59], v[140:143], a[236:239]
  buffer_load_dwordx4 v[104:107], v2, s[16:19], s72 offen offset:2048 sc1
  s_waitcnt vmcnt(14)
  v_mfma_f32_16x16x32_bf16 a[192:195], a[60:63], v[144:147], a[192:195]
  v_mfma_f32_16x16x32_bf16 a[208:211], a[64:67], v[144:147], a[208:211]
  v_mfma_f32_16x16x32_bf16 a[224:227], a[68:71], v[144:147], a[224:227]
  buffer_load_dwordx4 v[108:111], v2, s[16:19], s72 offen offset:3072 sc1
  s_add_u32 s72, s72, 4096
  s_waitcnt vmcnt(14)
  v_mfma_f32_16x16x32_bf16 a[196:199], a[60:63], v[148:151], a[196:199]
  v_mfma_f32_16x16x32_bf16 a[212:215], a[64:67], v[148:151], a[212:215]
  v_mfma_f32_16x16x32_bf16 a[228:231], a[68:71], v[148:151], a[228:231]
  buffer_load_dwordx4 v[112:115], v2, s[16:19], s72 offen offset:0 sc1
  s_waitcnt vmcnt(14)
  v_mfma_f32_16x16x32_bf16 a[200:203], a[60:63], v[152:155], a[200:203]
  v_mfma_f32_16x16x32_bf16 a[216:219], a[64:67], v[152:155], a[216:219]
  v_mfma_f32_16x16x32_bf16 a[232:235], a[68:71], v[152:155], a[232:235]
  buffer_load_dwordx4 v[116:119], v2, s[16:19], s72 offen offset:1024 sc1
  s_waitcnt vmcnt(14)
  v_mfma_f32_16x16x32_bf16 a[204:207], a[60:63], v[156:159], a[204:207]
  v_mfma_f32_16x16x32_bf16 a[220:223], a[64:67], v[156:159], a[220:223]
  v_mfma_f32_16x16x32_bf16 a[236:239], a[68:71], v[156:159], a[236:239]
  buffer_load_dwordx4 v[120:123], v2, s[16:19], s72 offen offset:2048 sc1
  s_waitcnt vmcnt(14)
  v_mfma_f32_16x16x32_bf16 a[192:195], a[72:75], v[64:67], a[192:195]
  v_mfma_f32_16x16x32_bf16 a[208:211], a[76:79], v[64:67], a[208:211]
  v_mfma_f32_16x16x32_bf16 a[224:227], a[80:83], v[64:67], a[224:227]
  buffer_load_dwordx4 v[124:127], v2, s[16:19], s72 offen offset:3072 sc1
  s_add_u32 s72, s72, 4096
  s_waitcnt vmcnt(14)
  v_mfma_f32_16x16x32_bf16 a[196:199], a[72:75], v[68:71], a[196:199]
  v_mfma_f32_16x16x32_bf16 a[212:215], a[76:79], v[68:71], a[212:215]
  v_mfma_f32_16x16x32_bf16 a[228:231], a[80:83], v[68:71], a[228:231]
  buffer_load_dwordx4 v[128:131], v2, s[16:19], s72 offen offset:0 sc1
  s_waitcnt vmcnt(14)
  v_mfma_f32_16x16x32_bf16 a[200:203], a[72:75], v[72:75], a[200:203]
  v_mfma_f32_16x16x32_bf16 a[216:219], a[76:79], v[72:75], a[216:219]
  v_mfma_f32_16x16x32_bf16 a[232:235], a[80:83], v[72:75], a[232:235]
  buffer_load_dwordx4 v[132:135], v2, s[16:19], s72 offen offset:1024 sc1
  s_waitcnt vmcnt(14)
  v_mfma_f32_16x16x32_bf16 a[204:207], a[72:75], v[76:79], a[204:207]
  v_mfma_f32_16x16x32_bf16 a[220:223], a[76:79], v[76:79], a[220:223]
  v_mfma_f32_16x16x32_bf16 a[236:239], a[80:83], v[76:79], a[236:239]
  buffer_load_dwordx4 v[136:139], v2, s[16:19], s72 offen offset:2048 sc1
  s_waitcnt vmcnt(14)
  v_mfma_f32_16x16x32_bf16 a[192:195], a[84:87], v[80:83], a[192:195]
  v_mfma_f32_16x16x32_bf16 a[208:211], a[88:91], v[80:83], a[208:211]
  v_mfma_f32_16x16x32_bf16 a[224:227], a[92:95], v[80:83], a[224:227]
  buffer_load_dwordx4 v[140:143], v2, s[16:19], s72 offen offset:3072 sc1
  s_add_u32 s72, s72, 4096
  s_waitcnt vmcnt(14)
  v_mfma_f32_16x16x32_bf16 a[196:199], a[84:87], v[84:87], a[196:199]
  v_mfma_f32_16x16x32_bf16 a[212:215], a[88:91], v[84:87], a[212:215]
  v_mfma_f32_16x16x32_bf16 a[228:231], a[92:95], v[84:87], a[228:231]
  buffer_load_dwordx4 v[144:147], v2, s[16:19], s72 offen offset:0 sc1
  s_waitcnt vmcnt(14)
  v_mfma_f32_16x16x32_bf16 a[200:203], a[84:87], v[88:91], a[200:203]
  v_mfma_f32_16x16x32_bf16 a[216:219], a[88:91], v[88:91], a[216:219]
  v_mfma_f32_16x16x32_bf16 a[232:235], a[92:95], v[88:91], a[232:235]
  buffer_load_dwordx4 v[148:151], v2, s[16:19], s72 offen offset:1024 sc1
  s_waitcnt vmcnt(14)
  v_mfma_f32_16x16x32_bf16 a[204:207], a[84:87], v[92:95], a[204:207]
  v_mfma_f32_16x16x32_bf16 a[220:223], a[88:91], v[92:95], a[220:223]
  v_mfma_f32_16x16x32_bf16 a[236:239], a[92:95], v[92:95], a[236:239]
  buffer_load_dwordx4 v[152:155], v2, s[16:19], s72 offen offset:2048 sc1
  s_waitcnt vmcnt(14)
  v_mfma_f32_16x16x32_bf16 a[192:195], a[96:99], v[96:99], a[192:195]
  v_mfma_f32_16x16x32_bf16 a[208:211], a[100:103], v[96:99], a[208:211]
  v_mfma_f32_16x16x32_bf16 a[224:227], a[104:107], v[96:99], a[224:227]
  buffer_load_dwordx4 v[156:159], v2, s[16:19], s72 offen offset:3072 sc1
  s_add_u32 s72, s72, 4096
  s_waitcnt vmcnt(14)
  v_mfma_f32_16x16x32_bf16 a[196:199], a[96:99], v[100:103], a[196:199]
  v_mfma_f32_16x16x32_bf16 a[212:215], a[100:103], v[100:103], a[212:215]
  v_mfma_f32_16x16x32_bf16 a[228:231], a[104:107], v[100:103], a[228:231]
  buffer_load_dwordx4 v[64:67], v2, s[16:19], s72 offen offset:0 sc1
  s_waitcnt vmcnt(14)
  v_mfma_f32_16x16x32_bf16 a[200:203], a[96:99], v[104:107], a[200:203]
  v_mfma_f32_16x16x32_bf16 a[216:219], a[100:103], v[104:107], a[216:219]
  v_mfma_f32_16x16x32_bf16 a[232:235], a[104:107], v[104:107], a[232:235]
  buffer_load_dwordx4 v[68:71], v2, s[16:19], s72 offen offset:1024 sc1
  s_waitcnt vmcnt(14)
  v_mfma_f32_16x16x32_bf16 a[204:207], a[96:99], v[108:111], a[204:207]
  v_mfma_f32_16x16x32_bf16 a[220:223], a[100:103], v[108:111], a[220:223]
  v_mfma_f32_16x16x32_bf16 a[236:239], a[104:107], v[108:111], a[236:239]
  buffer_load_dwordx4 v[72:75], v2, s[16:19], s72 offen offset:2048 sc1
  s_waitcnt vmcnt(14)
  v_mfma_f32_16x16x32_bf16 a[192:195], a[108:111], v[112:115], a[192:195]
  v_mfma_f32_16x16x32_bf16 a[208:211], a[112:115], v[112:115], a[208:211]
  v_mfma_f32_16x16x32_bf16 a[224:227], a[116:119], v[112:115], a[224:227]
  buffer_load_dwordx4 v[76:79], v2, s[16:19], s72 offen offset:3072 sc1
  s_add_u32 s72, s72, 4096
  s_waitcnt vmcnt(14)
  v_mfma_f32_16x16x32_bf16 a[196:199], a[108:111], v[116:119], a[196:199]
  v_mfma_f32_16x16x32_bf16 a[212:215], a[112:115], v[116:119], a[212:215]
  v_mfma_f32_16x16x32_bf16 a[228:231], a[116:119], v[116:119], a[228:231]
  buffer_load_dwordx4 v[80:83], v2, s[16:19], s72 offen offset:0 sc1
  s_waitcnt vmcnt(14)
  v_mfma_f32_16x16x32_bf16 a[200:203], a[108:111], v[120:123], a[200:203]
  v_mfma_f32_16x16x32_bf16 a[216:219], a[112:115], v[120:123], a[216:219]
  v_mfma_f32_16x16x32_bf16 a[232:235], a[116:119], v[120:123], a[232:235]
  buffer_load_dwordx4 v[84:87], v2, s[16:19], s72 offen offset:1024 sc1
  s_waitcnt vmcnt(14)
  v_mfma_f32_16x16x32_bf16 a[204:207], a[108:111], v[124:127], a[204:207]
  v_mfma_f32_16x16x32_bf16 a[220:223], a[112:115], v[124:127], a[220:223]
  v_mfma_f32_16x16x32_bf16 a[236:239], a[116:119], v[124:127], a[236:239]
  buffer_load_dwordx4 v[88:91], v2, s[16:19], s72 offen offset:2048 sc1
  s_waitcnt vmcnt(14)
  v_mfma_f32_16x16x32_bf16 a[192:195], a[120:123], v[128:131], a[192:195]
  v_mfma_f32_16x16x32_bf16 a[208:211], a[124:127], v[128:131], a[208:211]
  v_mfma_f32_16x16x32_bf16 a[224:227], a[128:131], v[128:131], a[224:227]
  buffer_load_dwordx4 v[92:95], v2, s[16:19], s72 offen offset:3072 sc1
  s_add_u32 s72, s72, 4096
  s_waitcnt vmcnt(14)
  v_mfma_f32_16x16x32_bf16 a[196:199], a[120:123], v[132:135], a[196:199]
  v_mfma_f32_16x16x32_bf16 a[212:215], a[124:127], v[132:135], a[212:215]
  v_mfma_f32_16x16x32_bf16 a[228:231], a[128:131], v[132:135], a[228:231]
  buffer_load_dwordx4 v[96:99], v2, s[16:19], s72 offen offset:0 sc1
  s_waitcnt vmcnt(14)
  v_mfma_f32_16x16x32_bf16 a[200:203], a[120:123], v[136:139], a[200:203]
  v_mfma_f32_16x16x32_bf16 a[216:219], a[124:127], v[136:139], a[216:219]
  v_mfma_f32_16x16x32_bf16 a[232:235], a[128:131], v[136:139], a[232:235]
  buffer_load_dwordx4 v[100:103], v2, s[16:19], s72 offen offset:1024 sc1
  s_waitcnt vmcnt(14)
  v_mfma_f32_16x16x32_bf16 a[204:207], a[120:123], v[140:143], a[204:207]
  v_mfma_f32_16x16x32_bf16 a[220:223], a[124:127], v[140:143], a[220:223]
  v_mfma_f32_16x16x32_bf16 a[236:239], a[128:131], v[140:143], a[236:239]
  buffer_load_dwordx4 v[104:107], v2, s[16:19], s72 offen offset:2048 sc1
  s_waitcnt vmcnt(14)
  v_mfma_f32_16x16x32_bf16 a[192:195], a[132:135], v[144:147], a[192:195]
  v_mfma_f32_16x16x32_bf16 a[208:211], a[136:139], v[144:147], a[208:211]
  v_mfma_f32_16x16x32_bf16 a[224:227], a[140:143], v[144:147], a[224:227]
  buffer_load_dwordx4 v[108:111], v2, s[16:19], s72 offen offset:3072 sc1
  s_add_u32 s72, s72, 4096
  s_waitcnt vmcnt(14)
  v_mfma_f32_16x16x32_bf16 a[196:199], a[132:135], v[148:151], a[196:199]
  v_mfma_f32_16x16x32_bf16 a[212:215], a[136:139], v[148:151], a[212:215]
  v_mfma_f32_16x16x32_bf16 a[228:231], a[140:143], v[148:151], a[228:231]
  buffer_load_dwordx4 v[112:115], v2, s[16:19], s72 offen offset:0 sc1
  s_waitcnt vmcnt(14)
  v_mfma_f32_16x16x32_bf16 a[200:203], a[132:135], v[152:155], a[200:203]
  v_mfma_f32_16x16x32_bf16 a[216:219], a[136:139], v[152:155], a[216:219]
  v_mfma_f32_16x16x32_bf16 a[232:235], a[140:143], v[152:155], a[232:235]
  buffer_load_dwordx4 v[116:119], v2, s[16:19], s72 offen offset:1024 sc1
  s_waitcnt vmcnt(14)
  v_mfma_f32_16x16x32_bf16 a[204:207], a[132:135], v[156:159], a[204:207]
  v_mfma_f32_16x16x32_bf16 a[220:223], a[136:139], v[156:159], a[220:223]
  v_mfma_f32_16x16x32_bf16 a[236:239], a[140:143], v[156:159], a[236:239]
  buffer_load_dwordx4 v[120:123], v2, s[16:19], s72 offen offset:2048 sc1
  s_waitcnt vmcnt(14)
  v_mfma_f32_16x16x32_bf16 a[192:195], a[144:147], v[64:67], a[192:195]
  v_mfma_f32_16x16x32_bf16 a[208:211], a[148:151], v[64:67], a[208:211]
  v_mfma_f32_16x16x32_bf16 a[224:227], a[152:155], v[64:67], a[224:227]
  buffer_load_dwordx4 v[124:127], v2, s[16:19], s72 offen offset:3072 sc1
  s_add_u32 s72, s72, 4096
  s_waitcnt vmcnt(14)
  v_mfma_f32_16x16x32_bf16 a[196:199], a[144:147], v[68:71], a[196:199]
  v_mfma_f32_16x16x32_bf16 a[212:215], a[148:151], v[68:71], a[212:215]
  v_mfma_f32_16x16x32_bf16 a[228:231], a[152:155], v[68:71], a[228:231]
  s_waitcnt vmcnt(13)
  v_mfma_f32_16x16x32_bf16 a[200:203], a[144:147], v[72:75], a[200:203]
  v_mfma_f32_16x16x32_bf16 a[216:219], a[148:151], v[72:75], a[216:219]
  v_mfma_f32_16x16x32_bf16 a[232:235], a[152:155], v[72:75], a[232:235]
  s_waitcnt vmcnt(12)
  v_mfma_f32_16x16x32_bf16 a[204:207], a[144:147], v[76:79], a[204:207]
  v_mfma_f32_16x16x32_bf16 a[220:223], a[148:151], v[76:79], a[220:223]
  v_mfma_f32_16x16x32_bf16 a[236:239], a[152:155], v[76:79], a[236:239]
  s_waitcnt vmcnt(11)
  v_mfma_f32_16x16x32_bf16 a[192:195], a[156:159], v[80:83], a[192:195]
  v_mfma_f32_16x16x32_bf16 a[208:211], a[160:163], v[80:83], a[208:211]
  v_mfma_f32_16x16x32_bf16 a[224:227], a[164:167], v[80:83], a[224:227]
  s_waitcnt vmcnt(10)
  v_mfma_f32_16x16x32_bf16 a[196:199], a[156:159], v[84:87], a[196:199]
  v_mfma_f32_16x16x32_bf16 a[212:215], a[160:163], v[84:87], a[212:215]
  v_mfma_f32_16x16x32_bf16 a[228:231], a[164:167], v[84:87], a[228:231]
  s_waitcnt vmcnt(9)
  v_mfma_f32_16x16x32_bf16 a[200:203], a[156:159], v[88:91], a[200:203]
  v_mfma_f32_16x16x32_bf16 a[216:219], a[160:163], v[88:91], a[216:219]
  v_mfma_f32_16x16x32_bf16 a[232:235], a[164:167], v[88:91], a[232:235]
  s_waitcnt vmcnt(8)
  v_mfma_f32_16x16x32_bf16 a[204:207], a[156:159], v[92:95], a[204:207]
  v_mfma_f32_16x16x32_bf16 a[220:223], a[160:163], v[92:95], a[220:223]
  v_mfma_f32_16x16x32_bf16 a[236:239], a[164:167], v[92:95], a[236:239]
  s_waitcnt vmcnt(7)
  v_mfma_f32_16x16x32_bf16 a[192:195], a[168:171], v[96:99], a[192:195]
  v_mfma_f32_16x16x32_bf16 a[208:211], a[172:175], v[96:99], a[208:211]
  v_mfma_f32_16x16x32_bf16 a[224:227], a[176:179], v[96:99], a[224:227]
  s_waitcnt vmcnt(6)
  v_mfma_f32_16x16x32_bf16 a[196:199], a[168:171], v[100:103], a[196:199]
  v_mfma_f32_16x16x32_bf16 a[212:215], a[172:175], v[100:103], a[212:215]
  v_mfma_f32_16x16x32_bf16 a[228:231], a[176:179], v[100:103], a[228:231]
  s_waitcnt vmcnt(5)
  v_mfma_f32_16x16x32_bf16 a[200:203], a[168:171], v[104:107], a[200:203]
  v_mfma_f32_16x16x32_bf16 a[216:219], a[172:175], v[104:107], a[216:219]
  v_mfma_f32_16x16x32_bf16 a[232:235], a[176:179], v[104:107], a[232:235]
  s_waitcnt vmcnt(4)
  v_mfma_f32_16x16x32_bf16 a[204:207], a[168:171], v[108:111], a[204:207]
  v_mfma_f32_16x16x32_bf16 a[220:223], a[172:175], v[108:111], a[220:223]
  v_mfma_f32_16x16x32_bf16 a[236:239], a[176:179], v[108:111], a[236:239]
  s_waitcnt vmcnt(3)
  v_mfma_f32_16x16x32_bf16 a[192:195], a[180:183], v[112:115], a[192:195]
  v_mfma_f32_16x16x32_bf16 a[208:211], a[184:187], v[112:115], a[208:211]
  v_mfma_f32_16x16x32_bf16 a[224:227], a[188:191], v[112:115], a[224:227]
  s_waitcnt vmcnt(2)
  v_mfma_f32_16x16x32_bf16 a[196:199], a[180:183], v[116:119], a[196:199]
  v_mfma_f32_16x16x32_bf16 a[212:215], a[184:187], v[116:119], a[212:215]
  v_mfma_f32_16x16x32_bf16 a[228:231], a[188:191], v[116:119], a[228:231]
  s_nop 1
  ds_write_b128 v13, a[192:195] offset:0
  ds_write_b128 v13, a[208:211] offset:64
  ds_write_b128 v13, a[224:227] offset:128
  s_waitcnt vmcnt(1)
  v_mfma_f32_16x16x32_bf16 a[200:203], a[180:183], v[120:123], a[200:203]
  v_mfma_f32_16x16x32_bf16 a[216:219], a[184:187], v[120:123], a[216:219]
  v_mfma_f32_16x16x32_bf16 a[232:235], a[188:191], v[120:123], a[232:235]
  ds_write_b128 v13, a[196:199] offset:3328
  ds_write_b128 v13, a[212:215] offset:3392
  ds_write_b128 v13, a[228:231] offset:3456
  s_waitcnt vmcnt(0)
  v_mfma_f32_16x16x32_bf16 a[204:207], a[180:183], v[124:127], a[204:207]
  v_mfma_f32_16x16x32_bf16 a[220:223], a[184:187], v[124:127], a[220:223]
  v_mfma_f32_16x16x32_bf16 a[236:239], a[188:191], v[124:127], a[236:239]
  ds_write_b128 v13, a[200:203] offset:6656
  ds_write_b128 v13, a[216:219] offset:6720
  ds_write_b128 v13, a[232:235] offset:6784
  s_nop 2
  ds_write_b128 v13, a[204:207] offset:9984
  ds_write_b128 v13, a[220:223] offset:10048
  ds_write_b128 v13, a[236:239] offset:10112
  s_waitcnt lgkmcnt(0)
  s_barrier
  ds_read_b128 v[64:67], v20 offset:0
  ds_read_b128 v[68:71], v20 offset:13312
  ds_read_b128 v[72:75], v20 offset:26624
  ds_read_b128 v[76:79], v20 offset:39936
  ds_read_b128 v[80:83], v21 offset:0
  ds_read_b128 v[84:87], v21 offset:13312
  ds_read_b128 v[88:91], v21 offset:26624
  ds_read_b128 v[92:95], v21 offset:39936
  ds_read_b128 v[96:99], v22 offset:0
  ds_read_b128 v[100:103], v22 offset:13312
  ds_read_b128 v[104:107], v22 offset:26624
  ds_read_b128 v[108:111], v22 offset:39936
  s_waitcnt lgkmcnt(10)
  v_add_f32 v64, v64, v68
  s_waitcnt lgkmcnt(8)
  v_add_f32 v72, v72, v76
  v_add_f32 v65, v65, v69
  v_add_f32 v73, v73, v77
  v_add_f32 v66, v66, v70
  v_add_f32 v74, v74, v78
  v_add_f32 v67, v67, v71
  v_add_f32 v75, v75, v79
  s_add_u32 m0, s86, 0
  s_add_u32 s88, s89, 0
  buffer_load_dwordx4 v40, s[28:31], s88 offen lds
  v_lshlrev_b32 v68, 16, v14
  v_and_b32 v69, 0xffff0000, v14
  v_lshlrev_b32 v70, 16, v15
  v_and_b32 v71, 0xffff0000, v15
  v_add_f32 v64, v64, v72
  v_add_f32 v65, v65, v73
  v_add_f32 v66, v66, v74
  v_add_f32 v67, v67, v75
  s_add_u32 m0, s86, 1024
  s_add_u32 s88, s89, 32768
  buffer_load_dwordx4 v41, s[28:31], s88 offen lds
  v_add_f32 v64, v64, v68
  v_add_f32 v65, v65, v69
  v_add_f32 v66, v66, v70
  v_add_f32 v67, v67, v71
  v_mul_f32 v68, v64, v64
  v_mov_b32 v72, s85
  v_mul_f32 v69, v65, v65
  v_mov_b32 v73, s85
  v_mul_f32 v70, v66, v66
  v_mov_b32 v74, s85
  v_mul_f32 v71, v67, v67
  v_mov_b32 v75, s85
  s_add_u32 m0, s86, 2048
  s_add_u32 s88, s89, 65536
  buffer_load_dwordx4 v40, s[28:31], s88 offen lds
  v_fmac_f32 v72, s84, v68
  v_fmac_f32 v73, s84, v69
  v_fmac_f32 v74, s84, v70
  v_fmac_f32 v75, s84, v71
  v_mul_f32 v72, v72, v64
  v_mul_f32 v73, v73, v65
  v_mul_f32 v74, v74, v66
  v_mul_f32 v75, v75, v67
  v_exp_f32 v72, v72
  v_exp_f32 v73, v73
  v_exp_f32 v74, v74
  v_exp_f32 v75, v75
  s_add_u32 m0, s86, 3072
  s_add_u32 s88, s89, 98304
  buffer_load_dwordx4 v41, s[28:31], s88 offen lds
  v_add_f32 v72, 1.0, v72
  v_add_f32 v73, 1.0, v73
  v_add_f32 v74, 1.0, v74
  v_add_f32 v75, 1.0, v75
  v_rcp_f32 v72, v72
  v_rcp_f32 v73, v73
  v_rcp_f32 v74, v74
  v_rcp_f32 v75, v75
  v_mul_f32 v64, v64, v72
  v_mul_f32 v65, v65, v73
  v_mul_f32 v66, v66, v74
  v_mul_f32 v67, v67, v75
  v_cvt_pk_bf16_f32 v68, v64, v65
  v_cvt_pk_bf16_f32 v69, v66, v67
  buffer_store_dwordx2 v[68:69], v11, s[16:19], s80 offen sc1
  s_waitcnt lgkmcnt(6)
  v_add_f32 v80, v80, v84
  s_waitcnt lgkmcnt(4)
  v_add_f32 v88, v88, v92
  v_add_f32 v81, v81, v85
  v_add_f32 v89, v89, v93
  v_add_f32 v82, v82, v86
  v_add_f32 v90, v90, v94
  v_add_f32 v83, v83, v87
  v_add_f32 v91, v91, v95
  s_add_u32 m0, s86, 4096
  s_add_u32 s88, s89, 131072
  buffer_load_dwordx4 v40, s[28:31], s88 offen lds
  v_lshlrev_b32 v84, 16, v16
  v_and_b32 v85, 0xffff0000, v16
  v_lshlrev_b32 v86, 16, v17
  v_and_b32 v87, 0xffff0000, v17
  v_add_f32 v80, v80, v88
  v_add_f32 v81, v81, v89
  v_add_f32 v82, v82, v90
  v_add_f32 v83, v83, v91
  s_add_u32 m0, s86, 5120
  s_add_u32 s88, s89, 163840
  buffer_load_dwordx4 v41, s[28:31], s88 offen lds
  v_add_f32 v80, v80, v84
  v_add_f32 v81, v81, v85
  v_add_f32 v82, v82, v86
  v_add_f32 v83, v83, v87
  v_mul_f32 v84, v80, v80
  v_mov_b32 v88, s85
  v_mul_f32 v85, v81, v81
  v_mov_b32 v89, s85
  v_mul_f32 v86, v82, v82
  v_mov_b32 v90, s85
  v_mul_f32 v87, v83, v83
  v_mov_b32 v91, s85
  s_add_u32 m0, s86, 6144
  s_add_u32 s88, s89, 196608
  buffer_load_dwordx4 v40, s[28:31], s88 offen lds
  v_fmac_f32 v88, s84, v84
  v_fmac_f32 v89, s84, v85
  v_fmac_f32 v90, s84, v86
  v_fmac_f32 v91, s84, v87
  v_mul_f32 v88, v88, v80
  v_mul_f32 v89, v89, v81
  v_mul_f32 v90, v90, v82
  v_mul_f32 v91, v91, v83
  v_exp_f32 v88, v88
  v_exp_f32 v89, v89
  v_exp_f32 v90, v90
  v_exp_f32 v91, v91
  s_add_u32 m0, s86, 7168
  s_add_u32 s88, s89, 229376
  buffer_load_dwordx4 v41, s[28:31], s88 offen lds
  v_add_f32 v88, 1.0, v88
  v_add_f32 v89, 1.0, v89
  v_add_f32 v90, 1.0, v90
  v_add_f32 v91, 1.0, v91
  v_rcp_f32 v88, v88
  v_rcp_f32 v89, v89
  v_rcp_f32 v90, v90
  v_rcp_f32 v91, v91
  v_mul_f32 v80, v80, v88
  v_mul_f32 v81, v81, v89
  v_mul_f32 v82, v82, v90
  v_mul_f32 v83, v83, v91
  v_cvt_pk_bf16_f32 v84, v80, v81
  v_cvt_pk_bf16_f32 v85, v82, v83
  buffer_store_dwordx2 v[84:85], v11, s[16:19], s81 offen sc1
  s_waitcnt lgkmcnt(2)
  v_add_f32 v96, v96, v100
  s_waitcnt lgkmcnt(0)
  v_add_f32 v104, v104, v108
  v_add_f32 v97, v97, v101
  v_add_f32 v105, v105, v109
  v_add_f32 v98, v98, v102
  v_add_f32 v106, v106, v110
  v_add_f32 v99, v99, v103
  v_add_f32 v107, v107, v111
  s_add_u32 m0, s86, 8192
  s_add_u32 s88, s89, 262144
  buffer_load_dwordx4 v40, s[28:31], s88 offen lds
  v_lshlrev_b32 v100, 16, v18
  v_and_b32 v101, 0xffff0000, v18
  v_lshlrev_b32 v102, 16, v19
  v_and_b32 v103, 0xffff0000, v19
  v_add_f32 v96, v96, v104
  v_add_f32 v97, v97, v105
  v_add_f32 v98, v98, v106
  v_add_f32 v99, v99, v107
  s_add_u32 m0, s86, 9216
  s_add_u32 s88, s89, 294912
  buffer_load_dwordx4 v41, s[28:31], s88 offen lds
  v_add_f32 v96, v96, v100
  v_add_f32 v97, v97, v101
  v_add_f32 v98, v98, v102
  v_add_f32 v99, v99, v103
  v_mul_f32 v100, v96, v96
  v_mov_b32 v104, s85
  v_mul_f32 v101, v97, v97
  v_mov_b32 v105, s85
  v_mul_f32 v102, v98, v98
  v_mov_b32 v106, s85
  v_mul_f32 v103, v99, v99
  v_mov_b32 v107, s85
  s_add_u32 m0, s86, 10240
  s_add_u32 s88, s89, 327680
  buffer_load_dwordx4 v40, s[28:31], s88 offen lds
  v_fmac_f32 v104, s84, v100
  v_fmac_f32 v105, s84, v101
  v_fmac_f32 v106, s84, v102
  v_fmac_f32 v107, s84, v103
  v_mul_f32 v104, v104, v96
  v_mul_f32 v105, v105, v97
  v_mul_f32 v106, v106, v98
  v_mul_f32 v107, v107, v99
  v_exp_f32 v104, v104
  v_exp_f32 v105, v105
  v_exp_f32 v106, v106
  v_exp_f32 v107, v107
  s_add_u32 m0, s86, 11264
  s_add_u32 s88, s89, 360448
  buffer_load_dwordx4 v41, s[28:31], s88 offen lds
  v_add_f32 v104, 1.0, v104
  v_add_f32 v105, 1.0, v105
  v_add_f32 v106, 1.0, v106
  v_add_f32 v107, 1.0, v107
  v_rcp_f32 v104, v104
  v_rcp_f32 v105, v105
  v_rcp_f32 v106, v106
  v_rcp_f32 v107, v107
  v_mul_f32 v96, v96, v104
  v_mul_f32 v97, v97, v105
  v_mul_f32 v98, v98, v106
  v_mul_f32 v99, v99, v107
  v_cvt_pk_bf16_f32 v100, v96, v97
  v_cvt_pk_bf16_f32 v101, v98, v99
  buffer_store_dwordx2 v[100:101], v11, s[16:19], s82 offen sc1
  s_add_u32 m0, s86, 12288
  s_add_u32 s88, s89, 393216
  buffer_load_dwordx4 v40, s[28:31], s88 offen lds
  s_add_u32 m0, s86, 13312
  s_add_u32 s88, s89, 425984
  buffer_load_dwordx4 v41, s[28:31], s88 offen lds
  s_add_u32 m0, s86, 14336
  s_add_u32 s88, s89, 458752
  buffer_load_dwordx4 v40, s[28:31], s88 offen lds
  s_add_u32 m0, s86, 15360
  s_add_u32 s88, s89, 491520
  buffer_load_dwordx4 v41, s[28:31], s88 offen lds
  s_add_u32 m0, s86, 16384
  s_add_u32 s88, s89, 524288
  buffer_load_dwordx4 v40, s[28:31], s88 offen lds
  s_add_u32 m0, s86, 17408
  s_add_u32 s88, s89, 557056
  buffer_load_dwordx4 v41, s[28:31], s88 offen lds
  s_add_u32 m0, s86, 18432
  s_add_u32 s88, s89, 589824
  buffer_load_dwordx4 v40, s[28:31], s88 offen lds
  s_add_u32 m0, s86, 19456
  s_add_u32 s88, s89, 622592
  buffer_load_dwordx4 v41, s[28:31], s88 offen lds
  s_waitcnt vmcnt(8)
  s_barrier
  s_cmp_eq_u32 s60, 0
  s_cbranch_scc0 L_pub_134
  s_lshl_b32 s70, s61, 8
  s_add_u32 s70, s70, s2
  s_lshl_b32 s70, s70, 7
  s_add_u32 s70, s70, 200704
  v_mov_b32 v4, s62
  v_mov_b32 v5, s63
  v_mov_b32 v6, s70
  s_mov_b64 exec, 1
  buffer_store_dwordx2 v[4:5], v6, s[16:19], 0 offen sc1
  s_mov_b64 exec, -1
L_pub_134:
L_m1_130:
  s_waitcnt vmcnt(0)
  s_add_u32 m0, s87, 0
  s_add_u32 s88, s89, 655360
  buffer_load_dwordx4 v40, s[28:31], s88 offen lds
  v_add_u32 v32, s86, v42
  v_add_u32 v33, s86, v43
  v_add_u32 v34, s86, v44
  v_add_u32 v35, s86, v45
  ds_read_b64_tr_b16 a[0:1], v32 offset:0
  ds_read_b64_tr_b16 a[2:3], v32 offset:512
  s_add_u32 m0, s87, 1024
  s_add_u32 s88, s89, 688128
  buffer_load_dwordx4 v41, s[28:31], s88 offen lds
  ds_read_b64_tr_b16 a[4:5], v33 offset:0
  ds_read_b64_tr_b16 a[6:7], v33 offset:512
  ds_read_b64_tr_b16 a[8:9], v34 offset:0
  ds_read_b64_tr_b16 a[10:11], v34 offset:512
  ds_read_b64_tr_b16 a[12:13], v35 offset:0
  ds_read_b64_tr_b16 a[14:15], v35 offset:512
  s_add_u32 m0, s87, 2048
  s_add_u32 s88, s89, 720896
  buffer_load_dwordx4 v40, s[28:31], s88 offen lds
  ds_read_b64_tr_b16 a[16:17], v32 offset:4096
  ds_read_b64_tr_b16 a[18:19], v32 offset:4608
  ds_read_b64_tr_b16 a[20:21], v33 offset:4096
  ds_read_b64_tr_b16 a[22:23], v33 offset:4608
  ds_read_b64_tr_b16 a[24:25], v34 offset:4096
  ds_read_b64_tr_b16 a[26:27], v34 offset:4608
  s_add_u32 m0, s87, 3072
  s_add_u32 s88, s89, 753664
  buffer_load_dwordx4 v41, s[28:31], s88 offen lds
  ds_read_b64_tr_b16 a[28:29], v35 offset:4096
  ds_read_b64_tr_b16 a[30:31], v35 offset:4608
  ds_read_b64_tr_b16 a[32:33], v32 offset:8192
  ds_read_b64_tr_b16 a[34:35], v32 offset:8704
  ds_read_b64_tr_b16 a[36:37], v33 offset:8192
  ds_read_b64_tr_b16 a[38:39], v33 offset:8704
  s_add_u32 m0, s87, 4096
  s_add_u32 s88, s89, 786432
  buffer_load_dwordx4 v40, s[28:31], s88 offen lds
  ds_read_b64_tr_b16 a[40:41], v34 offset:8192
  ds_read_b64_tr_b16 a[42:43], v34 offset:8704
  ds_read_b64_tr_b16 a[44:45], v35 offset:8192
  ds_read_b64_tr_b16 a[46:47], v35 offset:8704
  ds_read_b64_tr_b16 a[48:49], v32 offset:12288
  ds_read_b64_tr_b16 a[50:51], v32 offset:12800
  s_add_u32 m0, s87, 5120
  s_add_u32 s88, s89, 819200
  buffer_load_dwordx4 v41, s[28:31], s88 offen lds
  ds_read_b64_tr_b16 a[52:53], v33 offset:12288
  ds_read_b64_tr_b16 a[54:55], v33 offset:12800
  ds_read_b64_tr_b16 a[56:57], v34 offset:12288
  ds_read_b64_tr_b16 a[58:59], v34 offset:12800
  ds_read_b64_tr_b16 a[60:61], v35 offset:12288
  ds_read_b64_tr_b16 a[62:63], v35 offset:12800
  s_add_u32 m0, s87, 6144
  s_add_u32 s88, s89, 851968
  buffer_load_dwordx4 v40, s[28:31], s88 offen lds
  ds_read_b64_tr_b16 a[64:65], v32 offset:16384
  ds_read_b64_tr_b16 a[66:67], v32 offset:16896
  ds_read_b64_tr_b16 a[68:69], v33 offset:16384
  ds_read_b64_tr_b16 a[70:71], v33 offset:16896
  ds_read_b64_tr_b16 a[72:73], v34 offset:16384
  ds_read_b64_tr_b16 a[74:75], v34 offset:16896
  s_add_u32 m0, s87, 7168
  s_add_u32 s88, s89, 884736
  buffer_load_dwordx4 v41, s[28:31], s88 offen lds
  ds_read_b64_tr_b16 a[76:77], v35 offset:16384
  ds_read_b64_tr_b16 a[78:79], v35 offset:16896
  s_mov_b32 s32, s50
  s_mov_b32 s33, s51
  s_mov_b32 s34, 4096
  s_mov_b32 s35, 0x20000
  s_add_u32 m0, s87, 8192
  s_add_u32 s88, s89, 917504
  buffer_load_dwordx4 v40, s[28:31], s88 offen lds
  v_lshrrev_b32 v10, 3, v0
  s_lshl_b32 s72, s58, 7
  v_lshl_add_u32 v11, v10, 1, s72
  buffer_load_ushort v12, v11, s[32:35], 0 offen
  buffer_load_ushort v13, v11, s[32:35], 0 offen offset:64
  s_mul_i32 s72, s59, 176128
  s_add_u32 m0, s87, 9216
  s_add_u32 s88, s89, 950272
  buffer_load_dwordx4 v41, s[28:31], s88 offen lds
  s_lshl_b32 s73, s61, 21
  s_add_u32 s72, s72, s73
  s_add_u32 s72, s72, 17825792
  s_add_u32 s24, s56, s72
  s_addc_u32 s25, s57, 0
  s_mov_b32 s26, 176128
  s_add_u32 m0, s87, 10240
  s_add_u32 s88, s89, 983040
  buffer_load_dwordx4 v40, s[28:31], s88 offen lds
  s_mov_b32 s27, 0x20000
  v_and_b32 v3, 15, v1
  v_lshrrev_b32 v4, 4, v1
  v_and_b32 v5, 7, v1
  s_lshl_b32 s72, s60, 14
  v_add_u32 v6, 0, v4
  s_add_u32 m0, s87, 11264
  s_add_u32 s88, s89, 1015808
  buffer_load_dwordx4 v41, s[28:31], s88 offen lds
  v_xor_b32 v6, v6, v5
  v_lshlrev_b32 v6, 4, v6
  v_lshl_add_u32 v6, v3, 8, v6
  v_add_u32 v14, s72, v6
  v_add_u32 v6, 4, v4
  v_xor_b32 v6, v6, v5
  s_add_u32 m0, s87, 12288
  s_add_u32 s88, s89, 1048576
  buffer_load_dwordx4 v40, s[28:31], s88 offen lds
  v_lshlrev_b32 v6, 4, v6
  v_lshl_add_u32 v6, v3, 8, v6
  v_add_u32 v15, s72, v6
  v_add_u32 v6, 8, v4
  v_xor_b32 v6, v6, v5
  v_lshlrev_b32 v6, 4, v6
  s_add_u32 m0, s87, 13312
  s_add_u32 s88, s89, 1081344
  buffer_load_dwordx4 v41, s[28:31], s88 offen lds
  v_lshl_add_u32 v6, v3, 8, v6
  v_add_u32 v16, s72, v6
  v_add_u32 v6, 12, v4
  v_xor_b32 v6, v6, v5
  v_lshlrev_b32 v6, 4, v6
  v_lshl_add_u32 v6, v3, 8, v6
  s_add_u32 m0, s87, 14336
  s_add_u32 s88, s89, 1114112
  buffer_load_dwordx4 v40, s[28:31], s88 offen lds
  v_add_u32 v17, s72, v6
  s_add_u32 m0, s87, 15360
  s_add_u32 s88, s89, 1146880
  buffer_load_dwordx4 v41, s[28:31], s88 offen lds
  s_waitcnt lgkmcnt(0)
  v_and_b32 v3, 7, v0
  v_and_b32 v4, 7, v10
  v_lshlrev_b32 v5, 1, v3
  v_add_u32 v6, 0, v5
  v_xor_b32 v6, v6, v4
  v_lshlrev_b32 v6, 4, v6
  v_lshl_add_u32 v18, v10, 8, v6
  v_add_u32 v6, 1, v5
  v_xor_b32 v6, v6, v4
  v_lshlrev_b32 v6, 4, v6
  v_lshl_add_u32 v19, v10, 8, v6
  v_mul_u32_u24 v20, 144, v10
  v_lshl_add_u32 v20, v3, 4, v20
  v_add_u32 v20, 147456, v20
  v_lshlrev_b32 v21, 10, v10
  v_lshl_add_u32 v21, v3, 4, v21
  s_mul_i32 s72, s60, 352
  s_mul_hi_u32 s72, s72, 89478486
  s_sub_u32 s72, s72, 0
  v_add_u32 v8, s72, v1
  v_max_i32 v8, 0, v8
  v_min_u32 v8, 28, v8
  v_cmp_le_u32 vcc, 8, v8
  s_nop 1
  v_cndmask_b32 v6, 0, 1, vcc
  v_cmp_le_u32 vcc, 15, v8
  s_nop 1
  v_addc_co_u32 v6, vcc, 0, v6, vcc
  v_cmp_le_u32 vcc, 22, v8
  s_nop 1
  v_addc_co_u32 v6, vcc, 0, v6, vcc
  v_mul_u32_u24 v7, 7, v6
  v_min_u32 v9, 1, v6
  v_add_u32 v7, v7, v9
  v_sub_u32 v7, v8, v7
  s_and_b32 s72, s59, 3
  s_lshr_b32 s73, s59, 2
  v_lshl_add_u32 v7, v7, 2, s72
  v_lshlrev_b32 v7, 3, v7
  v_lshl_add_u32 v9, v6, 1, v7
  v_add_u32 v9, s73, v9
  s_lshl_b32 s70, s61, 15
  s_add_u32 s70, s70, 200704
  v_lshlrev_b32 v9, 7, v9
  v_add_u32 v9, s70, v9
  s_mov_b64 exec, 0xff
  buffer_load_dwordx2 v[26:27], v9, s[16:19], 0 offen sc1
  s_mov_b64 exec, -1
  s_add_u32 m0, s86, 0
  s_add_u32 s88, s89, 1179648
  buffer_load_dwordx4 v40, s[28:31], s88 offen lds
  s_add_u32 m0, s86, 1024
  s_add_u32 s88, s89, 1212416
  buffer_load_dwordx4 v41, s[28:31], s88 offen lds
  s_add_u32 m0, s86, 2048
  s_add_u32 s88, s89, 1245184
  buffer_load_dwordx4 v40, s[28:31], s88 offen lds
  s_add_u32 m0, s86, 3072
  s_add_u32 s88, s89, 1277952
  buffer_load_dwordx4 v41, s[28:31], s88 offen lds
  s_add_u32 m0, s86, 4096
  s_add_u32 s88, s89, 1310720
  buffer_load_dwordx4 v40, s[28:31], s88 offen lds
  s_add_u32 m0, s86, 5120
  s_add_u32 s88, s89, 1343488
  buffer_load_dwordx4 v41, s[28:31], s88 offen lds
  s_add_u32 m0, s86, 6144
  s_add_u32 s88, s89, 1376256
  buffer_load_dwordx4 v40, s[28:31], s88 offen lds
  s_add_u32 m0, s86, 7168
  s_add_u32 s88, s89, 1409024
  buffer_load_dwordx4 v41, s[28:31], s88 offen lds
  s_mov_b64 exec, 0xff
  s_waitcnt vmcnt(8)
  v_cmp_ne_u64 vcc, s[62:63], v[26:27]
  s_mov_b64 exec, -1
  s_cbranch_vccz L_upr_135
  s_mov_b64 exec, 0xff
  s_mov_b32 s100, 0
  s_cbranch_execz L_pok_137
L_poll_136:
  buffer_load_dwordx2 v[4:5], v9, s[16:19], 0 offen sc1
  s_waitcnt vmcnt(0)
  v_cmp_ne_u64 vcc, s[62:63], v[4:5]
  s_nop 0
  s_cbranch_vccz L_pok_137
  s_add_u32 s100, s100, 1
  s_cmp_lt_u32 s100, 400000
  s_cbranch_scc1 L_poll_136
  s_branch L_fail
L_pok_137:
  s_mov_b64 exec, -1
L_upr_135:
  s_mul_i32 s85, s60, 45056
  s_add_u32 s84, s85, 0
  buffer_load_dwordx4 v[64:67], v2, s[24:27], s84 offen offset:0 sc1
  v_add_u32 v32, s87, v42
  v_add_u32 v33, s87, v43
  v_add_u32 v34, s87, v44
  v_add_u32 v35, s87, v45
  buffer_load_dwordx4 v[68:71], v2, s[24:27], s84 offen offset:1024 sc1
  ds_read_b64_tr_b16 a[80:81], v32 offset:0
  ds_read_b64_tr_b16 a[82:83], v32 offset:512
  ds_read_b64_tr_b16 a[84:85], v33 offset:0
  ds_read_b64_tr_b16 a[86:87], v33 offset:512
  buffer_load_dwordx4 v[72:75], v2, s[24:27], s84 offen offset:2048 sc1
  ds_read_b64_tr_b16 a[88:89], v34 offset:0
  ds_read_b64_tr_b16 a[90:91], v34 offset:512
  ds_read_b64_tr_b16 a[92:93], v35 offset:0
  ds_read_b64_tr_b16 a[94:95], v35 offset:512
  buffer_load_dwordx4 v[76:79], v2, s[24:27], s84 offen offset:3072 sc1
  ds_read_b64_tr_b16 a[96:97], v32 offset:4096
  ds_read_b64_tr_b16 a[98:99], v32 offset:4608
  ds_read_b64_tr_b16 a[100:101], v33 offset:4096
  ds_read_b64_tr_b16 a[102:103], v33 offset:4608
  s_add_u32 s84, s85, 4096
  buffer_load_dwordx4 v[80:83], v2, s[24:27], s84 offen offset:0 sc1
  ds_read_b64_tr_b16 a[104:105], v34 offset:4096
  ds_read_b64_tr_b16 a[106:107], v34 offset:4608
  ds_read_b64_tr_b16 a[108:109], v35 offset:4096
  ds_read_b64_tr_b16 a[110:111], v35 offset:4608
  buffer_load_dwordx4 v[84:87], v2, s[24:27], s84 offen offset:1024 sc1
  ds_read_b64_tr_b16 a[112:113], v32 offset:8192
  ds_read_b64_tr_b16 a[114:115], v32 offset:8704
  ds_read_b64_tr_b16 a[116:117], v33 offset:8192
  ds_read_b64_tr_b16 a[118:119], v33 offset:8704
  buffer_load_dwordx4 v[88:91], v2, s[24:27], s84 offen offset:2048 sc1
  ds_read_b64_tr_b16 a[120:121], v34 offset:8192
  ds_read_b64_tr_b16 a[122:123], v34 offset:8704
  ds_read_b64_tr_b16 a[124:125], v35 offset:8192
  ds_read_b64_tr_b16 a[126:127], v35 offset:8704
  buffer_load_dwordx4 v[92:95], v2, s[24:27], s84 offen offset:3072 sc1
  ds_read_b64_tr_b16 a[128:129], v32 offset:12288
  ds_read_b64_tr_b16 a[130:131], v32 offset:12800
  ds_read_b64_tr_b16 a[132:133], v33 offset:12288
  ds_read_b64_tr_b16 a[134:135], v33 offset:12800
  s_add_u32 s84, s85, 8192
  buffer_load_dwordx4 v[96:99], v2, s[24:27], s84 offen offset:0 sc1
  ds_read_b64_tr_b16 a[136:137], v34 offset:12288
  ds_read_b64_tr_b16 a[138:139], v34 offset:12800
  ds_read_b64_tr_b16 a[140:141], v35 offset:12288
  ds_read_b64_tr_b16 a[142:143], v35 offset:12800
  buffer_load_dwordx4 v[100:103], v2, s[24:27], s84 offen offset:1024 sc1
  s_waitcnt vmcnt(10)
  buffer_load_dwordx4 v[104:107], v2, s[24:27], s84 offen offset:2048 sc1
  v_add_u32 v32, s86, v42
  v_add_u32 v33, s86, v43
  v_add_u32 v34, s86, v44
  v_add_u32 v35, s86, v45
  ds_read_b64_tr_b16 a[144:145], v32 offset:0
  buffer_load_dwordx4 v[108:111], v2, s[24:27], s84 offen offset:3072 sc1
  ds_read_b64_tr_b16 a[146:147], v32 offset:512
  ds_read_b64_tr_b16 a[148:149], v33 offset:0
  ds_read_b64_tr_b16 a[150:151], v33 offset:512
  ds_read_b64_tr_b16 a[152:153], v34 offset:0
  ds_read_b64_tr_b16 a[154:155], v34 offset:512
  s_add_u32 s84, s85, 12288
  buffer_load_dwordx4 v[112:115], v2, s[24:27], s84 offen offset:0 sc1
  ds_read_b64_tr_b16 a[156:157], v35 offset:0
  ds_read_b64_tr_b16 a[158:159], v35 offset:512
  ds_read_b64_tr_b16 a[160:161], v32 offset:4096
  ds_read_b64_tr_b16 a[162:163], v32 offset:4608
  ds_read_b64_tr_b16 a[164:165], v33 offset:4096
  buffer_load_dwordx4 v[116:119], v2, s[24:27], s84 offen offset:1024 sc1
  ds_read_b64_tr_b16 a[166:167], v33 offset:4608
  ds_read_b64_tr_b16 a[168:169], v34 offset:4096
  ds_read_b64_tr_b16 a[170:171], v34 offset:4608
  ds_read_b64_tr_b16 a[172:173], v35 offset:4096
  ds_read_b64_tr_b16 a[174:175], v35 offset:4608
  s_waitcnt vmcnt(13)
  v_mfma_f32_16x16x32_bf16 a[192:195], v[64:67], a[0:3], 0
  v_mfma_f32_16x16x32_bf16 a[196:199], v[64:67], a[4:7], 0
  buffer_load_dwordx4 v[120:123], v2, s[24:27], s84 offen offset:2048 sc1
  v_mfma_f32_16x16x32_bf16 a[200:203], v[64:67], a[8:11], 0
  v_mfma_f32_16x16x32_bf16 a[204:207], v[64:67], a[12:15], 0
  s_waitcnt vmcnt(13)
  v_mfma_f32_16x16x32_bf16 a[208:211], v[68:71], a[0:3], 0
  v_mfma_f32_16x16x32_bf16 a[212:215], v[68:71], a[4:7], 0
  buffer_load_dwordx4 v[124:127], v2, s[24:27], s84 offen offset:3072 sc1
  v_mfma_f32_16x16x32_bf16 a[216:219], v[68:71], a[8:11], 0
  v_mfma_f32_16x16x32_bf16 a[220:223], v[68:71], a[12:15], 0
  s_waitcnt vmcnt(13)
  v_mfma_f32_16x16x32_bf16 a[224:227], v[72:75], a[0:3], 0
  v_mfma_f32_16x16x32_bf16 a[228:231], v[72:75], a[4:7], 0
  s_add_u32 s84, s85, 16384
  buffer_load_dwordx4 v[128:131], v2, s[24:27], s84 offen offset:0 sc1
  v_mfma_f32_16x16x32_bf16 a[232:235], v[72:75], a[8:11], 0
  v_mfma_f32_16x16x32_bf16 a[236:239], v[72:75], a[12:15], 0
  s_waitcnt vmcnt(13)
  v_mfma_f32_16x16x32_bf16 a[240:243], v[76:79], a[0:3], 0
  v_mfma_f32_16x16x32_bf16 a[244:247], v[76:79], a[4:7], 0
  buffer_load_dwordx4 v[132:135], v2, s[24:27], s84 offen offset:1024 sc1
  v_mfma_f32_16x16x32_bf16 a[248:251], v[76:79], a[8:11], 0
  v_mfma_f32_16x16x32_bf16 a[252:255], v[76:79], a[12:15], 0
  s_waitcnt vmcnt(13)
  v_mfma_f32_16x16x32_bf16 a[192:195], v[80:83], a[16:19], a[192:195]
  v_mfma_f32_16x16x32_bf16 a[196:199], v[80:83], a[20:23], a[196:199]
  buffer_load_dwordx4 v[136:139], v2, s[24:27], s84 offen offset:2048 sc1
  v_mfma_f32_16x16x32_bf16 a[200:203], v[80:83], a[24:27], a[200:203]
  v_mfma_f32_16x16x32_bf16 a[204:207], v[80:83], a[28:31], a[204:207]
  s_waitcnt vmcnt(13)
  v_mfma_f32_16x16x32_bf16 a[208:211], v[84:87], a[16:19], a[208:211]
  v_mfma_f32_16x16x32_bf16 a[212:215], v[84:87], a[20:23], a[212:215]
  buffer_load_dwordx4 v[140:143], v2, s[24:27], s84 offen offset:3072 sc1
  v_mfma_f32_16x16x32_bf16 a[216:219], v[84:87], a[24:27], a[216:219]
  v_mfma_f32_16x16x32_bf16 a[220:223], v[84:87], a[28:31], a[220:223]
  s_waitcnt vmcnt(13)
  v_mfma_f32_16x16x32_bf16 a[224:227], v[88:91], a[16:19], a[224:227]
  v_mfma_f32_16x16x32_bf16 a[228:231], v[88:91], a[20:23], a[228:231]
  s_add_u32 s84, s85, 20480
  buffer_load_dwordx4 v[144:147], v2, s[24:27], s84 offen offset:0 sc1
  v_mfma_f32_16x16x32_bf16 a[232:235], v[88:91], a[24:27], a[232:235]
  v_mfma_f32_16x16x32_bf16 a[236:239], v[88:91], a[28:31], a[236:239]
  s_waitcnt vmcnt(13)
  v_mfma_f32_16x16x32_bf16 a[240:243], v[92:95], a[16:19], a[240:243]
  v_mfma_f32_16x16x32_bf16 a[244:247], v[92:95], a[20:23], a[244:247]
  buffer_load_dwordx4 v[148:151], v2, s[24:27], s84 offen offset:1024 sc1
  v_mfma_f32_16x16x32_bf16 a[248:251], v[92:95], a[24:27], a[248:251]
  v_mfma_f32_16x16x32_bf16 a[252:255], v[92:95], a[28:31], a[252:255]
  s_waitcnt vmcnt(13)
  v_mfma_f32_16x16x32_bf16 a[192:195], v[96:99], a[32:35], a[192:195]
  v_mfma_f32_16x16x32_bf16 a[196:199], v[96:99], a[36:39], a[196:199]
  buffer_load_dwordx4 v[152:155], v2, s[24:27], s84 offen offset:2048 sc1
  v_mfma_f32_16x16x32_bf16 a[200:203], v[96:99], a[40:43], a[200:203]
  v_mfma_f32_16x16x32_bf16 a[204:207], v[96:99], a[44:47], a[204:207]
  s_waitcnt vmcnt(13)
  v_mfma_f32_16x16x32_bf16 a[208:211], v[100:103], a[32:35], a[208:211]
  v_mfma_f32_16x16x32_bf16 a[212:215], v[100:103], a[36:39], a[212:215]
  buffer_load_dwordx4 v[156:159], v2, s[24:27], s84 offen offset:3072 sc1
  v_mfma_f32_16x16x32_bf16 a[216:219], v[100:103], a[40:43], a[216:219]
  v_mfma_f32_16x16x32_bf16 a[220:223], v[100:103], a[44:47], a[220:223]
  s_waitcnt vmcnt(13)
  v_mfma_f32_16x16x32_bf16 a[224:227], v[104:107], a[32:35], a[224:227]
  v_mfma_f32_16x16x32_bf16 a[228:231], v[104:107], a[36:39], a[228:231]
  s_add_u32 s84, s85, 24576
  buffer_load_dwordx4 v[160:163], v2, s[24:27], s84 offen offset:0 sc1
  v_mfma_f32_16x16x32_bf16 a[232:235], v[104:107], a[40:43], a[232:235]
  v_mfma_f32_16x16x32_bf16 a[236:239], v[104:107], a[44:47], a[236:239]
  s_waitcnt vmcnt(13)
  v_mfma_f32_16x16x32_bf16 a[240:243], v[108:111], a[32:35], a[240:243]
  v_mfma_f32_16x16x32_bf16 a[244:247], v[108:111], a[36:39], a[244:247]
  buffer_load_dwordx4 v[164:167], v2, s[24:27], s84 offen offset:1024 sc1
  v_mfma_f32_16x16x32_bf16 a[248:251], v[108:111], a[40:43], a[248:251]
  v_mfma_f32_16x16x32_bf16 a[252:255], v[108:111], a[44:47], a[252:255]
  s_waitcnt vmcnt(13)
  v_mfma_f32_16x16x32_bf16 a[192:195], v[112:115], a[48:51], a[192:195]
  v_mfma_f32_16x16x32_bf16 a[196:199], v[112:115], a[52:55], a[196:199]
  buffer_load_dwordx4 v[168:171], v2, s[24:27], s84 offen offset:2048 sc1
  v_mfma_f32_16x16x32_bf16 a[200:203], v[112:115], a[56:59], a[200:203]
  v_mfma_f32_16x16x32_bf16 a[204:207], v[112:115], a[60:63], a[204:207]
  s_waitcnt vmcnt(13)
  v_mfma_f32_16x16x32_bf16 a[208:211], v[116:119], a[48:51], a[208:211]
  v_mfma_f32_16x16x32_bf16 a[212:215], v[116:119], a[52:55], a[212:215]
  buffer_load_dwordx4 v[172:175], v2, s[24:27], s84 offen offset:3072 sc1
  v_mfma_f32_16x16x32_bf16 a[216:219], v[116:119], a[56:59], a[216:219]
  v_mfma_f32_16x16x32_bf16 a[220:223], v[116:119], a[60:63], a[220:223]
  s_waitcnt vmcnt(13)
  v_mfma_f32_16x16x32_bf16 a[224:227], v[120:123], a[48:51], a[224:227]
  v_mfma_f32_16x16x32_bf16 a[228:231], v[120:123], a[52:55], a[228:231]
  s_add_u32 s84, s85, 28672
  buffer_load_dwordx4 v[176:179], v2, s[24:27], s84 offen offset:0 sc1
  v_mfma_f32_16x16x32_bf16 a[232:235], v[120:123], a[56:59], a[232:235]
  v_mfma_f32_16x16x32_bf16 a[236:239], v[120:123], a[60:63], a[236:239]
  s_waitcnt vmcnt(13)
  v_mfma_f32_16x16x32_bf16 a[240:243], v[124:127], a[48:51], a[240:243]
  v_mfma_f32_16x16x32_bf16 a[244:247], v[124:127], a[52:55], a[244:247]
  buffer_load_dwordx4 v[180:183], v2, s[24:27], s84 offen offset:1024 sc1
  v_mfma_f32_16x16x32_bf16 a[248:251], v[124:127], a[56:59], a[248:251]
  v_mfma_f32_16x16x32_bf16 a[252:255], v[124:127], a[60:63], a[252:255]
  s_waitcnt vmcnt(13)
  v_mfma_f32_16x16x32_bf16 a[192:195], v[128:131], a[64:67], a[192:195]
  v_mfma_f32_16x16x32_bf16 a[196:199], v[128:131], a[68:71], a[196:199]
  buffer_load_dwordx4 v[184:187], v2, s[24:27], s84 offen offset:2048 sc1
  v_mfma_f32_16x16x32_bf16 a[200:203], v[128:131], a[72:75], a[200:203]
  v_mfma_f32_16x16x32_bf16 a[204:207], v[128:131], a[76:79], a[204:207]
  s_waitcnt vmcnt(13)
  v_mfma_f32_16x16x32_bf16 a[208:211], v[132:135], a[64:67], a[208:211]
  v_mfma_f32_16x16x32_bf16 a[212:215], v[132:135], a[68:71], a[212:215]
  buffer_load_dwordx4 v[188:191], v2, s[24:27], s84 offen offset:3072 sc1
  v_mfma_f32_16x16x32_bf16 a[216:219], v[132:135], a[72:75], a[216:219]
  v_mfma_f32_16x16x32_bf16 a[220:223], v[132:135], a[76:79], a[220:223]
  s_waitcnt vmcnt(13)
  v_mfma_f32_16x16x32_bf16 a[224:227], v[136:139], a[64:67], a[224:227]
  v_mfma_f32_16x16x32_bf16 a[228:231], v[136:139], a[68:71], a[228:231]
  s_add_u32 s84, s85, 32768
  buffer_load_dwordx4 v[192:195], v2, s[24:27], s84 offen offset:0 sc1
  v_mfma_f32_16x16x32_bf16 a[232:235], v[136:139], a[72:75], a[232:235]
  v_mfma_f32_16x16x32_bf16 a[236:239], v[136:139], a[76:79], a[236:239]
  s_waitcnt vmcnt(13)
  v_mfma_f32_16x16x32_bf16 a[240:243], v[140:143], a[64:67], a[240:243]
  v_mfma_f32_16x16x32_bf16 a[244:247], v[140:143], a[68:71], a[244:247]
  buffer_load_dwordx4 v[196:199], v2, s[24:27], s84 offen offset:1024 sc1
  v_mfma_f32_16x16x32_bf16 a[248:251], v[140:143], a[72:75], a[248:251]
  v_mfma_f32_16x16x32_bf16 a[252:255], v[140:143], a[76:79], a[252:255]
  s_waitcnt vmcnt(13) lgkmcnt(15)
  v_mfma_f32_16x16x32_bf16 a[192:195], v[144:147], a[80:83], a[192:195]
  s_waitcnt lgkmcnt(15)
  v_mfma_f32_16x16x32_bf16 a[196:199], v[144:147], a[84:87], a[196:199]
  buffer_load_dwordx4 v[200:203], v2, s[24:27], s84 offen offset:2048 sc1
  s_waitcnt lgkmcnt(15)
  v_mfma_f32_16x16x32_bf16 a[200:203], v[144:147], a[88:91], a[200:203]
  s_waitcnt lgkmcnt(15)
  v_mfma_f32_16x16x32_bf16 a[204:207], v[144:147], a[92:95], a[204:207]
  s_waitcnt vmcnt(13)
  v_mfma_f32_16x16x32_bf16 a[208:211], v[148:151], a[80:83], a[208:211]
  v_mfma_f32_16x16x32_bf16 a[212:215], v[148:151], a[84:87], a[212:215]
  buffer_load_dwordx4 v[204:207], v2, s[24:27], s84 offen offset:3072 sc1
  v_mfma_f32_16x16x32_bf16 a[216:219], v[148:151], a[88:91], a[216:219]
  v_mfma_f32_16x16x32_bf16 a[220:223], v[148:151], a[92:95], a[220:223]
  s_waitcnt vmcnt(13)
  v_mfma_f32_16x16x32_bf16 a[224:227], v[152:155], a[80:83], a[224:227]
  v_mfma_f32_16x16x32_bf16 a[228:231], v[152:155], a[84:87], a[228:231]
  s_add_u32 s84, s85, 36864
  buffer_load_dwordx4 v[208:211], v2, s[24:27], s84 offen offset:0 sc1
  v_mfma_f32_16x16x32_bf16 a[232:235], v[152:155], a[88:91], a[232:235]
  v_mfma_f32_16x16x32_bf16 a[236:239], v[152:155], a[92:95], a[236:239]
  s_waitcnt vmcnt(13)
  v_mfma_f32_16x16x32_bf16 a[240:243], v[156:159], a[80:83], a[240:243]
  v_mfma_f32_16x16x32_bf16 a[244:247], v[156:159], a[84:87], a[244:247]
  buffer_load_dwordx4 v[212:215], v2, s[24:27], s84 offen offset:1024 sc1
  v_mfma_f32_16x16x32_bf16 a[248:251], v[156:159], a[88:91], a[248:251]
  v_mfma_f32_16x16x32_bf16 a[252:255], v[156:159], a[92:95], a[252:255]
  s_waitcnt vmcnt(13) lgkmcnt(15)
  v_mfma_f32_16x16x32_bf16 a[192:195], v[160:163], a[96:99], a[192:195]
  s_waitcnt lgkmcnt(15)
  v_mfma_f32_16x16x32_bf16 a[196:199], v[160:163], a[100:103], a[196:199]
  buffer_load_dwordx4 v[216:219], v2, s[24:27], s84 offen offset:2048 sc1
  s_waitcnt lgkmcnt(15)
  v_mfma_f32_16x16x32_bf16 a[200:203], v[160:163], a[104:107], a[200:203]
  s_waitcnt lgkmcnt(15)
  v_mfma_f32_16x16x32_bf16 a[204:207], v[160:163], a[108:111], a[204:207]
  s_waitcnt vmcnt(13)
  v_mfma_f32_16x16x32_bf16 a[208:211], v[164:167], a[96:99], a[208:211]
  v_mfma_f32_16x16x32_bf16 a[212:215], v[164:167], a[100:103], a[212:215]
  buffer_load_dwordx4 v[220:223], v2, s[24:27], s84 offen offset:3072 sc1
  v_mfma_f32_16x16x32_bf16 a[216:219], v[164:167], a[104:107], a[216:219]
  v_mfma_f32_16x16x32_bf16 a[220:223], v[164:167], a[108:111], a[220:223]
  s_waitcnt vmcnt(13)
  v_mfma_f32_16x16x32_bf16 a[224:227], v[168:171], a[96:99], a[224:227]
  v_mfma_f32_16x16x32_bf16 a[228:231], v[168:171], a[100:103], a[228:231]
  s_add_u32 s84, s85, 40960
  buffer_load_dwordx4 v[224:227], v2, s[24:27], s84 offen offset:0 sc1
  v_mfma_f32_16x16x32_bf16 a[232:235], v[168:171], a[104:107], a[232:235]
  v_mfma_f32_16x16x32_bf16 a[236:239], v[168:171], a[108:111], a[236:239]
  s_waitcnt vmcnt(13)
  v_mfma_f32_16x16x32_bf16 a[240:243], v[172:175], a[96:99], a[240:243]
  v_mfma_f32_16x16x32_bf16 a[244:247], v[172:175], a[100:103], a[244:247]
  buffer_load_dwordx4 v[228:231], v2, s[24:27], s84 offen offset:1024 sc1
  v_mfma_f32_16x16x32_bf16 a[248:251], v[172:175], a[104:107], a[248:251]
  v_mfma_f32_16x16x32_bf16 a[252:255], v[172:175], a[108:111], a[252:255]
  s_waitcnt vmcnt(13) lgkmcnt(15)
  v_mfma_f32_16x16x32_bf16 a[192:195], v[176:179], a[112:115], a[192:195]
  s_waitcnt lgkmcnt(15)
  v_mfma_f32_16x16x32_bf16 a[196:199], v[176:179], a[116:119], a[196:199]
  buffer_load_dwordx4 v[232:235], v2, s[24:27], s84 offen offset:2048 sc1
  s_waitcnt lgkmcnt(15)
  v_mfma_f32_16x16x32_bf16 a[200:203], v[176:179], a[120:123], a[200:203]
  s_waitcnt lgkmcnt(15)
  v_mfma_f32_16x16x32_bf16 a[204:207], v[176:179], a[124:127], a[204:207]
  s_waitcnt vmcnt(13)
  v_mfma_f32_16x16x32_bf16 a[208:211], v[180:183], a[112:115], a[208:211]
  v_mfma_f32_16x16x32_bf16 a[212:215], v[180:183], a[116:119], a[212:215]
  buffer_load_dwordx4 v[236:239], v2, s[24:27], s84 offen offset:3072 sc1
  v_mfma_f32_16x16x32_bf16 a[216:219], v[180:183], a[120:123], a[216:219]
  v_mfma_f32_16x16x32_bf16 a[220:223], v[180:183], a[124:127], a[220:223]
  s_waitcnt vmcnt(13)
  v_mfma_f32_16x16x32_bf16 a[224:227], v[184:187], a[112:115], a[224:227]
  v_mfma_f32_16x16x32_bf16 a[228:231], v[184:187], a[116:119], a[228:231]
  v_mfma_f32_16x16x32_bf16 a[232:235], v[184:187], a[120:123], a[232:235]
  v_mfma_f32_16x16x32_bf16 a[236:239], v[184:187], a[124:127], a[236:239]
  s_waitcnt vmcnt(12)
  v_mfma_f32_16x16x32_bf16 a[240:243], v[188:191], a[112:115], a[240:243]
  v_mfma_f32_16x16x32_bf16 a[244:247], v[188:191], a[116:119], a[244:247]
  v_mfma_f32_16x16x32_bf16 a[248:251], v[188:191], a[120:123], a[248:251]
  v_mfma_f32_16x16x32_bf16 a[252:255], v[188:191], a[124:127], a[252:255]
  s_waitcnt vmcnt(11) lgkmcnt(15)
  v_mfma_f32_16x16x32_bf16 a[192:195], v[192:195], a[128:131], a[192:195]
  s_waitcnt lgkmcnt(15)
  v_mfma_f32_16x16x32_bf16 a[196:199], v[192:195], a[132:135], a[196:199]
  s_waitcnt lgkmcnt(15)
  v_mfma_f32_16x16x32_bf16 a[200:203], v[192:195], a[136:139], a[200:203]
  s_waitcnt lgkmcnt(15)
  v_mfma_f32_16x16x32_bf16 a[204:207], v[192:195], a[140:143], a[204:207]
  s_waitcnt vmcnt(10)
  v_mfma_f32_16x16x32_bf16 a[208:211], v[196:199], a[128:131], a[208:211]
  v_mfma_f32_16x16x32_bf16 a[212:215], v[196:199], a[132:135], a[212:215]
  v_mfma_f32_16x16x32_bf16 a[216:219], v[196:199], a[136:139], a[216:219]
  v_mfma_f32_16x16x32_bf16 a[220:223], v[196:199], a[140:143], a[220:223]
  s_waitcnt vmcnt(9)
  v_mfma_f32_16x16x32_bf16 a[224:227], v[200:203], a[128:131], a[224:227]
  v_mfma_f32_16x16x32_bf16 a[228:231], v[200:203], a[132:135], a[228:231]
  v_mfma_f32_16x16x32_bf16 a[232:235], v[200:203], a[136:139], a[232:235]
  v_mfma_f32_16x16x32_bf16 a[236:239], v[200:203], a[140:143], a[236:239]
  s_waitcnt vmcnt(8)
  v_mfma_f32_16x16x32_bf16 a[240:243], v[204:207], a[128:131], a[240:243]
  v_mfma_f32_16x16x32_bf16 a[244:247], v[204:207], a[132:135], a[244:247]
  v_mfma_f32_16x16x32_bf16 a[248:251], v[204:207], a[136:139], a[248:251]
  v_mfma_f32_16x16x32_bf16 a[252:255], v[204:207], a[140:143], a[252:255]
  s_waitcnt vmcnt(7) lgkmcnt(14)
  v_mfma_f32_16x16x32_bf16 a[192:195], v[208:211], a[144:147], a[192:195]
  s_waitcnt lgkmcnt(12)
  v_mfma_f32_16x16x32_bf16 a[196:199], v[208:211], a[148:151], a[196:199]
  s_waitcnt lgkmcnt(10)
  v_mfma_f32_16x16x32_bf16 a[200:203], v[208:211], a[152:155], a[200:203]
  s_waitcnt lgkmcnt(8)
  v_mfma_f32_16x16x32_bf16 a[204:207], v[208:211], a[156:159], a[204:207]
  s_waitcnt vmcnt(6)
  v_mfma_f32_16x16x32_bf16 a[208:211], v[212:215], a[144:147], a[208:211]
  v_mfma_f32_16x16x32_bf16 a[212:215], v[212:215], a[148:151], a[212:215]
  v_mfma_f32_16x16x32_bf16 a[216:219], v[212:215], a[152:155], a[216:219]
  v_mfma_f32_16x16x32_bf16 a[220:223], v[212:215], a[156:159], a[220:223]
  s_waitcnt vmcnt(5)
  v_mfma_f32_16x16x32_bf16 a[224:227], v[216:219], a[144:147], a[224:227]
  v_mfma_f32_16x16x32_bf16 a[228:231], v[216:219], a[148:151], a[228:231]
  v_mfma_f32_16x16x32_bf16 a[232:235], v[216:219], a[152:155], a[232:235]
  v_mfma_f32_16x16x32_bf16 a[236:239], v[216:219], a[156:159], a[236:239]
  s_waitcnt vmcnt(4)
  v_mfma_f32_16x16x32_bf16 a[240:243], v[220:223], a[144:147], a[240:243]
  v_mfma_f32_16x16x32_bf16 a[244:247], v[220:223], a[148:151], a[244:247]
  v_mfma_f32_16x16x32_bf16 a[248:251], v[220:223], a[152:155], a[248:251]
  v_mfma_f32_16x16x32_bf16 a[252:255], v[220:223], a[156:159], a[252:255]
  s_waitcnt vmcnt(3) lgkmcnt(6)
  v_mfma_f32_16x16x32_bf16 a[192:195], v[224:227], a[160:163], a[192:195]
  s_waitcnt lgkmcnt(4)
  v_mfma_f32_16x16x32_bf16 a[196:199], v[224:227], a[164:167], a[196:199]
  s_waitcnt lgkmcnt(2)
  v_mfma_f32_16x16x32_bf16 a[200:203], v[224:227], a[168:171], a[200:203]
  s_waitcnt lgkmcnt(0)
  v_mfma_f32_16x16x32_bf16 a[204:207], v[224:227], a[172:175], a[204:207]
  s_waitcnt vmcnt(2)
  v_mfma_f32_16x16x32_bf16 a[208:211], v[228:231], a[160:163], a[208:211]
  v_mfma_f32_16x16x32_bf16 a[212:215], v[228:231], a[164:167], a[212:215]
  v_mfma_f32_16x16x32_bf16 a[216:219], v[228:231], a[168:171], a[216:219]
  v_mfma_f32_16x16x32_bf16 a[220:223], v[228:231], a[172:175], a[220:223]
  ds_write_b128 v14, a[192:195] offset:0
  ds_write_b128 v14, a[196:199] offset:4096
  ds_write_b128 v14, a[200:203] offset:8192
  ds_write_b128 v14, a[204:207] offset:12288
  s_waitcnt vmcnt(1)
  v_mfma_f32_16x16x32_bf16 a[224:227], v[232:235], a[160:163], a[224:227]
  v_mfma_f32_16x16x32_bf16 a[228:231], v[232:235], a[164:167], a[228:231]
  v_mfma_f32_16x16x32_bf16 a[232:235], v[232:235], a[168:171], a[232:235]
  v_mfma_f32_16x16x32_bf16 a[236:239], v[232:235], a[172:175], a[236:239]
  ds_write_b128 v15, a[208:211] offset:0
  ds_write_b128 v15, a[212:215] offset:4096
  ds_write_b128 v15, a[216:219] offset:8192
  ds_write_b128 v15, a[220:223] offset:12288
  s_waitcnt vmcnt(0)
  v_mfma_f32_16x16x32_bf16 a[240:243], v[236:239], a[160:163], a[240:243]
  v_mfma_f32_16x16x32_bf16 a[244:247], v[236:239], a[164:167], a[244:247]
  v_mfma_f32_16x16x32_bf16 a[248:251], v[236:239], a[168:171], a[248:251]
  v_mfma_f32_16x16x32_bf16 a[252:255], v[236:239], a[172:175], a[252:255]
  ds_write_b128 v16, a[224:227] offset:0
  ds_write_b128 v16, a[228:231] offset:4096
  ds_write_b128 v16, a[232:235] offset:8192
  ds_write_b128 v16, a[236:239] offset:12288
  s_nop 0
  ds_write_b128 v17, a[240:243] offset:0
  ds_write_b128 v17, a[244:247] offset:4096
  ds_write_b128 v17, a[248:251] offset:8192
  ds_write_b128 v17, a[252:255] offset:12288
  s_waitcnt lgkmcnt(0)
  s_barrier
  s_lshl_b32 s72, s58, 16
  s_lshl_b32 s73, s59, 7
  s_add_u32 s72, s72, s73
  ds_read_b128 v[64:67], v18 offset:0
  ds_read_b128 v[68:71], v19 offset:0
  ds_read_b128 v[72:75], v18 offset:16384
  ds_read_b128 v[76:79], v19 offset:16384
  ds_read_b128 v[80:83], v18 offset:32768
  ds_read_b128 v[84:87], v19 offset:32768
  ds_read_b128 v[88:91], v18 offset:49152
  ds_read_b128 v[92:95], v19 offset:49152
  ds_read_b128 v[96:99], v20 offset:0
  ds_read_b128 v[112:115], v18 offset:8192
  ds_read_b128 v[116:119], v19 offset:8192
  ds_read_b128 v[120:123], v18 offset:24576
  ds_read_b128 v[124:127], v19 offset:24576
  ds_read_b128 v[128:131], v18 offset:40960
  ds_read_b128 v[132:135], v19 offset:40960
  ds_read_b128 v[136:139], v18 offset:57344
  ds_read_b128 v[140:143], v19 offset:57344
  ds_read_b128 v[144:147], v20 offset:4608
  v_lshlrev_b32 v22, 16, v12
  s_waitcnt lgkmcnt(15)
  v_add_f32 v64, v64, v72
  s_waitcnt lgkmcnt(11)
  v_add_f32 v80, v80, v88
  v_add_f32 v65, v65, v73
  v_add_f32 v81, v81, v89
  v_add_f32 v66, v66, v74
  v_add_f32 v82, v82, v90
  v_add_f32 v67, v67, v75
  v_add_f32 v83, v83, v91
  v_add_f32 v68, v68, v76
  s_waitcnt lgkmcnt(10)
  v_add_f32 v84, v84, v92
  v_add_f32 v69, v69, v77
  v_add_f32 v85, v85, v93
  v_add_f32 v70, v70, v78
  v_add_f32 v86, v86, v94
  v_add_f32 v71, v71, v79
  v_add_f32 v87, v87, v95
  v_add_f32 v64, v64, v80
  v_add_f32 v65, v65, v81
  v_add_f32 v66, v66, v82
  v_add_f32 v67, v67, v83
  v_add_f32 v68, v68, v84
  v_add_f32 v69, v69, v85
  v_add_f32 v70, v70, v86
  v_add_f32 v71, v71, v87
  v_add_f32 v64, v64, v22
  v_add_f32 v65, v65, v22
  v_add_f32 v66, v66, v22
  v_add_f32 v67, v67, v22
  v_add_f32 v68, v68, v22
  v_add_f32 v69, v69, v22
  v_add_f32 v70, v70, v22
  v_add_f32 v71, v71, v22
  s_waitcnt lgkmcnt(9)
  v_lshlrev_b32 v72, 16, v96
  v_and_b32 v73, 0xffff0000, v96
  v_lshlrev_b32 v74, 16, v97
  v_and_b32 v75, 0xffff0000, v97
  v_lshlrev_b32 v76, 16, v98
  v_and_b32 v77, 0xffff0000, v98
  v_lshlrev_b32 v78, 16, v99
  v_and_b32 v79, 0xffff0000, v99
  v_add_f32 v64, v64, v72
  v_add_f32 v65, v65, v73
  v_add_f32 v66, v66, v74
  v_add_f32 v67, v67, v75
  v_add_f32 v68, v68, v76
  v_add_f32 v69, v69, v77
  v_add_f32 v70, v70, v78
  v_add_f32 v71, v71, v79
  v_cvt_pk_bf16_f32 v100, v64, v65
  v_cvt_pk_bf16_f32 v101, v66, v67
  v_cvt_pk_bf16_f32 v102, v68, v69
  v_cvt_pk_bf16_f32 v103, v70, v71
  buffer_store_dwordx4 v[100:103], v21, s[20:23], s72 offen sc1
  s_add_u32 s72, s72, 32768
  v_lshlrev_b32 v22, 16, v13
  s_waitcnt lgkmcnt(6)
  v_add_f32 v112, v112, v120
  s_waitcnt lgkmcnt(2)
  v_add_f32 v128, v128, v136
  v_add_f32 v113, v113, v121
  v_add_f32 v129, v129, v137
  v_add_f32 v114, v114, v122
  v_add_f32 v130, v130, v138
  v_add_f32 v115, v115, v123
  v_add_f32 v131, v131, v139
  v_add_f32 v116, v116, v124
  s_waitcnt lgkmcnt(1)
  v_add_f32 v132, v132, v140
  v_add_f32 v117, v117, v125
  v_add_f32 v133, v133, v141
  v_add_f32 v118, v118, v126
  v_add_f32 v134, v134, v142
  v_add_f32 v119, v119, v127
  v_add_f32 v135, v135, v143
  v_add_f32 v112, v112, v128
  v_add_f32 v113, v113, v129
  v_add_f32 v114, v114, v130
  v_add_f32 v115, v115, v131
  v_add_f32 v116, v116, v132
  v_add_f32 v117, v117, v133
  v_add_f32 v118, v118, v134
  v_add_f32 v119, v119, v135
  v_add_f32 v112, v112, v22
  v_add_f32 v113, v113, v22
  v_add_f32 v114, v114, v22
  v_add_f32 v115, v115, v22
  v_add_f32 v116, v116, v22
  v_add_f32 v117, v117, v22
  v_add_f32 v118, v118, v22
  v_add_f32 v119, v119, v22
  s_waitcnt lgkmcnt(0)
  v_lshlrev_b32 v120, 16, v144
  v_and_b32 v121, 0xffff0000, v144
  v_lshlrev_b32 v122, 16, v145
  v_and_b32 v123, 0xffff0000, v145
  v_lshlrev_b32 v124, 16, v146
  v_and_b32 v125, 0xffff0000, v146
  v_lshlrev_b32 v126, 16, v147
  v_and_b32 v127, 0xffff0000, v147
  v_add_f32 v112, v112, v120
  v_add_f32 v113, v113, v121
  v_add_f32 v114, v114, v122
  v_add_f32 v115, v115, v123
  v_add_f32 v116, v116, v124
  v_add_f32 v117, v117, v125
  v_add_f32 v118, v118, v126
  v_add_f32 v119, v119, v127
  v_cvt_pk_bf16_f32 v148, v112, v113
  v_cvt_pk_bf16_f32 v149, v114, v115
  v_cvt_pk_bf16_f32 v150, v116, v117
  v_cvt_pk_bf16_f32 v151, v118, v119
  buffer_store_dwordx4 v[148:151], v21, s[20:23], s72 offen sc1
  s_endpgm
  s_branch L_end
L_oa_48:
  s_add_u32 s73, s74, 8192
  buffer_load_dwordx4 v[108:111], v2, s[16:19], s73 offen offset:3072 sc1
  s_waitcnt vmcnt(11)
  v_mfma_f32_16x16x32_bf16 v[46:49], v[128:131], v[64:67], 0
  v_mfma_f32_16x16x32_bf16 v[50:53], v[132:135], v[64:67], 0
  v_mfma_f32_16x16x32_bf16 v[54:57], v[136:139], v[64:67], 0
  v_mfma_f32_16x16x32_bf16 v[58:61], v[140:143], v[64:67], 0
  s_add_u32 s73, s74, 12288
  buffer_load_dwordx4 v[112:115], v2, s[16:19], s73 offen offset:0 sc1
  s_waitcnt vmcnt(11)
  v_mfma_f32_16x16x32_bf16 v[46:49], v[144:147], v[68:71], v[46:49]
  v_mfma_f32_16x16x32_bf16 v[50:53], v[148:151], v[68:71], v[50:53]
  v_mfma_f32_16x16x32_bf16 v[54:57], v[152:155], v[68:71], v[54:57]
  v_mfma_f32_16x16x32_bf16 v[58:61], v[156:159], v[68:71], v[58:61]
  buffer_load_dwordx4 v[116:119], v2, s[16:19], s73 offen offset:1024 sc1
  s_waitcnt vmcnt(11)
  v_mfma_f32_16x16x32_bf16 v[46:49], v[160:163], v[72:75], v[46:49]
  v_mfma_f32_16x16x32_bf16 v[50:53], v[164:167], v[72:75], v[50:53]
  v_mfma_f32_16x16x32_bf16 v[54:57], v[168:171], v[72:75], v[54:57]
  v_mfma_f32_16x16x32_bf16 v[58:61], v[172:175], v[72:75], v[58:61]
  buffer_load_dwordx4 v[120:123], v2, s[16:19], s73 offen offset:2048 sc1
  s_waitcnt vmcnt(11)
  v_mfma_f32_16x16x32_bf16 v[46:49], v[176:179], v[76:79], v[46:49]
  v_mfma_f32_16x16x32_bf16 v[50:53], v[180:183], v[76:79], v[50:53]
  v_mfma_f32_16x16x32_bf16 v[54:57], v[184:187], v[76:79], v[54:57]
  v_mfma_f32_16x16x32_bf16 v[58:61], v[188:191], v[76:79], v[58:61]
  buffer_load_dwordx4 v[124:127], v2, s[16:19], s73 offen offset:3072 sc1
  s_waitcnt vmcnt(11)
  v_mfma_f32_16x16x32_bf16 v[46:49], v[192:195], v[80:83], v[46:49]
  v_mfma_f32_16x16x32_bf16 v[50:53], v[196:199], v[80:83], v[50:53]
  v_mfma_f32_16x16x32_bf16 v[54:57], v[200:203], v[80:83], v[54:57]
  v_mfma_f32_16x16x32_bf16 v[58:61], v[204:207], v[80:83], v[58:61]
  s_waitcnt vmcnt(10)
  v_mfma_f32_16x16x32_bf16 v[46:49], v[208:211], v[84:87], v[46:49]
  v_mfma_f32_16x16x32_bf16 v[50:53], v[212:215], v[84:87], v[50:53]
  v_mfma_f32_16x16x32_bf16 v[54:57], v[216:219], v[84:87], v[54:57]
  v_mfma_f32_16x16x32_bf16 v[58:61], v[220:223], v[84:87], v[58:61]
  s_waitcnt vmcnt(9)
  v_mfma_f32_16x16x32_bf16 v[46:49], v[224:227], v[88:91], v[46:49]
  ds_read_b64_tr_b16 v[14:15], v10 offset:32768
  ds_read_b64_tr_b16 v[16:17], v10 offset:33792
  v_mfma_f32_16x16x32_bf16 v[50:53], v[228:231], v[88:91], v[50:53]
  ds_read_b64_tr_b16 v[18:19], v11 offset:32768
  ds_read_b64_tr_b16 v[20:21], v11 offset:33792
  v_mfma_f32_16x16x32_bf16 v[54:57], v[232:235], v[88:91], v[54:57]
  ds_read_b64_tr_b16 v[22:23], v12 offset:32768
  ds_read_b64_tr_b16 v[24:25], v12 offset:33792
  v_mfma_f32_16x16x32_bf16 v[58:61], v[236:239], v[88:91], v[58:61]
  ds_read_b64_tr_b16 v[26:27], v13 offset:32768
  ds_read_b64_tr_b16 v[28:29], v13 offset:33792
  s_waitcnt vmcnt(8)
  v_mfma_f32_16x16x32_bf16 v[46:49], v[240:243], v[92:95], v[46:49]
  ds_read_b64_tr_b16 v[30:31], v10 offset:36864
  ds_read_b64_tr_b16 v[32:33], v10 offset:37888
  v_mfma_f32_16x16x32_bf16 v[50:53], v[244:247], v[92:95], v[50:53]
  ds_read_b64_tr_b16 v[34:35], v11 offset:36864
  ds_read_b64_tr_b16 v[36:37], v11 offset:37888
  v_mfma_f32_16x16x32_bf16 v[54:57], v[248:251], v[92:95], v[54:57]
  ds_read_b64_tr_b16 v[38:39], v12 offset:36864
  ds_read_b64_tr_b16 v[40:41], v12 offset:37888
  v_mfma_f32_16x16x32_bf16 v[58:61], v[252:255], v[92:95], v[58:61]
  ds_read_b64_tr_b16 v[42:43], v13 offset:36864
  ds_read_b64_tr_b16 v[44:45], v13 offset:37888
  s_waitcnt vmcnt(7) lgkmcnt(14)
  v_mfma_f32_16x16x32_bf16 v[46:49], v[14:17], v[96:99], v[46:49]
  ds_read_b64_tr_b16 v[14:15], v10 offset:40960
  ds_read_b64_tr_b16 v[16:17], v10 offset:41984
  s_waitcnt lgkmcnt(14)
  v_mfma_f32_16x16x32_bf16 v[50:53], v[18:21], v[96:99], v[50:53]
  ds_read_b64_tr_b16 v[18:19], v11 offset:40960
  ds_read_b64_tr_b16 v[20:21], v11 offset:41984
  s_waitcnt lgkmcnt(14)
  v_mfma_f32_16x16x32_bf16 v[54:57], v[22:25], v[96:99], v[54:57]
  ds_read_b64_tr_b16 v[22:23], v12 offset:40960
  ds_read_b64_tr_b16 v[24:25], v12 offset:41984
  s_waitcnt lgkmcnt(14)
  v_mfma_f32_16x16x32_bf16 v[58:61], v[26:29], v[96:99], v[58:61]
  ds_read_b64_tr_b16 v[26:27], v13 offset:40960
  ds_read_b64_tr_b16 v[28:29], v13 offset:41984
  s_waitcnt vmcnt(6) lgkmcnt(14)
  v_mfma_f32_16x16x32_bf16 v[46:49], v[30:33], v[100:103], v[46:49]
  ds_read_b64_tr_b16 v[30:31], v10 offset:45056
  ds_read_b64_tr_b16 v[32:33], v10 offset:46080
  s_waitcnt lgkmcnt(14)
  v_mfma_f32_16x16x32_bf16 v[50:53], v[34:37], v[100:103], v[50:53]
  ds_read_b64_tr_b16 v[34:35], v11 offset:45056
  ds_read_b64_tr_b16 v[36:37], v11 offset:46080
  s_waitcnt lgkmcnt(14)
  v_mfma_f32_16x16x32_bf16 v[54:57], v[38:41], v[100:103], v[54:57]
  ds_read_b64_tr_b16 v[38:39], v12 offset:45056
  ds_read_b64_tr_b16 v[40:41], v12 offset:46080
  s_waitcnt lgkmcnt(14)
  v_mfma_f32_16x16x32_bf16 v[58:61], v[42:45], v[100:103], v[58:61]
  ds_read_b64_tr_b16 v[42:43], v13 offset:45056
  ds_read_b64_tr_b16 v[44:45], v13 offset:46080
  s_waitcnt vmcnt(5) lgkmcnt(14)
  v_mfma_f32_16x16x32_bf16 v[46:49], v[14:17], v[104:107], v[46:49]
  ds_read_b64_tr_b16 v[14:15], v10 offset:49152
  ds_read_b64_tr_b16 v[16:17], v10 offset:50176
  s_waitcnt lgkmcnt(14)
  v_mfma_f32_16x16x32_bf16 v[50:53], v[18:21], v[104:107], v[50:53]
  ds_read_b64_tr_b16 v[18:19], v11 offset:49152
  ds_read_b64_tr_b16 v[20:21], v11 offset:50176
  s_waitcnt lgkmcnt(14)
  v_mfma_f32_16x16x32_bf16 v[54:57], v[22:25], v[104:107], v[54:57]
  ds_read_b64_tr_b16 v[22:23], v12 offset:49152
  ds_read_b64_tr_b16 v[24:25], v12 offset:50176
  s_waitcnt lgkmcnt(14)
  v_mfma_f32_16x16x32_bf16 v[58:61], v[26:29], v[104:107], v[58:61]
  ds_read_b64_tr_b16 v[26:27], v13 offset:49152
  ds_read_b64_tr_b16 v[28:29], v13 offset:50176
  s_waitcnt vmcnt(4) lgkmcnt(14)
  v_mfma_f32_16x16x32_bf16 v[46:49], v[30:33], v[108:111], v[46:49]
  ds_read_b64_tr_b16 v[30:31], v10 offset:53248
  ds_read_b64_tr_b16 v[32:33], v10 offset:54272
  s_waitcnt lgkmcnt(14)
  v_mfma_f32_16x16x32_bf16 v[50:53], v[34:37], v[108:111], v[50:53]
  ds_read_b64_tr_b16 v[34:35], v11 offset:53248
  ds_read_b64_tr_b16 v[36:37], v11 offset:54272
  s_waitcnt lgkmcnt(14)
  v_mfma_f32_16x16x32_bf16 v[54:57], v[38:41], v[108:111], v[54:57]
  ds_read_b64_tr_b16 v[38:39], v12 offset:53248
  ds_read_b64_tr_b16 v[40:41], v12 offset:54272
  s_waitcnt lgkmcnt(14)
  v_mfma_f32_16x16x32_bf16 v[58:61], v[42:45], v[108:111], v[58:61]
  ds_read_b64_tr_b16 v[42:43], v13 offset:53248
  ds_read_b64_tr_b16 v[44:45], v13 offset:54272
  s_waitcnt vmcnt(3) lgkmcnt(14)
  v_mfma_f32_16x16x32_bf16 v[46:49], v[14:17], v[112:115], v[46:49]
  ds_read_b64_tr_b16 v[14:15], v10 offset:57344
  ds_read_b64_tr_b16 v[16:17], v10 offset:58368
  s_waitcnt lgkmcnt(14)
  v_mfma_f32_16x16x32_bf16 v[50:53], v[18:21], v[112:115], v[50:53]
  ds_read_b64_tr_b16 v[18:19], v11 offset:57344
  ds_read_b64_tr_b16 v[20:21], v11 offset:58368
  s_waitcnt lgkmcnt(14)
  v_mfma_f32_16x16x32_bf16 v[54:57], v[22:25], v[112:115], v[54:57]
  ds_read_b64_tr_b16 v[22:23], v12 offset:57344
  ds_read_b64_tr_b16 v[24:25], v12 offset:58368
  s_waitcnt lgkmcnt(14)
  v_mfma_f32_16x16x32_bf16 v[58:61], v[26:29], v[112:115], v[58:61]
  ds_read_b64_tr_b16 v[26:27], v13 offset:57344
  ds_read_b64_tr_b16 v[28:29], v13 offset:58368
  s_waitcnt vmcnt(2) lgkmcnt(14)
  v_mfma_f32_16x16x32_bf16 v[46:49], v[30:33], v[116:119], v[46:49]
  ds_read_b64_tr_b16 v[30:31], v10 offset:61440
  ds_read_b64_tr_b16 v[32:33], v10 offset:62464
  s_waitcnt lgkmcnt(14)
  v_mfma_f32_16x16x32_bf16 v[50:53], v[34:37], v[116:119], v[50:53]
  ds_read_b64_tr_b16 v[34:35], v11 offset:61440
  ds_read_b64_tr_b16 v[36:37], v11 offset:62464
  s_waitcnt lgkmcnt(14)
  v_mfma_f32_16x16x32_bf16 v[54:57], v[38:41], v[116:119], v[54:57]
  ds_read_b64_tr_b16 v[38:39], v12 offset:61440
  ds_read_b64_tr_b16 v[40:41], v12 offset:62464
  s_waitcnt lgkmcnt(14)
  v_mfma_f32_16x16x32_bf16 v[58:61], v[42:45], v[116:119], v[58:61]
  ds_read_b64_tr_b16 v[42:43], v13 offset:61440
  ds_read_b64_tr_b16 v[44:45], v13 offset:62464
  s_waitcnt vmcnt(1) lgkmcnt(14)
  v_mfma_f32_16x16x32_bf16 v[46:49], v[14:17], v[120:123], v[46:49]
  s_waitcnt lgkmcnt(12)
  v_mfma_f32_16x16x32_bf16 v[50:53], v[18:21], v[120:123], v[50:53]
  s_waitcnt lgkmcnt(10)
  v_mfma_f32_16x16x32_bf16 v[54:57], v[22:25], v[120:123], v[54:57]
  s_waitcnt lgkmcnt(8)
  v_mfma_f32_16x16x32_bf16 v[58:61], v[26:29], v[120:123], v[58:61]
  s_waitcnt vmcnt(0) lgkmcnt(6)
  v_mfma_f32_16x16x32_bf16 v[46:49], v[30:33], v[124:127], v[46:49]
  s_waitcnt lgkmcnt(4)
  v_mfma_f32_16x16x32_bf16 v[50:53], v[34:37], v[124:127], v[50:53]
  s_waitcnt lgkmcnt(2)
  v_mfma_f32_16x16x32_bf16 v[54:57], v[38:41], v[124:127], v[54:57]
  s_waitcnt lgkmcnt(0)
  v_mfma_f32_16x16x32_bf16 v[58:61], v[42:45], v[124:127], v[58:61]
  s_branch L_ob_49
L_oa_121:
  s_add_u32 s73, s74, 8192
  buffer_load_dwordx4 v[108:111], v2, s[16:19], s73 offen offset:3072 sc1
  s_waitcnt vmcnt(11)
  v_mfma_f32_16x16x32_bf16 v[46:49], v[128:131], v[64:67], 0
  v_mfma_f32_16x16x32_bf16 v[50:53], v[132:135], v[64:67], 0
  v_mfma_f32_16x16x32_bf16 v[54:57], v[136:139], v[64:67], 0
  v_mfma_f32_16x16x32_bf16 v[58:61], v[140:143], v[64:67], 0
  s_add_u32 s73, s74, 12288
  buffer_load_dwordx4 v[112:115], v2, s[16:19], s73 offen offset:0 sc1
  s_waitcnt vmcnt(11)
  v_mfma_f32_16x16x32_bf16 v[46:49], v[144:147], v[68:71], v[46:49]
  v_mfma_f32_16x16x32_bf16 v[50:53], v[148:151], v[68:71], v[50:53]
  v_mfma_f32_16x16x32_bf16 v[54:57], v[152:155], v[68:71], v[54:57]
  v_mfma_f32_16x16x32_bf16 v[58:61], v[156:159], v[68:71], v[58:61]
  buffer_load_dwordx4 v[116:119], v2, s[16:19], s73 offen offset:1024 sc1
  s_waitcnt vmcnt(11)
  v_mfma_f32_16x16x32_bf16 v[46:49], v[160:163], v[72:75], v[46:49]
  v_mfma_f32_16x16x32_bf16 v[50:53], v[164:167], v[72:75], v[50:53]
  v_mfma_f32_16x16x32_bf16 v[54:57], v[168:171], v[72:75], v[54:57]
  v_mfma_f32_16x16x32_bf16 v[58:61], v[172:175], v[72:75], v[58:61]
  buffer_load_dwordx4 v[120:123], v2, s[16:19], s73 offen offset:2048 sc1
  s_waitcnt vmcnt(11)
  v_mfma_f32_16x16x32_bf16 v[46:49], v[176:179], v[76:79], v[46:49]
  v_mfma_f32_16x16x32_bf16 v[50:53], v[180:183], v[76:79], v[50:53]
  v_mfma_f32_16x16x32_bf16 v[54:57], v[184:187], v[76:79], v[54:57]
  v_mfma_f32_16x16x32_bf16 v[58:61], v[188:191], v[76:79], v[58:61]
  buffer_load_dwordx4 v[124:127], v2, s[16:19], s73 offen offset:3072 sc1
  s_waitcnt vmcnt(11)
  v_mfma_f32_16x16x32_bf16 v[46:49], v[192:195], v[80:83], v[46:49]
  v_mfma_f32_16x16x32_bf16 v[50:53], v[196:199], v[80:83], v[50:53]
  v_mfma_f32_16x16x32_bf16 v[54:57], v[200:203], v[80:83], v[54:57]
  v_mfma_f32_16x16x32_bf16 v[58:61], v[204:207], v[80:83], v[58:61]
  s_waitcnt vmcnt(10)
  v_mfma_f32_16x16x32_bf16 v[46:49], v[208:211], v[84:87], v[46:49]
  v_mfma_f32_16x16x32_bf16 v[50:53], v[212:215], v[84:87], v[50:53]
  v_mfma_f32_16x16x32_bf16 v[54:57], v[216:219], v[84:87], v[54:57]
  v_mfma_f32_16x16x32_bf16 v[58:61], v[220:223], v[84:87], v[58:61]
  s_waitcnt vmcnt(9)
  v_mfma_f32_16x16x32_bf16 v[46:49], v[224:227], v[88:91], v[46:49]
  ds_read_b64_tr_b16 v[14:15], v10 offset:32768
  ds_read_b64_tr_b16 v[16:17], v10 offset:33792
  v_mfma_f32_16x16x32_bf16 v[50:53], v[228:231], v[88:91], v[50:53]
  ds_read_b64_tr_b16 v[18:19], v11 offset:32768
  ds_read_b64_tr_b16 v[20:21], v11 offset:33792
  v_mfma_f32_16x16x32_bf16 v[54:57], v[232:235], v[88:91], v[54:57]
  ds_read_b64_tr_b16 v[22:23], v12 offset:32768
  ds_read_b64_tr_b16 v[24:25], v12 offset:33792
  v_mfma_f32_16x16x32_bf16 v[58:61], v[236:239], v[88:91], v[58:61]
  ds_read_b64_tr_b16 v[26:27], v13 offset:32768
  ds_read_b64_tr_b16 v[28:29], v13 offset:33792
  s_waitcnt vmcnt(8)
  v_mfma_f32_16x16x32_bf16 v[46:49], v[240:243], v[92:95], v[46:49]
  ds_read_b64_tr_b16 v[30:31], v10 offset:36864
  ds_read_b64_tr_b16 v[32:33], v10 offset:37888
  v_mfma_f32_16x16x32_bf16 v[50:53], v[244:247], v[92:95], v[50:53]
  ds_read_b64_tr_b16 v[34:35], v11 offset:36864
  ds_read_b64_tr_b16 v[36:37], v11 offset:37888
  v_mfma_f32_16x16x32_bf16 v[54:57], v[248:251], v[92:95], v[54:57]
  ds_read_b64_tr_b16 v[38:39], v12 offset:36864
  ds_read_b64_tr_b16 v[40:41], v12 offset:37888
  v_mfma_f32_16x16x32_bf16 v[58:61], v[252:255], v[92:95], v[58:61]
  ds_read_b64_tr_b16 v[42:43], v13 offset:36864
  ds_read_b64_tr_b16 v[44:45], v13 offset:37888
  s_waitcnt vmcnt(7) lgkmcnt(14)
  v_mfma_f32_16x16x32_bf16 v[46:49], v[14:17], v[96:99], v[46:49]
  ds_read_b64_tr_b16 v[14:15], v10 offset:40960
  ds_read_b64_tr_b16 v[16:17], v10 offset:41984
  s_waitcnt lgkmcnt(14)
  v_mfma_f32_16x16x32_bf16 v[50:53], v[18:21], v[96:99], v[50:53]
  ds_read_b64_tr_b16 v[18:19], v11 offset:40960
  ds_read_b64_tr_b16 v[20:21], v11 offset:41984
  s_waitcnt lgkmcnt(14)
  v_mfma_f32_16x16x32_bf16 v[54:57], v[22:25], v[96:99], v[54:57]
  ds_read_b64_tr_b16 v[22:23], v12 offset:40960
  ds_read_b64_tr_b16 v[24:25], v12 offset:41984
  s_waitcnt lgkmcnt(14)
  v_mfma_f32_16x16x32_bf16 v[58:61], v[26:29], v[96:99], v[58:61]
  ds_read_b64_tr_b16 v[26:27], v13 offset:40960
  ds_read_b64_tr_b16 v[28:29], v13 offset:41984
  s_waitcnt vmcnt(6) lgkmcnt(14)
  v_mfma_f32_16x16x32_bf16 v[46:49], v[30:33], v[100:103], v[46:49]
  ds_read_b64_tr_b16 v[30:31], v10 offset:45056
  ds_read_b64_tr_b16 v[32:33], v10 offset:46080
  s_waitcnt lgkmcnt(14)
  v_mfma_f32_16x16x32_bf16 v[50:53], v[34:37], v[100:103], v[50:53]
  ds_read_b64_tr_b16 v[34:35], v11 offset:45056
  ds_read_b64_tr_b16 v[36:37], v11 offset:46080
  s_waitcnt lgkmcnt(14)
  v_mfma_f32_16x16x32_bf16 v[54:57], v[38:41], v[100:103], v[54:57]
  ds_read_b64_tr_b16 v[38:39], v12 offset:45056
  ds_read_b64_tr_b16 v[40:41], v12 offset:46080
  s_waitcnt lgkmcnt(14)
  v_mfma_f32_16x16x32_bf16 v[58:61], v[42:45], v[100:103], v[58:61]
  ds_read_b64_tr_b16 v[42:43], v13 offset:45056
  ds_read_b64_tr_b16 v[44:45], v13 offset:46080
  s_waitcnt vmcnt(5) lgkmcnt(14)
  v_mfma_f32_16x16x32_bf16 v[46:49], v[14:17], v[104:107], v[46:49]
  ds_read_b64_tr_b16 v[14:15], v10 offset:49152
  ds_read_b64_tr_b16 v[16:17], v10 offset:50176
  s_waitcnt lgkmcnt(14)
  v_mfma_f32_16x16x32_bf16 v[50:53], v[18:21], v[104:107], v[50:53]
  ds_read_b64_tr_b16 v[18:19], v11 offset:49152
  ds_read_b64_tr_b16 v[20:21], v11 offset:50176
  s_waitcnt lgkmcnt(14)
  v_mfma_f32_16x16x32_bf16 v[54:57], v[22:25], v[104:107], v[54:57]
  ds_read_b64_tr_b16 v[22:23], v12 offset:49152
  ds_read_b64_tr_b16 v[24:25], v12 offset:50176
  s_waitcnt lgkmcnt(14)
  v_mfma_f32_16x16x32_bf16 v[58:61], v[26:29], v[104:107], v[58:61]
  ds_read_b64_tr_b16 v[26:27], v13 offset:49152
  ds_read_b64_tr_b16 v[28:29], v13 offset:50176
  s_waitcnt vmcnt(4) lgkmcnt(14)
  v_mfma_f32_16x16x32_bf16 v[46:49], v[30:33], v[108:111], v[46:49]
  ds_read_b64_tr_b16 v[30:31], v10 offset:53248
  ds_read_b64_tr_b16 v[32:33], v10 offset:54272
  s_waitcnt lgkmcnt(14)
  v_mfma_f32_16x16x32_bf16 v[50:53], v[34:37], v[108:111], v[50:53]
  ds_read_b64_tr_b16 v[34:35], v11 offset:53248
  ds_read_b64_tr_b16 v[36:37], v11 offset:54272
  s_waitcnt lgkmcnt(14)
  v_mfma_f32_16x16x32_bf16 v[54:57], v[38:41], v[108:111], v[54:57]
  ds_read_b64_tr_b16 v[38:39], v12 offset:53248
  ds_read_b64_tr_b16 v[40:41], v12 offset:54272
  s_waitcnt lgkmcnt(14)
  v_mfma_f32_16x16x32_bf16 v[58:61], v[42:45], v[108:111], v[58:61]
  ds_read_b64_tr_b16 v[42:43], v13 offset:53248
  ds_read_b64_tr_b16 v[44:45], v13 offset:54272
  s_waitcnt vmcnt(3) lgkmcnt(14)
  v_mfma_f32_16x16x32_bf16 v[46:49], v[14:17], v[112:115], v[46:49]
  ds_read_b64_tr_b16 v[14:15], v10 offset:57344
  ds_read_b64_tr_b16 v[16:17], v10 offset:58368
  s_waitcnt lgkmcnt(14)
  v_mfma_f32_16x16x32_bf16 v[50:53], v[18:21], v[112:115], v[50:53]
  ds_read_b64_tr_b16 v[18:19], v11 offset:57344
  ds_read_b64_tr_b16 v[20:21], v11 offset:58368
  s_waitcnt lgkmcnt(14)
  v_mfma_f32_16x16x32_bf16 v[54:57], v[22:25], v[112:115], v[54:57]
  ds_read_b64_tr_b16 v[22:23], v12 offset:57344
  ds_read_b64_tr_b16 v[24:25], v12 offset:58368
  s_waitcnt lgkmcnt(14)
  v_mfma_f32_16x16x32_bf16 v[58:61], v[26:29], v[112:115], v[58:61]
  ds_read_b64_tr_b16 v[26:27], v13 offset:57344
  ds_read_b64_tr_b16 v[28:29], v13 offset:58368
  s_waitcnt vmcnt(2) lgkmcnt(14)
  v_mfma_f32_16x16x32_bf16 v[46:49], v[30:33], v[116:119], v[46:49]
  ds_read_b64_tr_b16 v[30:31], v10 offset:61440
  ds_read_b64_tr_b16 v[32:33], v10 offset:62464
  s_waitcnt lgkmcnt(14)
  v_mfma_f32_16x16x32_bf16 v[50:53], v[34:37], v[116:119], v[50:53]
  ds_read_b64_tr_b16 v[34:35], v11 offset:61440
  ds_read_b64_tr_b16 v[36:37], v11 offset:62464
  s_waitcnt lgkmcnt(14)
  v_mfma_f32_16x16x32_bf16 v[54:57], v[38:41], v[116:119], v[54:57]
  ds_read_b64_tr_b16 v[38:39], v12 offset:61440
  ds_read_b64_tr_b16 v[40:41], v12 offset:62464
  s_waitcnt lgkmcnt(14)
  v_mfma_f32_16x16x32_bf16 v[58:61], v[42:45], v[116:119], v[58:61]
  ds_read_b64_tr_b16 v[42:43], v13 offset:61440
  ds_read_b64_tr_b16 v[44:45], v13 offset:62464
  s_waitcnt vmcnt(1) lgkmcnt(14)
  v_mfma_f32_16x16x32_bf16 v[46:49], v[14:17], v[120:123], v[46:49]
  s_waitcnt lgkmcnt(12)
  v_mfma_f32_16x16x32_bf16 v[50:53], v[18:21], v[120:123], v[50:53]
  s_waitcnt lgkmcnt(10)
  v_mfma_f32_16x16x32_bf16 v[54:57], v[22:25], v[120:123], v[54:57]
  s_waitcnt lgkmcnt(8)
  v_mfma_f32_16x16x32_bf16 v[58:61], v[26:29], v[120:123], v[58:61]
  s_waitcnt vmcnt(0) lgkmcnt(6)
  v_mfma_f32_16x16x32_bf16 v[46:49], v[30:33], v[124:127], v[46:49]
  s_waitcnt lgkmcnt(4)
  v_mfma_f32_16x16x32_bf16 v[50:53], v[34:37], v[124:127], v[50:53]
  s_waitcnt lgkmcnt(2)
  v_mfma_f32_16x16x32_bf16 v[54:57], v[38:41], v[124:127], v[54:57]
  s_waitcnt lgkmcnt(0)
  v_mfma_f32_16x16x32_bf16 v[58:61], v[42:45], v[124:127], v[58:61]
  s_branch L_ob_122
L_p1s_9:
  s_nop 7
  s_waitcnt lgkmcnt(0)
  ds_read_b128 a[20:23], v10 offset:10240
  s_waitcnt lgkmcnt(0)
  v_mfma_f32_32x32x16_bf16 v[96:111], a[8:11], v[224:227], 0
  s_waitcnt lgkmcnt(0)
  ds_read_b128 a[24:27], v10 offset:12288
  s_waitcnt lgkmcnt(0)
  v_mfma_f32_32x32x16_bf16 v[112:127], a[12:15], v[228:231], 0
  s_waitcnt lgkmcnt(0)
  s_nop 11
  s_branch L_p1b_10
L_p1s_11:
  s_nop 7
  s_waitcnt lgkmcnt(0)
  ds_read_b128 a[28:31], v10 offset:14336
  s_waitcnt lgkmcnt(0)
  v_mfma_f32_32x32x16_bf16 v[64:79], a[16:19], v[224:227], 0
  s_waitcnt lgkmcnt(0)
  ds_read_b128 a[32:35], v10 offset:16384
  s_waitcnt lgkmcnt(0)
  v_mfma_f32_32x32x16_bf16 v[80:95], a[20:23], v[228:231], 0
  s_waitcnt lgkmcnt(0)
  s_nop 11
  s_branch L_p1b_12
L_p1s_13:
  s_nop 7
  s_waitcnt lgkmcnt(0)
  ds_read_b128 a[36:39], v10 offset:18432
  s_waitcnt lgkmcnt(0)
  v_mfma_f32_32x32x16_bf16 v[96:111], a[24:27], v[224:227], 0
  s_waitcnt lgkmcnt(0)
  ds_read_b128 a[40:43], v10 offset:20480
  s_waitcnt lgkmcnt(0)
  v_mfma_f32_32x32x16_bf16 v[112:127], a[28:31], v[228:231], 0
  s_waitcnt lgkmcnt(0)
  s_nop 11
  s_branch L_p1b_14
L_p1s_15:
  s_nop 7
  s_waitcnt lgkmcnt(0)
  ds_read_b128 a[44:47], v10 offset:22528
  s_waitcnt lgkmcnt(0)
  v_mfma_f32_32x32x16_bf16 v[64:79], a[32:35], v[224:227], 0
  s_waitcnt lgkmcnt(0)
  ds_read_b128 a[48:51], v10 offset:24576
  s_waitcnt lgkmcnt(0)
  v_mfma_f32_32x32x16_bf16 v[80:95], a[36:39], v[228:231], 0
  s_waitcnt lgkmcnt(0)
  s_nop 11
  s_branch L_p1b_16
L_p1s_17:
  s_nop 7
  s_waitcnt lgkmcnt(0)
  ds_read_b128 a[52:55], v10 offset:26624
  s_waitcnt lgkmcnt(0)
  v_mfma_f32_32x32x16_bf16 v[96:111], a[40:43], v[224:227], 0
  s_waitcnt lgkmcnt(0)
  ds_read_b128 a[56:59], v10 offset:28672
  s_waitcnt lgkmcnt(0)
  v_mfma_f32_32x32x16_bf16 v[112:127], a[44:47], v[228:231], 0
  s_waitcnt lgkmcnt(0)
  s_nop 11
  s_branch L_p1b_18
L_p1s_19:
  s_nop 7
  s_waitcnt lgkmcnt(0)
  ds_read_b128 a[60:63], v10 offset:30720
  s_waitcnt lgkmcnt(0)
  v_mfma_f32_32x32x16_bf16 v[64:79], a[48:51], v[224:227], 0
  s_waitcnt lgkmcnt(0)
  ds_read_b128 a[64:67], v10 offset:32768
  s_waitcnt lgkmcnt(0)
  v_mfma_f32_32x32x16_bf16 v[80:95], a[52:55], v[228:231], 0
  s_waitcnt lgkmcnt(0)
  s_nop 11
  s_branch L_p1b_20
L_p1s_21:
  s_nop 7
  s_waitcnt lgkmcnt(0)
  ds_read_b128 a[68:71], v10 offset:34816
  s_waitcnt lgkmcnt(0)
  v_mfma_f32_32x32x16_bf16 v[96:111], a[56:59], v[224:227], 0
  s_waitcnt lgkmcnt(0)
  v_mfma_f32_32x32x16_bf16 v[112:127], a[60:63], v[228:231], 0
  s_waitcnt lgkmcnt(0)
  s_nop 11
  s_branch L_p1b_22
L_p1s_23:
  s_nop 7
  s_waitcnt lgkmcnt(0)
  v_mfma_f32_32x32x16_bf16 v[64:79], a[64:67], v[224:227], v[208:223]
  s_waitcnt lgkmcnt(0)
  v_mfma_f32_32x32x16_bf16 v[80:95], a[68:71], v[228:231], v[208:223]
  s_waitcnt lgkmcnt(0)
  s_nop 11
  s_branch L_p1b_24
L_sk_25:
  s_nop 7
  v_mfma_f32_32x32x16_bf16 v[64:79], a[8:11], v[224:227], v[128:143]
  s_nop 11
  s_branch L_bk_26
L_sk_27:
  s_nop 7
  v_mfma_f32_32x32x16_bf16 v[64:79], a[16:19], v[224:227], v[128:143]
  s_nop 11
  s_branch L_bk_28
L_sk_29:
  s_nop 7
  v_mfma_f32_32x32x16_bf16 v[64:79], a[24:27], v[224:227], v[128:143]
  s_nop 11
  s_branch L_bk_30
L_sk_31:
  s_nop 7
  v_mfma_f32_32x32x16_bf16 v[64:79], a[32:35], v[224:227], v[128:143]
  s_nop 11
  s_branch L_bk_32
L_sk_33:
  s_nop 7
  v_mfma_f32_32x32x16_bf16 v[64:79], a[40:43], v[224:227], v[128:143]
  s_nop 11
  s_branch L_bk_34
L_sk_35:
  s_nop 7
  v_mfma_f32_32x32x16_bf16 v[64:79], a[48:51], v[224:227], v[128:143]
  s_add_u32 m0, s79, 0
  s_add_u32 s72, s78, 0
  buffer_load_dwordx4 v19, s[12:15], s72 offen lds
  s_add_u32 m0, s79, 1024
  s_add_u32 s72, s78, 8192
  buffer_load_dwordx4 v19, s[12:15], s72 offen lds
  s_add_u32 m0, s79, 2048
  s_add_u32 s72, s78, 16384
  buffer_load_dwordx4 v19, s[12:15], s72 offen lds
  s_add_u32 m0, s79, 3072
  s_add_u32 s72, s78, 24576
  buffer_load_dwordx4 v19, s[12:15], s72 offen lds
  s_nop 11
  s_branch L_bk_36
L_sk_37:
  s_nop 7
  v_mfma_f32_32x32x16_bf16 v[64:79], a[56:59], v[224:227], v[128:143]
  s_add_u32 m0, s79, 4096
  s_add_u32 s72, s78, 32768
  buffer_load_dwordx4 v19, s[12:15], s72 offen lds
  s_add_u32 m0, s79, 5120
  s_add_u32 s72, s78, 40960
  buffer_load_dwordx4 v19, s[12:15], s72 offen lds
  s_add_u32 m0, s79, 6144
  s_add_u32 s72, s78, 49152
  buffer_load_dwordx4 v19, s[12:15], s72 offen lds
  s_add_u32 m0, s79, 7168
  s_add_u32 s72, s78, 57344
  buffer_load_dwordx4 v19, s[12:15], s72 offen lds
  s_nop 11
  s_branch L_bk_38
L_sk_39:
  s_nop 7
  v_mfma_f32_32x32x16_bf16 v[64:79], a[64:67], v[224:227], v[128:143]
  s_add_u32 m0, s79, 8192
  s_add_u32 s72, s78, 65536
  buffer_load_dwordx4 v19, s[12:15], s72 offen lds
  s_add_u32 m0, s79, 9216
  s_add_u32 s72, s78, 73728
  buffer_load_dwordx4 v19, s[12:15], s72 offen lds
  s_add_u32 m0, s79, 10240
  s_add_u32 s72, s78, 81920
  buffer_load_dwordx4 v19, s[12:15], s72 offen lds
  s_add_u32 m0, s79, 11264
  s_add_u32 s72, s78, 90112
  buffer_load_dwordx4 v19, s[12:15], s72 offen lds
  s_nop 11
  s_branch L_bk_40
L_p1s_82:
  s_nop 7
  s_waitcnt lgkmcnt(0)
  ds_read_b128 a[20:23], v10 offset:10240
  s_waitcnt lgkmcnt(0)
  v_mfma_f32_32x32x16_bf16 v[96:111], a[8:11], v[224:227], 0
  s_waitcnt lgkmcnt(0)
  ds_read_b128 a[24:27], v10 offset:12288
  s_waitcnt lgkmcnt(0)
  v_mfma_f32_32x32x16_bf16 v[112:127], a[12:15], v[228:231], 0
  s_waitcnt lgkmcnt(0)
  s_nop 11
  s_branch L_p1b_83
L_p1s_84:
  s_nop 7
  s_waitcnt lgkmcnt(0)
  ds_read_b128 a[28:31], v10 offset:14336
  s_waitcnt lgkmcnt(0)
  v_mfma_f32_32x32x16_bf16 v[64:79], a[16:19], v[224:227], 0
  s_waitcnt lgkmcnt(0)
  s_add_u32 m0, s79, 0
  s_add_u32 s72, s78, 0
  buffer_load_dwordx4 v19, s[12:15], s72 offen lds
  s_waitcnt lgkmcnt(0)
  ds_read_b128 a[32:35], v10 offset:16384
  s_waitcnt lgkmcnt(0)
  v_mfma_f32_32x32x16_bf16 v[80:95], a[20:23], v[228:231], 0
  s_waitcnt lgkmcnt(0)
  s_add_u32 m0, s79, 1024
  s_add_u32 s72, s78, 8192
  buffer_load_dwordx4 v19, s[12:15], s72 offen lds
  s_waitcnt lgkmcnt(0)
  s_nop 11
  s_branch L_p1b_85
L_p1s_86:
  s_nop 7
  s_waitcnt lgkmcnt(0)
  ds_read_b128 a[36:39], v10 offset:18432
  s_waitcnt lgkmcnt(0)
  v_mfma_f32_32x32x16_bf16 v[96:111], a[24:27], v[224:227], 0
  s_waitcnt lgkmcnt(0)
  s_add_u32 m0, s79, 2048
  s_add_u32 s72, s78, 16384
  buffer_load_dwordx4 v19, s[12:15], s72 offen lds
  s_waitcnt lgkmcnt(0)
  ds_read_b128 a[40:43], v10 offset:20480
  s_waitcnt lgkmcnt(0)
  v_mfma_f32_32x32x16_bf16 v[112:127], a[28:31], v[228:231], 0
  s_waitcnt lgkmcnt(0)
  s_add_u32 m0, s79, 3072
  s_add_u32 s72, s78, 24576
  buffer_load_dwordx4 v19, s[12:15], s72 offen lds
  s_waitcnt lgkmcnt(0)
  s_nop 11
  s_branch L_p1b_87
L_p1s_88:
  s_nop 7
  s_waitcnt lgkmcnt(0)
  ds_read_b128 a[44:47], v10 offset:22528
  s_waitcnt lgkmcnt(0)
  v_mfma_f32_32x32x16_bf16 v[64:79], a[32:35], v[224:227], 0
  s_waitcnt lgkmcnt(0)
  s_add_u32 m0, s79, 4096
  s_add_u32 s72, s78, 32768
  buffer_load_dwordx4 v19, s[12:15], s72 offen lds
  s_waitcnt lgkmcnt(0)
  ds_read_b128 a[48:51], v10 offset:24576
  s_waitcnt lgkmcnt(0)
  v_mfma_f32_32x32x16_bf16 v[80:95], a[36:39], v[228:231], 0
  s_waitcnt lgkmcnt(0)
  s_add_u32 m0, s79, 5120
  s_add_u32 s72, s78, 40960
  buffer_load_dwordx4 v19, s[12:15], s72 offen lds
  s_waitcnt lgkmcnt(0)
  s_nop 11
  s_branch L_p1b_89
L_p1s_90:
  s_nop 7
  s_waitcnt lgkmcnt(0)
  ds_read_b128 a[52:55], v10 offset:26624
  s_waitcnt lgkmcnt(0)
  v_mfma_f32_32x32x16_bf16 v[96:111], a[40:43], v[224:227], 0
  s_waitcnt lgkmcnt(0)
  s_add_u32 m0, s79, 6144
  s_add_u32 s72, s78, 49152
  buffer_load_dwordx4 v19, s[12:15], s72 offen lds
  s_waitcnt lgkmcnt(0)
  ds_read_b128 a[56:59], v10 offset:28672
  s_waitcnt lgkmcnt(0)
  v_mfma_f32_32x32x16_bf16 v[112:127], a[44:47], v[228:231], 0
  s_waitcnt lgkmcnt(0)
  s_add_u32 m0, s79, 7168
  s_add_u32 s72, s78, 57344
  buffer_load_dwordx4 v19, s[12:15], s72 offen lds
  s_waitcnt lgkmcnt(0)
  s_nop 11
  s_branch L_p1b_91
L_p1s_92:
  s_nop 7
  s_waitcnt lgkmcnt(0)
  ds_read_b128 a[60:63], v10 offset:30720
  s_waitcnt lgkmcnt(0)
  v_mfma_f32_32x32x16_bf16 v[64:79], a[48:51], v[224:227], 0
  s_waitcnt lgkmcnt(0)
  s_add_u32 m0, s79, 8192
  s_add_u32 s72, s78, 65536
  buffer_load_dwordx4 v19, s[12:15], s72 offen lds
  s_waitcnt lgkmcnt(0)
  ds_read_b128 a[64:67], v10 offset:32768
  s_waitcnt lgkmcnt(0)
  v_mfma_f32_32x32x16_bf16 v[80:95], a[52:55], v[228:231], 0
  s_waitcnt lgkmcnt(0)
  s_add_u32 m0, s79, 9216
  s_add_u32 s72, s78, 73728
  buffer_load_dwordx4 v19, s[12:15], s72 offen lds
  s_waitcnt lgkmcnt(0)
  s_nop 11
  s_branch L_p1b_93
L_p1s_94:
  s_nop 7
  s_waitcnt lgkmcnt(0)
  ds_read_b128 a[68:71], v10 offset:34816
  s_waitcnt lgkmcnt(0)
  v_mfma_f32_32x32x16_bf16 v[96:111], a[56:59], v[224:227], 0
  s_waitcnt lgkmcnt(0)
  s_add_u32 m0, s79, 10240
  s_add_u32 s72, s78, 81920
  buffer_load_dwordx4 v19, s[12:15], s72 offen lds
  s_waitcnt lgkmcnt(0)
  v_mfma_f32_32x32x16_bf16 v[112:127], a[60:63], v[228:231], 0
  s_waitcnt lgkmcnt(0)
  s_add_u32 m0, s79, 11264
  s_add_u32 s72, s78, 90112
  buffer_load_dwordx4 v19, s[12:15], s72 offen lds
  s_waitcnt lgkmcnt(0)
  s_nop 11
  s_branch L_p1b_95
L_p1s_96:
  s_nop 7
  s_waitcnt lgkmcnt(0)
  v_mfma_f32_32x32x16_bf16 v[64:79], a[64:67], v[224:227], v[208:223]
  s_waitcnt lgkmcnt(0)
  s_add_u32 m0, s79, 12288
  s_add_u32 s72, s78, 98304
  buffer_load_dwordx4 v19, s[12:15], s72 offen lds
  s_waitcnt lgkmcnt(0)
  v_mfma_f32_32x32x16_bf16 v[80:95], a[68:71], v[228:231], v[208:223]
  s_waitcnt lgkmcnt(0)
  s_add_u32 m0, s79, 13312
  s_add_u32 s72, s78, 106496
  buffer_load_dwordx4 v19, s[12:15], s72 offen lds
  s_waitcnt lgkmcnt(0)
  s_nop 11
  s_branch L_p1b_97
L_sk_98:
  s_nop 7
  v_mfma_f32_32x32x16_bf16 v[64:79], a[8:11], v[224:227], v[128:143]
  s_nop 11
  s_branch L_bk_99
L_sk_100:
  s_nop 7
  v_mfma_f32_32x32x16_bf16 v[64:79], a[16:19], v[224:227], v[128:143]
  s_nop 11
  s_branch L_bk_101
L_sk_102:
  s_nop 7
  v_mfma_f32_32x32x16_bf16 v[64:79], a[24:27], v[224:227], v[128:143]
  s_nop 11
  s_branch L_bk_103
L_sk_104:
  s_nop 7
  v_mfma_f32_32x32x16_bf16 v[64:79], a[32:35], v[224:227], v[128:143]
  s_nop 11
  s_branch L_bk_105
L_sk_106:
  s_nop 7
  v_mfma_f32_32x32x16_bf16 v[64:79], a[40:43], v[224:227], v[128:143]
  s_nop 11
  s_branch L_bk_107
L_sk_108:
  s_nop 7
  v_mfma_f32_32x32x16_bf16 v[64:79], a[48:51], v[224:227], v[128:143]
  s_nop 11
  s_branch L_bk_109
L_sk_110:
  s_nop 7
  v_mfma_f32_32x32x16_bf16 v[64:79], a[56:59], v[224:227], v[128:143]
  s_nop 11
  s_branch L_bk_111
L_sk_112:
  s_nop 7
  v_mfma_f32_32x32x16_bf16 v[64:79], a[64:67], v[224:227], v[128:143]
  s_nop 11
  s_branch L_bk_113
L_m1o_58:
  s_lshl_b32 s72, s2, 2
  s_add_u32 s72, s72, s60
  s_mul_i32 s73, s72, 5504
  v_lshlrev_b32 v7, 7, v1
  s_mov_b32 exec_lo, -1
  s_mov_b32 exec_hi, 0x7ff
  buffer_load_dword v60, v7, s[28:31], s73 offen
  s_mov_b64 exec, -1
  v_lshrrev_b32 v6, 3, v0
  v_and_b32 v3, 7, v0
  v_lshlrev_b32 v6, 10, v6
  v_lshl_add_u32 v6, v3, 4, v6
  s_lshl_b32 s72, s58, 16
  s_lshl_b32 s73, s59, 7
  s_add_u32 s72, s72, s73
  s_add_u32 s73, s72, 32768
  buffer_load_dword v23, v6, s[20:23], s72 offen sc1
  buffer_load_dword v24, v6, s[20:23], s73 offen sc1
  s_add_u32 s72, s58, 32
  s_lshl_b32 s72, s72, 3
  s_add_u32 s72, s72, s59
  s_lshl_b32 s72, s72, 10
  s_add_u32 s72, s72, 36700160
  buffer_load_dword v25, v2, s[16:19], s72 offen sc1
  s_add_u32 m0, s86, 0
  s_add_u32 s88, s89, 0
  buffer_load_dwordx4 v40, s[28:31], s88 offen lds
  s_add_u32 m0, s86, 1024
  s_add_u32 s88, s89, 32768
  buffer_load_dwordx4 v41, s[28:31], s88 offen lds
  s_add_u32 m0, s86, 2048
  s_add_u32 s88, s89, 65536
  buffer_load_dwordx4 v40, s[28:31], s88 offen lds
  s_add_u32 m0, s86, 3072
  s_add_u32 s88, s89, 98304
  buffer_load_dwordx4 v41, s[28:31], s88 offen lds
  s_add_u32 m0, s86, 4096
  s_add_u32 s88, s89, 131072
  buffer_load_dwordx4 v40, s[28:31], s88 offen lds
  s_add_u32 m0, s86, 5120
  s_add_u32 s88, s89, 163840
  buffer_load_dwordx4 v41, s[28:31], s88 offen lds
  s_add_u32 m0, s86, 6144
  s_add_u32 s88, s89, 196608
  buffer_load_dwordx4 v40, s[28:31], s88 offen lds
  s_add_u32 m0, s86, 7168
  s_add_u32 s88, s89, 229376
  buffer_load_dwordx4 v41, s[28:31], s88 offen lds
  s_add_u32 m0, s86, 8192
  s_add_u32 s88, s89, 262144
  buffer_load_dwordx4 v40, s[28:31], s88 offen lds
  s_add_u32 m0, s86, 9216
  s_add_u32 s88, s89, 294912
  buffer_load_dwordx4 v41, s[28:31], s88 offen lds
  s_add_u32 m0, s86, 10240
  s_add_u32 s88, s89, 327680
  buffer_load_dwordx4 v40, s[28:31], s88 offen lds
  s_add_u32 m0, s86, 11264
  s_add_u32 s88, s89, 360448
  buffer_load_dwordx4 v41, s[28:31], s88 offen lds
  s_add_u32 m0, s86, 12288
  s_add_u32 s88, s89, 393216
  buffer_load_dwordx4 v40, s[28:31], s88 offen lds
  s_add_u32 m0, s86, 13312
  s_add_u32 s88, s89, 425984
  buffer_load_dwordx4 v41, s[28:31], s88 offen lds
  s_add_u32 m0, s86, 14336
  s_add_u32 s88, s89, 458752
  buffer_load_dwordx4 v40, s[28:31], s88 offen lds
  s_add_u32 m0, s86, 15360
  s_add_u32 s88, s89, 491520
  buffer_load_dwordx4 v41, s[28:31], s88 offen lds
  s_add_u32 m0, s86, 16384
  s_add_u32 s88, s89, 524288
  buffer_load_dwordx4 v40, s[28:31], s88 offen lds
  s_add_u32 m0, s86, 17408
  s_add_u32 s88, s89, 557056
  buffer_load_dwordx4 v41, s[28:31], s88 offen lds
  s_add_u32 m0, s86, 18432
  s_add_u32 s88, s89, 589824
  buffer_load_dwordx4 v40, s[28:31], s88 offen lds
  s_add_u32 m0, s86, 19456
  s_add_u32 s88, s89, 622592
  buffer_load_dwordx4 v41, s[28:31], s88 offen lds
  s_branch L_m1_57
L_m1o_131:
  s_add_u32 m0, s86, 0
  s_add_u32 s88, s89, 0
  buffer_load_dwordx4 v40, s[28:31], s88 offen lds
  s_add_u32 m0, s86, 1024
  s_add_u32 s88, s89, 32768
  buffer_load_dwordx4 v41, s[28:31], s88 offen lds
  s_add_u32 m0, s86, 2048
  s_add_u32 s88, s89, 65536
  buffer_load_dwordx4 v40, s[28:31], s88 offen lds
  s_add_u32 m0, s86, 3072
  s_add_u32 s88, s89, 98304
  buffer_load_dwordx4 v41, s[28:31], s88 offen lds
  s_add_u32 m0, s86, 4096
  s_add_u32 s88, s89, 131072
  buffer_load_dwordx4 v40, s[28:31], s88 offen lds
  s_add_u32 m0, s86, 5120
  s_add_u32 s88, s89, 163840
  buffer_load_dwordx4 v41, s[28:31], s88 offen lds
  s_add_u32 m0, s86, 6144
  s_add_u32 s88, s89, 196608
  buffer_load_dwordx4 v40, s[28:31], s88 offen lds
  s_add_u32 m0, s86, 7168
  s_add_u32 s88, s89, 229376
  buffer_load_dwordx4 v41, s[28:31], s88 offen lds
  s_add_u32 m0, s86, 8192
  s_add_u32 s88, s89, 262144
  buffer_load_dwordx4 v40, s[28:31], s88 offen lds
  s_add_u32 m0, s86, 9216
  s_add_u32 s88, s89, 294912
  buffer_load_dwordx4 v41, s[28:31], s88 offen lds
  s_add_u32 m0, s86, 10240
  s_add_u32 s88, s89, 327680
  buffer_load_dwordx4 v40, s[28:31], s88 offen lds
  s_add_u32 m0, s86, 11264
  s_add_u32 s88, s89, 360448
  buffer_load_dwordx4 v41, s[28:31], s88 offen lds
  s_add_u32 m0, s86, 12288
  s_add_u32 s88, s89, 393216
  buffer_load_dwordx4 v40, s[28:31], s88 offen lds
  s_add_u32 m0, s86, 13312
  s_add_u32 s88, s89, 425984
  buffer_load_dwordx4 v41, s[28:31], s88 offen lds
  s_add_u32 m0, s86, 14336
  s_add_u32 s88, s89, 458752
  buffer_load_dwordx4 v40, s[28:31], s88 offen lds
  s_add_u32 m0, s86, 15360
  s_add_u32 s88, s89, 491520
  buffer_load_dwordx4 v41, s[28:31], s88 offen lds
  s_add_u32 m0, s86, 16384
  s_add_u32 s88, s89, 524288
  buffer_load_dwordx4 v40, s[28:31], s88 offen lds
  s_add_u32 m0, s86, 17408
  s_add_u32 s88, s89, 557056
  buffer_load_dwordx4 v41, s[28:31], s88 offen lds
  s_add_u32 m0, s86, 18432
  s_add_u32 s88, s89, 589824
  buffer_load_dwordx4 v40, s[28:31], s88 offen lds
  s_add_u32 m0, s86, 19456
  s_add_u32 s88, s89, 622592
  buffer_load_dwordx4 v41, s[28:31], s88 offen lds
  s_branch L_m1_130
L_fail:
  s_mov_b32 s32, s54
  s_mov_b32 s33, s55
  s_mov_b32 s34, 256
  s_mov_b32 s35, 0x20000
  v_mov_b32 v4, 0xdead
  v_mov_b32 v5, 0
  s_mov_b64 exec, 1
  buffer_store_dword v4, v5, s[32:35], 0 offen
L_end:
  s_endpgm
L_code_end:
.section .rodata,"a"
.p2align 6
.amdhsa_kernel interleave_layers__sliding_block__mixer_token_mlp__prompt_kernel
  .amdhsa_next_free_vgpr 512
  .amdhsa_next_free_sgpr 102
  .amdhsa_accum_offset 256
  .amdhsa_group_segment_fixed_size 0
  .amdhsa_kernarg_size 88
  .amdhsa_user_sgpr_count 2
  .amdhsa_user_sgpr_kernarg_segment_ptr 1
  .amdhsa_system_sgpr_workgroup_id_x 1
.end_amdhsa_kernel
```
